```python
import torch

def _softmax(x, axis=-1):
    return torch.softmax(x, dim=axis)

def _gelu(x):
    return torch.nn.functional.gelu(x, approximate='tanh')

def _silu(x):
    return torch.nn.functional.silu(x)

def _sigmoid(x):
    return torch.sigmoid(x)

def _layernorm(x, axis=-1, eps=1e-05):
    m = x.mean(dim=axis, keepdim=True)
    v = x.var(dim=axis, keepdim=True, unbiased=False)
    return (x - m) / torch.sqrt(v + eps)

def _scatter_add(tgt, idx, src, axis=0):
    return tgt.clone().index_add_(axis, idx, src)

def _segment_sum(src, seg, n):
    out = torch.zeros((n,) + src.shape[1:], dtype=src.dtype)
    return out.index_add_(0, seg, src)

def _pad(x, pw):
    flat = tuple((v for pair in reversed(pw) for v in pair))
    return torch.nn.functional.pad(x, flat)
kernel_name = 'gated_mix__memory_aug_recurrent_mem_tr__mixer_token_mlp__prompt'

def setup_inputs():

    _w = lambda a: (lambda t: t.to(torch.bfloat16) if t.is_floating_point() else t)(torch.as_tensor(a))

    def _A_setup():
        B, S, Dm = (1, 2048, 512)
        H, Dh = (32, 128)
        M, seg = (8, 32)
        seg = min(seg, S)
        S = S // seg * seg
        return {'x': _w((lambda *s: torch.randn(*s, dtype=torch.bfloat16) * 0.05)(B, S, Dm)), 'mem0': _w((lambda *s: torch.randn(*s, dtype=torch.bfloat16) * 0.8)(B, M, Dm)), 'Wq': _w((lambda *s: torch.randn(*s, dtype=torch.bfloat16) * 3.2)(Dm, H, Dh) * Dm ** (-0.5)), 'Wk': _w((lambda *s: torch.randn(*s, dtype=torch.bfloat16) * 3.2)(Dm, H, Dh) * Dm ** (-0.5)), 'Wv': _w((lambda *s: torch.randn(*s, dtype=torch.bfloat16) * 0.8)(Dm, H, Dh) * Dm ** (-0.5)), 'Wo': _w((lambda *s: torch.randn(*s, dtype=torch.bfloat16) * 0.8)(H, Dh, Dm) * (H * Dh) ** (-0.5)), 'seg_len': seg}
    _A_in = _A_setup()

    def _B_setup():
        B, S, D, F = (1, 2048, 512, 1792)
        return {'x': _w((lambda *s: torch.randn(*s, dtype=torch.bfloat16) * 0.05)(B, S, D)), 'w1': _w((lambda *s: torch.randn(*s, dtype=torch.bfloat16) * 0.4)(S, F) * S ** (-0.5)), 'b1': _w((lambda *s: torch.randn(*s, dtype=torch.bfloat16) * 3.2)(F) * 0.02), 'w2': _w((lambda *s: torch.randn(*s, dtype=torch.bfloat16) * 0.8)(F, S) * F ** (-0.5)), 'b2': _w((lambda *s: torch.randn(*s, dtype=torch.bfloat16) * 3.2)(S) * 0.02)}
    _B_in = _B_setup()
    return {'A_x': _A_in['x'], 'A_mem0': _A_in['mem0'], 'A_Wq': _A_in['Wq'], 'A_Wk': _A_in['Wk'], 'A_Wv': _A_in['Wv'], 'A_Wo': _A_in['Wo'], 'A_seg_len': _A_in['seg_len'], 'B_x': _B_in['x'], 'B_w1': _B_in['w1'], 'B_b1': _B_in['b1'], 'B_w2': _B_in['w2'], 'B_b2': _B_in['b2'], 'gate_w': _w((lambda *s: torch.randn(*s, dtype=torch.bfloat16) * 0.05)(512) * 16.0)}

def reference(A_x, A_mem0, A_Wq, A_Wk, A_Wv, A_Wo, A_seg_len, B_x, B_w1, B_b1, B_w2, B_b2, gate_w):

    def _A_ref(x, mem0, Wq, Wk, Wv, Wo, seg_len):
        B, S, Dm = x.shape
        H, Dh = (Wq.shape[1], Wq.shape[2])
        M = mem0.shape[1]
        scale = Dh ** (-0.5)
        n_seg = S // seg_len
        L = M + seg_len
        idx = torch.arange(L)
        mask = (idx[:, None] < M) | (idx[:, None] >= idx[None, :])
        mem = mem0
        outs = []
        for s in range(n_seg):
            xs = x[:, s * seg_len:(s + 1) * seg_len, :].clone()
            h = torch.concatenate([mem, xs], axis=1)
            q = torch.einsum('btd,dhe->bhte', h, Wq)
            k = torch.einsum('btd,dhe->bhte', h, Wk)
            v = torch.einsum('btd,dhe->bhte', h, Wv)
            scores = torch.einsum('bhqe,bhke->bhqk', q, k) * scale
            scores = torch.where(mask[None, None], scores, -1000000000.0)
            p = _softmax(scores, axis=-1)
            o = torch.einsum('bhqk,bhke->bhqe', p, v)
            o = torch.einsum('bhte,hed->btd', o, Wo)
            mem = o[:, :M, :].clone()
            outs.append(o[:, M:, :])
        return torch.concatenate(outs, axis=1)

    def _B_ref(x, w1, b1, w2, b2):
        B, S, D = x.shape
        h = _layernorm(x, axis=-1)
        u = torch.einsum('bsd,sf->bdf', h, w1) + b1
        u = _gelu(u)
        y = torch.einsum('bdf,fs->bds', u, w2) + b2
        return (lambda x, *d: x.permute(*d))(y, 0, 2, 1)
    x = A_x
    g = _sigmoid((x * gate_w).sum(-1, keepdims=True))
    a = _A_ref(x, A_mem0, A_Wq, A_Wk, A_Wv, A_Wo, A_seg_len)
    b = _B_ref(x, B_w1, B_b1, B_w2, B_b2)
    return g * a + (1 - g) * b
```

```asm
; @launch grid=(256,1,1) block=(256,1,1) lds=163840
.amdgcn_target "amdgcn-amd-amdhsa--gfx950"
.text
.globl gated_mix__memory_aug_recurrent_mem_tr__mixer_token_mlp__prompt_kernel
.p2align 8
.type gated_mix__memory_aug_recurrent_mem_tr__mixer_token_mlp__prompt_kernel,@function
gated_mix__memory_aug_recurrent_mem_tr__mixer_token_mlp__prompt_kernel:
  s_cmp_ge_u32 s2, 256
  s_cbranch_scc0 L_run
  s_endpgm
L_run:
  s_xor_b32 s2, s2, 3
  s_and_b32 s3, s2, 7
  s_cmp_eq_u32 s3, 0
  s_cbranch_scc0 L_worker
  s_lshr_b32 s28, s2, 3
  s_load_dwordx2 s[16:17], s[0:1], 24
  s_mov_b32 s18, 4194304
  s_mov_b32 s19, 0x20000
  s_load_dwordx2 s[20:21], s[0:1], 32
  s_mov_b32 s22, 4194304
  s_mov_b32 s23, 0x20000
  s_load_dwordx2 s[12:13], s[0:1], 16
  s_mov_b32 s14, 4194304
  s_mov_b32 s15, 0x20000
  s_load_dwordx2 s[24:25], s[0:1], 40
  s_mov_b32 s26, 4194304
  s_mov_b32 s27, 0x20000
  s_load_dwordx2 s[8:9], s[0:1], 120
  s_mov_b32 s10, 268435456
  s_mov_b32 s11, 0x20000
  s_load_dwordx2 s[52:53], s[0:1], 112
  s_mov_b32 s54, 256
  s_mov_b32 s55, 0x20000
  s_load_dwordx2 s[4:5], s[0:1], 8
  v_lshrrev_b32 v16, 6, v0
  v_and_b32 v17, 63, v0
  v_readfirstlane_b32 s29, v16
  v_lshrrev_b32 v19, 4, v17
  v_bfe_u32 v18, v17, 1, 3
  v_xor_b32 v18, v18, v19
  v_lshlrev_b32 v21, 5, v18
  v_bfe_u32 v18, v17, 0, 1
  v_lshlrev_b32 v20, 4, v18
  v_bfe_u32 v18, v17, 4, 1
  v_lshl_add_u32 v20, v18, 17, v20
  v_bfe_u32 v18, v17, 5, 1
  v_lshl_add_u32 v20, v18, 18, v20
  s_lshl_b32 s3, s28, 8
  s_lshl_b32 s6, s29, 20
  s_add_u32 s3, s3, s6
  v_add3_u32 v20, v20, v21, s3
  v_xor_b32 v21, 128, v20
  s_lshl_b32 s40, s29, 15
  s_add_u32 s40, s40, 32768
  v_lshlrev_b32 v23, 4, v17
  s_lshl_b32 s3, s29, 11
  v_add_u32 v2, s3, v23
  v_lshlrev_b32 v10, 2, v0
  v_bfe_u32 v18, v17, 0, 1
  v_lshlrev_b32 v11, 10, v18
  v_bfe_u32 v18, v17, 1, 1
  v_lshl_add_u32 v11, v18, 6, v11
  v_bfe_u32 v18, v17, 2, 1
  v_lshl_add_u32 v11, v18, 11, v11
  v_bfe_u32 v18, v17, 3, 1
  v_lshl_add_u32 v11, v18, 12, v11
  v_bfe_u32 v18, v17, 5, 1
  v_lshl_add_u32 v11, v18, 4, v11
  v_bfe_u32 v18, v17, 0, 1
  v_lshlrev_b32 v22, 10, v18
  v_bfe_u32 v18, v17, 1, 1
  v_lshl_add_u32 v22, v18, 6, v22
  v_bfe_u32 v18, v17, 2, 1
  v_lshl_add_u32 v22, v18, 11, v22
  v_bfe_u32 v18, v17, 3, 1
  v_lshl_add_u32 v22, v18, 12, v22
  v_bfe_u32 v18, v17, 5, 1
  v_lshl_add_u32 v22, v18, 4, v22
  v_mov_b32 v32, -1
  v_mov_b32 v33, -1
  v_mov_b32 v34, -1
  v_mov_b32 v35, -1
  s_lshl_b32 s3, s29, 8
  v_add_u32 v11, s3, v11
  v_add_u32 v22, s3, v22
  v_and_b32 v18, 1, v17
  v_lshlrev_b32 v18, 21, v18
  s_lshl_b32 s6, s28, 13
  s_add_u32 s6, s6, 0
  s_lshl_b32 s7, s28, 10
  s_add_u32 s7, s7, 524288
  s_waitcnt lgkmcnt(0)
  buffer_store_dwordx4 v[32:35], v2, s[8:11], s6 offen offset:0 sc1
  buffer_store_dwordx4 v[32:35], v2, s[8:11], s6 offen offset:1024 sc1
  buffer_store_dword v32, v10, s[8:11], s7 offen sc1
  s_cmp_lg_u32 s29, 0
  s_cbranch_scc1 T_fa_1
  s_lshl_b32 s3, s28, 7
  s_add_u32 s3, s3, 589824
  v_mov_b32 v16, 0
  s_mov_b32 exec_hi, 0
  buffer_store_dword v16, v10, s[8:11], s3 offen sc1
  s_mov_b32 exec_hi, -1
T_fa_1:
  global_load_dwordx4 v[36:39], v11, s[4:5] offset:0
  global_load_dwordx4 v[40:43], v11, s[4:5] offset:32
  global_load_dwordx4 v[44:47], v22, s[4:5] offset:128
  global_load_dwordx4 v[12:15], v22, s[4:5] offset:160
  s_add_u32 m0, s40, 0
  s_mov_b32 s3, 0
  buffer_load_dwordx4 v20, s[16:19], s3 offen  lds
  s_add_u32 m0, s40, 1024
  s_mov_b32 s3, 32768
  buffer_load_dwordx4 v21, s[16:19], s3 offen  lds
  s_add_u32 m0, s40, 2048
  s_mov_b32 s3, 8192
  buffer_load_dwordx4 v20, s[16:19], s3 offen  lds
  s_add_u32 m0, s40, 3072
  s_mov_b32 s3, 40960
  buffer_load_dwordx4 v21, s[16:19], s3 offen  lds
  s_add_u32 m0, s40, 4096
  s_mov_b32 s3, 16384
  buffer_load_dwordx4 v20, s[16:19], s3 offen  lds
  s_add_u32 m0, s40, 5120
  s_mov_b32 s3, 49152
  buffer_load_dwordx4 v21, s[16:19], s3 offen  lds
  s_add_u32 m0, s40, 6144
  s_mov_b32 s3, 24576
  buffer_load_dwordx4 v20, s[16:19], s3 offen  lds
  s_add_u32 m0, s40, 7168
  s_mov_b32 s3, 57344
  buffer_load_dwordx4 v21, s[16:19], s3 offen  lds
  v_add_u32 v8, s40, v23
  v_bfe_u32 v18, v17, 2, 2
  v_xor_b32 v18, v18, v19
  v_lshlrev_b32 v32, 6, v18
  v_bfe_u32 v18, v17, 0, 1
  v_lshlrev_b32 v22, 4, v18
  v_bfe_u32 v18, v17, 1, 1
  v_lshl_add_u32 v22, v18, 5, v22
  v_bfe_u32 v18, v17, 4, 1
  v_lshl_add_u32 v22, v18, 10, v22
  v_bfe_u32 v18, v17, 5, 1
  v_lshl_add_u32 v22, v18, 14, v22
  s_lshl_b32 s3, s28, 17
  s_lshl_b32 s6, s29, 8
  s_add_u32 s3, s3, s6
  v_add3_u32 v22, v22, v32, s3
  s_lshl_b32 s43, s29, 15
  v_bfe_u32 v18, v17, 0, 1
  v_lshlrev_b32 v32, 3, v18
  v_bfe_u32 v18, v17, 1, 1
  v_lshl_add_u32 v32, v18, 4, v32
  v_bfe_u32 v18, v17, 2, 1
  v_lshl_add_u32 v32, v18, 8, v32
  v_bfe_u32 v18, v17, 3, 1
  v_lshl_add_u32 v32, v18, 9, v32
  v_bfe_u32 v18, v17, 4, 1
  v_lshl_add_u32 v32, v18, 10, v32
  v_bfe_u32 v18, v17, 5, 1
  v_lshl_add_u32 v32, v18, 11, v32
  s_lshl_b32 s3, s29, 1
  v_bfe_u32 v18, v17, 2, 3
  v_xor_b32 v18, s3, v18
  v_lshl_add_u32 v32, v18, 5, v32
  s_xor_b32 s3, s43, 0
  s_add_u32 s3, s3, 32768
  v_add_u32 v24, s3, v32
  v_xor_b32 v25, 32, v24
  s_xor_b32 s3, s43, 32768
  s_add_u32 s3, s3, 32768
  v_add_u32 v26, s3, v32
  v_xor_b32 v27, 32, v26
  s_xor_b32 s3, s43, 65536
  s_add_u32 s3, s3, 32768
  v_add_u32 v28, s3, v32
  v_xor_b32 v29, 32, v28
  s_xor_b32 s3, s43, 98304
  s_add_u32 s3, s3, 32768
  v_add_u32 v30, s3, v32
  v_xor_b32 v31, 32, v30
  s_lshl_b32 s6, s28, 13
  s_add_u32 s6, s6, 0
  s_and_b32 s7, s29, 1
  s_lshl_b32 s3, s7, 12
  s_add_u32 s3, s3, s6
  v_lshl_add_u32 v0, v17, 4, s3
  v_bfe_u32 v18, v17, 0, 1
  v_lshlrev_b32 v7, 2, v18
  v_bfe_u32 v18, v17, 1, 1
  v_lshl_add_u32 v7, v18, 3, v7
  v_bfe_u32 v18, v17, 2, 1
  v_lshl_add_u32 v7, v18, 5, v7
  v_bfe_u32 v18, v17, 3, 1
  v_lshl_add_u32 v7, v18, 4, v7
  v_bfe_u32 v18, v17, 4, 1
  v_lshl_add_u32 v7, v18, 8, v7
  v_bfe_u32 v18, v17, 5, 1
  v_lshl_add_u32 v7, v18, 13, v7
  s_lshl_b32 s3, s7, 10
  s_lshr_b32 s7, s28, 3
  s_lshl_b32 s7, s7, 11
  s_add_u32 s3, s3, s7
  s_and_b32 s7, s28, 1
  s_lshl_b32 s7, s7, 9
  s_add_u32 s3, s3, s7
  s_and_b32 s7, s28, 6
  s_lshl_b32 s7, s7, 5
  s_add_u32 s3, s3, s7
  s_add_u32 s3, s3, 524288
  v_add_u32 v7, s3, v7
  v_xor_b32 v7, 8192, v7
  s_mov_b32 s31, 524288
  s_mov_b32 s48, 0
  s_mov_b32 s49, -1
  v_and_b32 v18, 2, v17
  v_cmp_ne_u32 vcc, 0, v18
  v_mov_b32 v19, 0x44444444
  v_mov_b32 v18, 0xeeeeeeee
  v_cndmask_b32 v1, v19, v18, vcc
  v_lshrrev_b32 v18, 4, v17
  v_bfe_u32 v19, v17, 2, 2
  v_xor_b32 v19, v18, v19
  v_lshlrev_b32 v19, 3, v19
  v_and_b32 v3, 15, v17
  v_lshl_add_u32 v3, v3, 5, v19
  s_lshl_b32 s3, s29, 10
  s_add_u32 s7, s3, 24576
  v_add_u32 v3, s7, v3
  v_and_b32 v19, 3, v17
  v_xor_b32 v19, v18, v19
  v_lshlrev_b32 v19, 3, v19
  v_lshrrev_b32 v18, 2, v17
  v_lshl_add_u32 v19, v18, 5, v19
  v_add_u32 v4, 24576, v19
  s_add_u32 s7, s3, 0
  v_add_u32 v5, s7, v23
  v_add_u32 v9, 8192, v23
  v_lshrrev_b32 v18, 3, v17
  v_lshlrev_b32 v18, 13, v18
  v_and_b32 v19, 7, v17
  v_lshl_add_u32 v18, v19, 3, v18
  s_lshl_b32 s3, s29, 16
  s_lshl_b32 s7, s28, 7
  s_add_u32 s3, s3, s7
  s_add_u32 s3, s3, 0
  v_add_u32 v6, s3, v18
  s_mov_b32 s41, 0x3e0293ee
  s_mov_b32 s46, 0x3f803f80
  s_mov_b32 s47, 0x3f803f80
  s_mov_b32 s56, 1199570944
  s_mov_b32 s57, 0xcccccccc
  s_mov_b32 s32, 0x6000
  s_mov_b32 s30, 0
  s_mov_b32 s34, 0
  s_mov_b32 s35, 4096
  s_mov_b32 s44, 0
  s_lshl_b32 s3, s28, 20
  s_add_u32 s37, s3, 8396800
  s_add_u32 s38, s3, 8388608
  s_mov_b32 s36, 0
  s_mul_i32 s3, s28, 266240
  s_add_u32 s39, s3, 59768832
  v_mov_b32 v35, 0x3f80
  s_mov_b32 vcc_lo, 0xcccccccc
  s_mov_b32 vcc_hi, 0xcccccccc
  v_cndmask_b32 v19, v35, 1.0, vcc
  s_mov_b32 vcc_lo, 84215045
  s_mov_b32 vcc_hi, 84215045
  v_cndmask_b32 v32, 0, v19, vcc
  s_mov_b32 vcc_lo, 168430090
  s_mov_b32 vcc_hi, 168430090
  v_cndmask_b32 v33, 0, v19, vcc
  s_mov_b32 vcc_lo, 1347440720
  s_mov_b32 vcc_hi, 1347440720
  v_cndmask_b32 v34, 0, v19, vcc
  s_mov_b32 vcc_lo, 2694881440
  s_mov_b32 vcc_hi, 2694881440
  v_cndmask_b32 v35, 0, v19, vcc
  ds_write_b128 v23, v[32:35] offset:29696
  s_lshl_b32 s6, s29, 12
  s_add_u32 s6, s6, 8192
  s_lshl_b32 s3, s28, 7
  s_add_u32 s3, s3, 589824
  v_and_b32 v18, 31, v17
  v_min_u32 v19, 5, v18
  v_lshl_add_u32 v18, v18, 7, s6
  v_lshl_add_u32 v19, v19, 2, s3
  v_cndmask_b32 v18, v18, v19, s[48:49]
  v_lshrrev_b32 v19, 2, v5
  ds_write_b32 v19, v18 offset:30720
  s_lshl_b32 s50, s29, 8
  s_add_u32 s50, s50, 28672
  s_add_u32 m0, s40, 8192
  s_mov_b32 s3, 65536
  buffer_load_dwordx4 v20, s[16:19], s3 offen  lds
  s_add_u32 m0, s40, 9216
  s_mov_b32 s3, 98304
  buffer_load_dwordx4 v21, s[16:19], s3 offen  lds
  s_add_u32 m0, s40, 10240
  s_mov_b32 s3, 73728
  buffer_load_dwordx4 v20, s[16:19], s3 offen  lds
  s_add_u32 m0, s40, 11264
  s_mov_b32 s3, 106496
  buffer_load_dwordx4 v21, s[16:19], s3 offen  lds
  s_add_u32 m0, s40, 12288
  s_mov_b32 s3, 81920
  buffer_load_dwordx4 v20, s[16:19], s3 offen  lds
  s_add_u32 m0, s40, 13312
  s_mov_b32 s3, 114688
  buffer_load_dwordx4 v21, s[16:19], s3 offen  lds
  s_add_u32 m0, s40, 14336
  s_mov_b32 s3, 90112
  buffer_load_dwordx4 v20, s[16:19], s3 offen  lds
  s_add_u32 m0, s40, 15360
  s_mov_b32 s3, 122880
  buffer_load_dwordx4 v21, s[16:19], s3 offen  lds
  s_add_u32 m0, s40, 16384
  s_mov_b32 s3, 524288
  buffer_load_dwordx4 v20, s[16:19], s3 offen  lds
  s_add_u32 m0, s40, 17408
  s_mov_b32 s3, 557056
  buffer_load_dwordx4 v21, s[16:19], s3 offen  lds
  s_add_u32 m0, s40, 18432
  s_mov_b32 s3, 532480
  buffer_load_dwordx4 v20, s[16:19], s3 offen  lds
  s_add_u32 m0, s40, 19456
  s_mov_b32 s3, 565248
  buffer_load_dwordx4 v21, s[16:19], s3 offen  lds
  s_add_u32 m0, s40, 20480
  s_mov_b32 s3, 540672
  buffer_load_dwordx4 v20, s[16:19], s3 offen  lds
  s_add_u32 m0, s40, 21504
  s_mov_b32 s3, 573440
  buffer_load_dwordx4 v21, s[16:19], s3 offen  lds
  s_add_u32 m0, s40, 22528
  s_mov_b32 s3, 548864
  buffer_load_dwordx4 v20, s[16:19], s3 offen  lds
  s_add_u32 m0, s40, 23552
  s_mov_b32 s3, 581632
  buffer_load_dwordx4 v21, s[16:19], s3 offen  lds
  s_waitcnt vmcnt(16) lgkmcnt(0)
  s_barrier
  s_cmp_lg_u32 s29, 0
  s_cbranch_scc1 T_say_2
  s_getreg_b32 s3, hwreg(HW_REG_XCC_ID, 0, 4)
  s_add_u32 s3, s3, 1
  v_mov_b32 v19, s3
  s_lshl_b32 s6, s28, 2
  s_mov_b64 exec, 1
  buffer_store_dword v19, off, s[52:55], s6 sc1
  s_mov_b64 exec, -1
T_say_2:
  ds_read_b64_tr_b16 a[0:1], v24 offset:0
  ds_read_b64_tr_b16 a[2:3], v24 offset:4096
  s_add_u32 m0, s40, 24576
  s_mov_b32 s3, 589824
  buffer_load_dwordx4 v20, s[16:19], s3 offen  lds
  ds_read_b64_tr_b16 a[8:9], v25 offset:0
  ds_read_b64_tr_b16 a[10:11], v25 offset:4096
  s_add_u32 m0, s40, 25600
  s_mov_b32 s3, 622592
  buffer_load_dwordx4 v21, s[16:19], s3 offen  lds
  ds_read_b64_tr_b16 a[16:17], v26 offset:0
  ds_read_b64_tr_b16 a[18:19], v26 offset:4096
  s_add_u32 m0, s40, 26624
  s_mov_b32 s3, 598016
  buffer_load_dwordx4 v20, s[16:19], s3 offen  lds
  ds_read_b64_tr_b16 a[24:25], v27 offset:0
  ds_read_b64_tr_b16 a[26:27], v27 offset:4096
  s_add_u32 m0, s40, 27648
  s_mov_b32 s3, 630784
  buffer_load_dwordx4 v21, s[16:19], s3 offen  lds
  ds_read_b64_tr_b16 a[64:65], v28 offset:0
  ds_read_b64_tr_b16 a[66:67], v28 offset:4096
  s_add_u32 m0, s40, 28672
  s_mov_b32 s3, 606208
  buffer_load_dwordx4 v20, s[16:19], s3 offen  lds
  ds_read_b64_tr_b16 a[72:73], v29 offset:0
  ds_read_b64_tr_b16 a[74:75], v29 offset:4096
  s_add_u32 m0, s40, 29696
  s_mov_b32 s3, 638976
  buffer_load_dwordx4 v21, s[16:19], s3 offen  lds
  ds_read_b64_tr_b16 a[80:81], v30 offset:0
  ds_read_b64_tr_b16 a[82:83], v30 offset:4096
  s_add_u32 m0, s40, 30720
  s_mov_b32 s3, 614400
  buffer_load_dwordx4 v20, s[16:19], s3 offen  lds
  ds_read_b64_tr_b16 a[88:89], v31 offset:0
  ds_read_b64_tr_b16 a[90:91], v31 offset:4096
  s_add_u32 m0, s40, 31744
  s_mov_b32 s3, 647168
  buffer_load_dwordx4 v21, s[16:19], s3 offen  lds
  s_waitcnt vmcnt(16) lgkmcnt(0)
  s_barrier
  ds_read_b64_tr_b16 a[4:5], v24 offset:8192
  ds_read_b64_tr_b16 a[6:7], v24 offset:12288
  s_add_u32 m0, s40, 0
  s_mov_b32 s3, 0
  buffer_load_dwordx4 v20, s[20:23], s3 offen  lds
  ds_read_b64_tr_b16 a[12:13], v25 offset:8192
  ds_read_b64_tr_b16 a[14:15], v25 offset:12288
  s_add_u32 m0, s40, 1024
  s_mov_b32 s3, 32768
  buffer_load_dwordx4 v21, s[20:23], s3 offen  lds
  ds_read_b64_tr_b16 a[20:21], v26 offset:8192
  ds_read_b64_tr_b16 a[22:23], v26 offset:12288
  s_add_u32 m0, s40, 2048
  s_mov_b32 s3, 8192
  buffer_load_dwordx4 v20, s[20:23], s3 offen  lds
  ds_read_b64_tr_b16 a[28:29], v27 offset:8192
  ds_read_b64_tr_b16 a[30:31], v27 offset:12288
  s_add_u32 m0, s40, 3072
  s_mov_b32 s3, 40960
  buffer_load_dwordx4 v21, s[20:23], s3 offen  lds
  ds_read_b64_tr_b16 a[68:69], v28 offset:8192
  ds_read_b64_tr_b16 a[70:71], v28 offset:12288
  s_add_u32 m0, s40, 4096
  s_mov_b32 s3, 16384
  buffer_load_dwordx4 v20, s[20:23], s3 offen  lds
  ds_read_b64_tr_b16 a[76:77], v29 offset:8192
  ds_read_b64_tr_b16 a[78:79], v29 offset:12288
  s_add_u32 m0, s40, 5120
  s_mov_b32 s3, 49152
  buffer_load_dwordx4 v21, s[20:23], s3 offen  lds
  ds_read_b64_tr_b16 a[84:85], v30 offset:8192
  ds_read_b64_tr_b16 a[86:87], v30 offset:12288
  s_add_u32 m0, s40, 6144
  s_mov_b32 s3, 24576
  buffer_load_dwordx4 v20, s[20:23], s3 offen  lds
  ds_read_b64_tr_b16 a[92:93], v31 offset:8192
  ds_read_b64_tr_b16 a[94:95], v31 offset:12288
  s_add_u32 m0, s40, 7168
  s_mov_b32 s3, 57344
  buffer_load_dwordx4 v21, s[20:23], s3 offen  lds
  s_waitcnt vmcnt(16) lgkmcnt(0)
  s_barrier
  ds_read_b64_tr_b16 a[32:33], v24 offset:16384
  ds_read_b64_tr_b16 a[34:35], v24 offset:20480
  s_add_u32 m0, s40, 8192
  s_mov_b32 s3, 65536
  buffer_load_dwordx4 v20, s[20:23], s3 offen  lds
  ds_read_b64_tr_b16 a[40:41], v25 offset:16384
  ds_read_b64_tr_b16 a[42:43], v25 offset:20480
  s_add_u32 m0, s40, 9216
  s_mov_b32 s3, 98304
  buffer_load_dwordx4 v21, s[20:23], s3 offen  lds
  ds_read_b64_tr_b16 a[48:49], v26 offset:16384
  ds_read_b64_tr_b16 a[50:51], v26 offset:20480
  s_add_u32 m0, s40, 10240
  s_mov_b32 s3, 73728
  buffer_load_dwordx4 v20, s[20:23], s3 offen  lds
  ds_read_b64_tr_b16 a[56:57], v27 offset:16384
  ds_read_b64_tr_b16 a[58:59], v27 offset:20480
  s_add_u32 m0, s40, 11264
  s_mov_b32 s3, 106496
  buffer_load_dwordx4 v21, s[20:23], s3 offen  lds
  ds_read_b64_tr_b16 a[96:97], v28 offset:16384
  ds_read_b64_tr_b16 a[98:99], v28 offset:20480
  s_add_u32 m0, s40, 12288
  s_mov_b32 s3, 81920
  buffer_load_dwordx4 v20, s[20:23], s3 offen  lds
  ds_read_b64_tr_b16 a[104:105], v29 offset:16384
  ds_read_b64_tr_b16 a[106:107], v29 offset:20480
  s_add_u32 m0, s40, 13312
  s_mov_b32 s3, 114688
  buffer_load_dwordx4 v21, s[20:23], s3 offen  lds
  ds_read_b64_tr_b16 a[112:113], v30 offset:16384
  ds_read_b64_tr_b16 a[114:115], v30 offset:20480
  s_add_u32 m0, s40, 14336
  s_mov_b32 s3, 90112
  buffer_load_dwordx4 v20, s[20:23], s3 offen  lds
  ds_read_b64_tr_b16 a[120:121], v31 offset:16384
  ds_read_b64_tr_b16 a[122:123], v31 offset:20480
  s_add_u32 m0, s40, 15360
  s_mov_b32 s3, 122880
  buffer_load_dwordx4 v21, s[20:23], s3 offen  lds
  s_waitcnt vmcnt(16) lgkmcnt(0)
  s_barrier
  ds_read_b64_tr_b16 a[36:37], v24 offset:24576
  ds_read_b64_tr_b16 a[38:39], v24 offset:28672
  s_add_u32 m0, s40, 16384
  s_mov_b32 s3, 524288
  buffer_load_dwordx4 v20, s[20:23], s3 offen  lds
  ds_read_b64_tr_b16 a[44:45], v25 offset:24576
  ds_read_b64_tr_b16 a[46:47], v25 offset:28672
  s_add_u32 m0, s40, 17408
  s_mov_b32 s3, 557056
  buffer_load_dwordx4 v21, s[20:23], s3 offen  lds
  ds_read_b64_tr_b16 a[52:53], v26 offset:24576
  ds_read_b64_tr_b16 a[54:55], v26 offset:28672
  s_add_u32 m0, s40, 18432
  s_mov_b32 s3, 532480
  buffer_load_dwordx4 v20, s[20:23], s3 offen  lds
  ds_read_b64_tr_b16 a[60:61], v27 offset:24576
  ds_read_b64_tr_b16 a[62:63], v27 offset:28672
  s_add_u32 m0, s40, 19456
  s_mov_b32 s3, 565248
  buffer_load_dwordx4 v21, s[20:23], s3 offen  lds
  ds_read_b64_tr_b16 a[100:101], v28 offset:24576
  ds_read_b64_tr_b16 a[102:103], v28 offset:28672
  s_add_u32 m0, s40, 20480
  s_mov_b32 s3, 540672
  buffer_load_dwordx4 v20, s[20:23], s3 offen  lds
  ds_read_b64_tr_b16 a[108:109], v29 offset:24576
  ds_read_b64_tr_b16 a[110:111], v29 offset:28672
  s_add_u32 m0, s40, 21504
  s_mov_b32 s3, 573440
  buffer_load_dwordx4 v21, s[20:23], s3 offen  lds
  ds_read_b64_tr_b16 a[116:117], v30 offset:24576
  ds_read_b64_tr_b16 a[118:119], v30 offset:28672
  s_add_u32 m0, s40, 22528
  s_mov_b32 s3, 548864
  buffer_load_dwordx4 v20, s[20:23], s3 offen  lds
  ds_read_b64_tr_b16 a[124:125], v31 offset:24576
  ds_read_b64_tr_b16 a[126:127], v31 offset:28672
  s_add_u32 m0, s40, 23552
  s_mov_b32 s3, 581632
  buffer_load_dwordx4 v21, s[20:23], s3 offen  lds
  s_waitcnt vmcnt(16) lgkmcnt(0)
  s_barrier
  ds_read_b64_tr_b16 a[128:129], v24 offset:0
  ds_read_b64_tr_b16 a[130:131], v24 offset:4096
  s_add_u32 m0, s40, 24576
  s_mov_b32 s3, 589824
  buffer_load_dwordx4 v20, s[20:23], s3 offen  lds
  ds_read_b64_tr_b16 a[136:137], v25 offset:0
  ds_read_b64_tr_b16 a[138:139], v25 offset:4096
  s_add_u32 m0, s40, 25600
  s_mov_b32 s3, 622592
  buffer_load_dwordx4 v21, s[20:23], s3 offen  lds
  ds_read_b64_tr_b16 a[144:145], v26 offset:0
  ds_read_b64_tr_b16 a[146:147], v26 offset:4096
  s_add_u32 m0, s40, 26624
  s_mov_b32 s3, 598016
  buffer_load_dwordx4 v20, s[20:23], s3 offen  lds
  ds_read_b64_tr_b16 a[152:153], v27 offset:0
  ds_read_b64_tr_b16 a[154:155], v27 offset:4096
  s_add_u32 m0, s40, 27648
  s_mov_b32 s3, 630784
  buffer_load_dwordx4 v21, s[20:23], s3 offen  lds
  ds_read_b64_tr_b16 a[192:193], v28 offset:0
  ds_read_b64_tr_b16 a[194:195], v28 offset:4096
  s_add_u32 m0, s40, 28672
  s_mov_b32 s3, 606208
  buffer_load_dwordx4 v20, s[20:23], s3 offen  lds
  ds_read_b64_tr_b16 a[200:201], v29 offset:0
  ds_read_b64_tr_b16 a[202:203], v29 offset:4096
  s_add_u32 m0, s40, 29696
  s_mov_b32 s3, 638976
  buffer_load_dwordx4 v21, s[20:23], s3 offen  lds
  ds_read_b64_tr_b16 a[208:209], v30 offset:0
  ds_read_b64_tr_b16 a[210:211], v30 offset:4096
  s_add_u32 m0, s40, 30720
  s_mov_b32 s3, 614400
  buffer_load_dwordx4 v20, s[20:23], s3 offen  lds
  ds_read_b64_tr_b16 a[216:217], v31 offset:0
  ds_read_b64_tr_b16 a[218:219], v31 offset:4096
  s_add_u32 m0, s40, 31744
  s_mov_b32 s3, 647168
  buffer_load_dwordx4 v21, s[20:23], s3 offen  lds
  s_waitcnt vmcnt(16) lgkmcnt(0)
  s_barrier
  ds_read_b64_tr_b16 a[132:133], v24 offset:8192
  ds_read_b64_tr_b16 a[134:135], v24 offset:12288
  s_add_u32 m0, s40, 0
  s_mov_b32 s3, 0
  buffer_load_dwordx4 v20, s[12:15], s3 offen  lds
  ds_read_b64_tr_b16 a[140:141], v25 offset:8192
  ds_read_b64_tr_b16 a[142:143], v25 offset:12288
  s_add_u32 m0, s40, 1024
  s_mov_b32 s3, 32768
  buffer_load_dwordx4 v21, s[12:15], s3 offen  lds
  ds_read_b64_tr_b16 a[148:149], v26 offset:8192
  ds_read_b64_tr_b16 a[150:151], v26 offset:12288
  s_add_u32 m0, s40, 2048
  s_mov_b32 s3, 8192
  buffer_load_dwordx4 v20, s[12:15], s3 offen  lds
  ds_read_b64_tr_b16 a[156:157], v27 offset:8192
  ds_read_b64_tr_b16 a[158:159], v27 offset:12288
  s_add_u32 m0, s40, 3072
  s_mov_b32 s3, 40960
  buffer_load_dwordx4 v21, s[12:15], s3 offen  lds
  ds_read_b64_tr_b16 a[196:197], v28 offset:8192
  ds_read_b64_tr_b16 a[198:199], v28 offset:12288
  s_add_u32 m0, s40, 4096
  s_mov_b32 s3, 16384
  buffer_load_dwordx4 v20, s[12:15], s3 offen  lds
  ds_read_b64_tr_b16 a[204:205], v29 offset:8192
  ds_read_b64_tr_b16 a[206:207], v29 offset:12288
  s_add_u32 m0, s40, 5120
  s_mov_b32 s3, 49152
  buffer_load_dwordx4 v21, s[12:15], s3 offen  lds
  ds_read_b64_tr_b16 a[212:213], v30 offset:8192
  ds_read_b64_tr_b16 a[214:215], v30 offset:12288
  s_add_u32 m0, s40, 6144
  s_mov_b32 s3, 24576
  buffer_load_dwordx4 v20, s[12:15], s3 offen  lds
  ds_read_b64_tr_b16 a[220:221], v31 offset:8192
  ds_read_b64_tr_b16 a[222:223], v31 offset:12288
  s_add_u32 m0, s40, 7168
  s_mov_b32 s3, 57344
  buffer_load_dwordx4 v21, s[12:15], s3 offen  lds
  s_waitcnt vmcnt(16) lgkmcnt(0)
  s_barrier
  ds_read_b64_tr_b16 a[160:161], v24 offset:16384
  ds_read_b64_tr_b16 a[162:163], v24 offset:20480
  s_add_u32 m0, s40, 8192
  s_mov_b32 s3, 65536
  buffer_load_dwordx4 v20, s[12:15], s3 offen  lds
  ds_read_b64_tr_b16 a[168:169], v25 offset:16384
  ds_read_b64_tr_b16 a[170:171], v25 offset:20480
  s_add_u32 m0, s40, 9216
  s_mov_b32 s3, 98304
  buffer_load_dwordx4 v21, s[12:15], s3 offen  lds
  ds_read_b64_tr_b16 a[176:177], v26 offset:16384
  ds_read_b64_tr_b16 a[178:179], v26 offset:20480
  s_add_u32 m0, s40, 10240
  s_mov_b32 s3, 73728
  buffer_load_dwordx4 v20, s[12:15], s3 offen  lds
  ds_read_b64_tr_b16 a[184:185], v27 offset:16384
  ds_read_b64_tr_b16 a[186:187], v27 offset:20480
  s_add_u32 m0, s40, 11264
  s_mov_b32 s3, 106496
  buffer_load_dwordx4 v21, s[12:15], s3 offen  lds
  ds_read_b64_tr_b16 a[224:225], v28 offset:16384
  ds_read_b64_tr_b16 a[226:227], v28 offset:20480
  s_add_u32 m0, s40, 12288
  s_mov_b32 s3, 81920
  buffer_load_dwordx4 v20, s[12:15], s3 offen  lds
  ds_read_b64_tr_b16 a[232:233], v29 offset:16384
  ds_read_b64_tr_b16 a[234:235], v29 offset:20480
  s_add_u32 m0, s40, 13312
  s_mov_b32 s3, 114688
  buffer_load_dwordx4 v21, s[12:15], s3 offen  lds
  ds_read_b64_tr_b16 a[240:241], v30 offset:16384
  ds_read_b64_tr_b16 a[242:243], v30 offset:20480
  s_add_u32 m0, s40, 14336
  s_mov_b32 s3, 90112
  buffer_load_dwordx4 v20, s[12:15], s3 offen  lds
  ds_read_b64_tr_b16 a[248:249], v31 offset:16384
  ds_read_b64_tr_b16 a[250:251], v31 offset:20480
  s_add_u32 m0, s40, 15360
  s_mov_b32 s3, 122880
  buffer_load_dwordx4 v21, s[12:15], s3 offen  lds
  s_waitcnt vmcnt(16) lgkmcnt(0)
  s_barrier
  ds_read_b64_tr_b16 a[164:165], v24 offset:24576
  ds_read_b64_tr_b16 a[166:167], v24 offset:28672
  s_add_u32 m0, s40, 16384
  s_mov_b32 s3, 524288
  buffer_load_dwordx4 v20, s[12:15], s3 offen  lds
  ds_read_b64_tr_b16 a[172:173], v25 offset:24576
  ds_read_b64_tr_b16 a[174:175], v25 offset:28672
  s_add_u32 m0, s40, 17408
  s_mov_b32 s3, 557056
  buffer_load_dwordx4 v21, s[12:15], s3 offen  lds
  ds_read_b64_tr_b16 a[180:181], v26 offset:24576
  ds_read_b64_tr_b16 a[182:183], v26 offset:28672
  s_add_u32 m0, s40, 18432
  s_mov_b32 s3, 532480
  buffer_load_dwordx4 v20, s[12:15], s3 offen  lds
  ds_read_b64_tr_b16 a[188:189], v27 offset:24576
  ds_read_b64_tr_b16 a[190:191], v27 offset:28672
  s_add_u32 m0, s40, 19456
  s_mov_b32 s3, 565248
  buffer_load_dwordx4 v21, s[12:15], s3 offen  lds
  ds_read_b64_tr_b16 a[228:229], v28 offset:24576
  ds_read_b64_tr_b16 a[230:231], v28 offset:28672
  s_add_u32 m0, s40, 20480
  s_mov_b32 s3, 540672
  buffer_load_dwordx4 v20, s[12:15], s3 offen  lds
  ds_read_b64_tr_b16 a[236:237], v29 offset:24576
  ds_read_b64_tr_b16 a[238:239], v29 offset:28672
  s_add_u32 m0, s40, 21504
  s_mov_b32 s3, 573440
  buffer_load_dwordx4 v21, s[12:15], s3 offen  lds
  ds_read_b64_tr_b16 a[244:245], v30 offset:24576
  ds_read_b64_tr_b16 a[246:247], v30 offset:28672
  s_add_u32 m0, s40, 22528
  s_mov_b32 s3, 548864
  buffer_load_dwordx4 v20, s[12:15], s3 offen  lds
  ds_read_b64_tr_b16 a[252:253], v31 offset:24576
  ds_read_b64_tr_b16 a[254:255], v31 offset:28672
  s_add_u32 m0, s40, 23552
  s_mov_b32 s3, 581632
  buffer_load_dwordx4 v21, s[12:15], s3 offen  lds
  s_waitcnt vmcnt(16) lgkmcnt(0)
  s_barrier
  ds_read_b64_tr_b16 v[64:65], v24 offset:0
  ds_read_b64_tr_b16 v[66:67], v24 offset:4096
  s_add_u32 m0, s40, 24576
  s_mov_b32 s3, 589824
  buffer_load_dwordx4 v20, s[12:15], s3 offen  lds
  ds_read_b64_tr_b16 v[72:73], v25 offset:0
  ds_read_b64_tr_b16 v[74:75], v25 offset:4096
  s_add_u32 m0, s40, 25600
  s_mov_b32 s3, 622592
  buffer_load_dwordx4 v21, s[12:15], s3 offen  lds
  ds_read_b64_tr_b16 v[80:81], v26 offset:0
  ds_read_b64_tr_b16 v[82:83], v26 offset:4096
  s_add_u32 m0, s40, 26624
  s_mov_b32 s3, 598016
  buffer_load_dwordx4 v20, s[12:15], s3 offen  lds
  ds_read_b64_tr_b16 v[88:89], v27 offset:0
  ds_read_b64_tr_b16 v[90:91], v27 offset:4096
  s_add_u32 m0, s40, 27648
  s_mov_b32 s3, 630784
  buffer_load_dwordx4 v21, s[12:15], s3 offen  lds
  ds_read_b64_tr_b16 v[208:209], v28 offset:0
  ds_read_b64_tr_b16 v[210:211], v28 offset:4096
  s_add_u32 m0, s40, 28672
  s_mov_b32 s3, 606208
  buffer_load_dwordx4 v20, s[12:15], s3 offen  lds
  ds_read_b64_tr_b16 v[216:217], v29 offset:0
  ds_read_b64_tr_b16 v[218:219], v29 offset:4096
  s_add_u32 m0, s40, 29696
  s_mov_b32 s3, 638976
  buffer_load_dwordx4 v21, s[12:15], s3 offen  lds
  ds_read_b64_tr_b16 v[224:225], v30 offset:0
  ds_read_b64_tr_b16 v[226:227], v30 offset:4096
  s_add_u32 m0, s40, 30720
  s_mov_b32 s3, 614400
  buffer_load_dwordx4 v20, s[12:15], s3 offen  lds
  ds_read_b64_tr_b16 v[232:233], v31 offset:0
  ds_read_b64_tr_b16 v[234:235], v31 offset:4096
  s_add_u32 m0, s40, 31744
  s_mov_b32 s3, 647168
  buffer_load_dwordx4 v21, s[12:15], s3 offen  lds
  s_waitcnt vmcnt(16) lgkmcnt(0)
  s_barrier
  ds_read_b64_tr_b16 v[68:69], v24 offset:8192
  ds_read_b64_tr_b16 v[70:71], v24 offset:12288
  s_add_u32 m0, s40, 0
  s_xor_b32 s3, s43, 0
  buffer_load_dwordx4 v22, s[24:27], s3 offen  lds
  ds_read_b64_tr_b16 v[76:77], v25 offset:8192
  ds_read_b64_tr_b16 v[78:79], v25 offset:12288
  s_add_u32 m0, s40, 1024
  s_xor_b32 s3, s43, 4096
  buffer_load_dwordx4 v22, s[24:27], s3 offen  lds
  ds_read_b64_tr_b16 v[84:85], v26 offset:8192
  ds_read_b64_tr_b16 v[86:87], v26 offset:12288
  s_add_u32 m0, s40, 2048
  s_xor_b32 s3, s43, 2048
  buffer_load_dwordx4 v22, s[24:27], s3 offen  lds
  ds_read_b64_tr_b16 v[92:93], v27 offset:8192
  ds_read_b64_tr_b16 v[94:95], v27 offset:12288
  s_add_u32 m0, s40, 3072
  s_xor_b32 s3, s43, 6144
  buffer_load_dwordx4 v22, s[24:27], s3 offen  lds
  ds_read_b64_tr_b16 v[212:213], v28 offset:8192
  ds_read_b64_tr_b16 v[214:215], v28 offset:12288
  s_add_u32 m0, s40, 4096
  s_xor_b32 s3, s43, 8192
  buffer_load_dwordx4 v22, s[24:27], s3 offen  lds
  ds_read_b64_tr_b16 v[220:221], v29 offset:8192
  ds_read_b64_tr_b16 v[222:223], v29 offset:12288
  s_add_u32 m0, s40, 5120
  s_xor_b32 s3, s43, 12288
  buffer_load_dwordx4 v22, s[24:27], s3 offen  lds
  ds_read_b64_tr_b16 v[228:229], v30 offset:8192
  ds_read_b64_tr_b16 v[230:231], v30 offset:12288
  s_add_u32 m0, s40, 6144
  s_xor_b32 s3, s43, 10240
  buffer_load_dwordx4 v22, s[24:27], s3 offen  lds
  ds_read_b64_tr_b16 v[236:237], v31 offset:8192
  ds_read_b64_tr_b16 v[238:239], v31 offset:12288
  s_add_u32 m0, s40, 7168
  s_xor_b32 s3, s43, 14336
  buffer_load_dwordx4 v22, s[24:27], s3 offen  lds
  s_waitcnt vmcnt(16) lgkmcnt(0)
  s_barrier
  v_min_u32 v10, 5, v17
  v_lshlrev_b32 v10, 2, v10
  s_lshl_b32 s3, s28, 7
  s_add_u32 s3, s3, 589824
  buffer_load_dword v11, v10, s[8:11], s3 offen sc1
  v_and_b32 v32, 31, v17
  v_lshlrev_b32 v32, 2, v32
  buffer_load_dword v33, v32, s[52:55], 0 offen sc1
  ds_read_b64_tr_b16 v[48:49], v24 offset:16384
  ds_read_b64_tr_b16 v[50:51], v24 offset:20480
  s_add_u32 m0, s40, 8192
  s_xor_b32 s3, s43, 32768
  buffer_load_dwordx4 v22, s[24:27], s3 offen  lds
  ds_read_b64_tr_b16 v[56:57], v25 offset:16384
  ds_read_b64_tr_b16 v[58:59], v25 offset:20480
  s_add_u32 m0, s40, 9216
  s_xor_b32 s3, s43, 36864
  buffer_load_dwordx4 v22, s[24:27], s3 offen  lds
  ds_read_b64_tr_b16 v[240:241], v26 offset:16384
  ds_read_b64_tr_b16 v[242:243], v26 offset:20480
  s_add_u32 m0, s40, 10240
  s_xor_b32 s3, s43, 34816
  buffer_load_dwordx4 v22, s[24:27], s3 offen  lds
  ds_read_b64_tr_b16 v[248:249], v27 offset:16384
  ds_read_b64_tr_b16 v[250:251], v27 offset:20480
  s_add_u32 m0, s40, 11264
  s_xor_b32 s3, s43, 38912
  buffer_load_dwordx4 v22, s[24:27], s3 offen  lds
  ds_read_b64_tr_b16 v[96:97], v28 offset:16384
  ds_read_b64_tr_b16 v[98:99], v28 offset:20480
  s_add_u32 m0, s40, 12288
  s_xor_b32 s3, s43, 40960
  buffer_load_dwordx4 v22, s[24:27], s3 offen  lds
  ds_read_b64_tr_b16 v[104:105], v29 offset:16384
  ds_read_b64_tr_b16 v[106:107], v29 offset:20480
  s_add_u32 m0, s40, 13312
  s_xor_b32 s3, s43, 45056
  buffer_load_dwordx4 v22, s[24:27], s3 offen  lds
  ds_read_b64_tr_b16 v[112:113], v30 offset:16384
  ds_read_b64_tr_b16 v[114:115], v30 offset:20480
  s_add_u32 m0, s40, 14336
  s_xor_b32 s3, s43, 43008
  buffer_load_dwordx4 v22, s[24:27], s3 offen  lds
  ds_read_b64_tr_b16 v[120:121], v31 offset:16384
  ds_read_b64_tr_b16 v[122:123], v31 offset:20480
  s_add_u32 m0, s40, 15360
  s_xor_b32 s3, s43, 47104
  buffer_load_dwordx4 v22, s[24:27], s3 offen  lds
  s_waitcnt vmcnt(18) lgkmcnt(0)
  s_barrier
  ds_read_b64_tr_b16 v[52:53], v24 offset:24576
  ds_read_b64_tr_b16 v[54:55], v24 offset:28672
  s_add_u32 m0, s40, 16384
  s_xor_b32 s3, s43, 65536
  buffer_load_dwordx4 v22, s[24:27], s3 offen  lds
  ds_read_b64_tr_b16 v[60:61], v25 offset:24576
  ds_read_b64_tr_b16 v[62:63], v25 offset:28672
  s_add_u32 m0, s40, 17408
  s_xor_b32 s3, s43, 69632
  buffer_load_dwordx4 v22, s[24:27], s3 offen  lds
  ds_read_b64_tr_b16 v[244:245], v26 offset:24576
  ds_read_b64_tr_b16 v[246:247], v26 offset:28672
  s_add_u32 m0, s40, 18432
  s_xor_b32 s3, s43, 67584
  buffer_load_dwordx4 v22, s[24:27], s3 offen  lds
  ds_read_b64_tr_b16 v[252:253], v27 offset:24576
  ds_read_b64_tr_b16 v[254:255], v27 offset:28672
  s_add_u32 m0, s40, 19456
  s_xor_b32 s3, s43, 71680
  buffer_load_dwordx4 v22, s[24:27], s3 offen  lds
  ds_read_b64_tr_b16 v[100:101], v28 offset:24576
  ds_read_b64_tr_b16 v[102:103], v28 offset:28672
  s_add_u32 m0, s40, 20480
  s_xor_b32 s3, s43, 73728
  buffer_load_dwordx4 v22, s[24:27], s3 offen  lds
  ds_read_b64_tr_b16 v[108:109], v29 offset:24576
  ds_read_b64_tr_b16 v[110:111], v29 offset:28672
  s_add_u32 m0, s40, 21504
  s_xor_b32 s3, s43, 77824
  buffer_load_dwordx4 v22, s[24:27], s3 offen  lds
  ds_read_b64_tr_b16 v[116:117], v30 offset:24576
  ds_read_b64_tr_b16 v[118:119], v30 offset:28672
  s_add_u32 m0, s40, 22528
  s_xor_b32 s3, s43, 75776
  buffer_load_dwordx4 v22, s[24:27], s3 offen  lds
  ds_read_b64_tr_b16 v[124:125], v31 offset:24576
  ds_read_b64_tr_b16 v[126:127], v31 offset:28672
  s_add_u32 m0, s40, 23552
  s_xor_b32 s3, s43, 79872
  buffer_load_dwordx4 v22, s[24:27], s3 offen  lds
  s_waitcnt vmcnt(18) lgkmcnt(0)
  s_barrier
  v_bfe_u32 v18, v17, 0, 1
  v_lshlrev_b32 v19, 3, v18
  v_bfe_u32 v18, v17, 1, 1
  v_lshl_add_u32 v19, v18, 4, v19
  v_bfe_u32 v18, v17, 3, 1
  v_lshl_add_u32 v19, v18, 5, v19
  v_bfe_u32 v18, v17, 2, 1
  v_lshl_add_u32 v19, v18, 8, v19
  v_bfe_u32 v18, v17, 4, 1
  v_lshl_add_u32 v19, v18, 9, v19
  v_bfe_u32 v18, v17, 5, 1
  v_lshl_add_u32 v19, v18, 10, v19
  v_bfe_u32 v18, v17, 2, 1
  v_lshlrev_b32 v16, 0, v18
  v_bfe_u32 v18, v17, 4, 1
  v_lshl_add_u32 v16, v18, 1, v16
  v_add_u32 v19, s40, v19
  v_xor_b32 v18, 0, v16
  v_lshl_add_u32 v24, v18, 6, v19
  v_xor_b32 v18, 1, v16
  v_lshl_add_u32 v25, v18, 6, v19
  v_xor_b32 v18, 2, v16
  v_lshl_add_u32 v26, v18, 6, v19
  v_xor_b32 v18, 3, v16
  v_lshl_add_u32 v27, v18, 6, v19
  ds_read_b64_tr_b16 v[128:129], v24 offset:0
  ds_read_b64_tr_b16 v[130:131], v24 offset:2048
  s_add_u32 m0, s40, 24576
  s_xor_b32 s3, s43, 98304
  buffer_load_dwordx4 v22, s[24:27], s3 offen  lds
  ds_read_b64_tr_b16 v[132:133], v24 offset:4096
  ds_read_b64_tr_b16 v[134:135], v24 offset:6144
  s_add_u32 m0, s40, 25600
  s_xor_b32 s3, s43, 102400
  buffer_load_dwordx4 v22, s[24:27], s3 offen  lds
  ds_read_b64_tr_b16 v[136:137], v25 offset:0
  ds_read_b64_tr_b16 v[138:139], v25 offset:2048
  s_add_u32 m0, s40, 26624
  s_xor_b32 s3, s43, 100352
  buffer_load_dwordx4 v22, s[24:27], s3 offen  lds
  ds_read_b64_tr_b16 v[140:141], v25 offset:4096
  ds_read_b64_tr_b16 v[142:143], v25 offset:6144
  s_add_u32 m0, s40, 27648
  s_xor_b32 s3, s43, 104448
  buffer_load_dwordx4 v22, s[24:27], s3 offen  lds
  ds_read_b64_tr_b16 v[144:145], v26 offset:0
  ds_read_b64_tr_b16 v[146:147], v26 offset:2048
  s_add_u32 m0, s40, 28672
  s_xor_b32 s3, s43, 106496
  buffer_load_dwordx4 v22, s[24:27], s3 offen  lds
  ds_read_b64_tr_b16 v[148:149], v26 offset:4096
  ds_read_b64_tr_b16 v[150:151], v26 offset:6144
  s_add_u32 m0, s40, 29696
  s_xor_b32 s3, s43, 110592
  buffer_load_dwordx4 v22, s[24:27], s3 offen  lds
  ds_read_b64_tr_b16 v[152:153], v27 offset:0
  ds_read_b64_tr_b16 v[154:155], v27 offset:2048
  s_add_u32 m0, s40, 30720
  s_xor_b32 s3, s43, 108544
  buffer_load_dwordx4 v22, s[24:27], s3 offen  lds
  ds_read_b64_tr_b16 v[156:157], v27 offset:4096
  ds_read_b64_tr_b16 v[158:159], v27 offset:6144
  s_add_u32 m0, s40, 31744
  s_xor_b32 s3, s43, 112640
  buffer_load_dwordx4 v22, s[24:27], s3 offen  lds
  s_waitcnt lgkmcnt(0)
  ds_write_b128 v8, v[48:51] offset:0
  ds_write_b128 v8, v[52:55] offset:1024
  ds_write_b128 v8, v[56:59] offset:2048
  ds_write_b128 v8, v[60:63] offset:3072
  ds_write_b128 v8, v[64:67] offset:4096
  ds_write_b128 v8, v[68:71] offset:5120
  ds_write_b128 v8, v[72:75] offset:6144
  ds_write_b128 v8, v[76:79] offset:7168
  s_waitcnt vmcnt(16) lgkmcnt(0)
  ds_read_b64_tr_b16 v[160:161], v24 offset:8192
  ds_read_b64_tr_b16 v[162:163], v24 offset:10240
  ds_read_b64_tr_b16 v[164:165], v24 offset:12288
  ds_read_b64_tr_b16 v[166:167], v24 offset:14336
  ds_read_b64_tr_b16 v[168:169], v25 offset:8192
  ds_read_b64_tr_b16 v[170:171], v25 offset:10240
  ds_read_b64_tr_b16 v[172:173], v25 offset:12288
  ds_read_b64_tr_b16 v[174:175], v25 offset:14336
  s_waitcnt lgkmcnt(4)
  ds_read_b64_tr_b16 v[176:177], v26 offset:8192
  ds_read_b64_tr_b16 v[178:179], v26 offset:10240
  ds_read_b64_tr_b16 v[180:181], v26 offset:12288
  ds_read_b64_tr_b16 v[182:183], v26 offset:14336
  ds_read_b64_tr_b16 v[184:185], v27 offset:8192
  ds_read_b64_tr_b16 v[186:187], v27 offset:10240
  ds_read_b64_tr_b16 v[188:189], v27 offset:12288
  ds_read_b64_tr_b16 v[190:191], v27 offset:14336
  v_lshrrev_b32 v19, 4, v5
  v_min_u32 v19, 71, v19
  v_cmp_lt_u32 vcc, 63, v19
  s_lshl_b32 s3, s28, 13
  s_add_u32 s3, s3, 0
  s_lshl_b32 s6, s28, 10
  s_add_u32 s6, s6, 516096
  v_lshl_add_u32 v18, v19, 7, s3
  v_lshl_add_u32 v19, v19, 7, s6
  v_cndmask_b32 v19, v18, v19, vcc
  buffer_load_dword v35, v19, s[8:11], 0 offen sc1
  s_waitcnt lgkmcnt(0)
  ds_write_b128 v8, v[80:83] offset:8192
  ds_write_b128 v8, v[84:87] offset:9216
  ds_write_b128 v8, v[88:91] offset:10240
  ds_write_b128 v8, v[92:95] offset:11264
  ds_write_b128 v8, v[96:99] offset:12288
  ds_write_b128 v8, v[100:103] offset:13312
  ds_write_b128 v8, v[104:107] offset:14336
  ds_write_b128 v8, v[108:111] offset:15360
  s_mov_b32 s42, 3
  s_waitcnt vmcnt(25)
  v_cmp_eq_u32 vcc, 0, v33
  s_cbranch_vccz T_join_3y
T_join_3:
  buffer_load_dword v33, v32, s[52:55], 0 offen sc1
  s_add_u32 s44, s44, 1
  s_cmp_gt_u32 s44, 400000
  s_waitcnt vmcnt(0)
  s_cbranch_scc1 T_join_3x
  v_cmp_eq_u32 vcc, 0, v33
  s_cbranch_vccnz T_join_3
T_join_3x:
T_join_3y:
  v_bfe_u32 v10, v2, 4, 6
  v_min_u32 v10, 5, v10
  v_lshlrev_b32 v10, 2, v10
  s_lshl_b32 s7, s28, 7
  s_add_u32 s7, s7, 589824
  s_branch T_prog_4h
T_prog_4:
  buffer_load_dword v11, v10, s[8:11], s7 offen sc1
  s_waitcnt vmcnt(0)
T_prog_4h:
  s_add_u32 s44, s44, 1
  s_mov_b32 s36, 64
  s_cmp_gt_u32 s44, 400000
  s_cbranch_scc1 T_prog_4x
  v_mul_u32_u24 v11, 24, v11
  v_add_u32 v11, v11, v10
  v_lshrrev_b32 v11, 2, v11
  s_nop 0
  v_readlane_b32 s3, v11, 0
  s_nop 0
  s_min_u32 s36, s36, s3
  v_readlane_b32 s3, v11, 1
  s_nop 0
  s_min_u32 s36, s36, s3
  v_readlane_b32 s3, v11, 2
  s_nop 0
  s_min_u32 s36, s36, s3
  v_readlane_b32 s3, v11, 3
  s_nop 0
  s_min_u32 s36, s36, s3
  v_readlane_b32 s3, v11, 4
  s_nop 0
  s_min_u32 s36, s36, s3
  v_readlane_b32 s3, v11, 5
  s_nop 0
  s_min_u32 s36, s36, s3
  s_cmp_lt_u32 s36, s42
  s_cbranch_scc1 T_prog_4
T_prog_4x:
  s_lshl_b32 s3, s29, 11
  s_add_u32 m0, s3, 8192
  v_lshlrev_b32 v19, 2, v5
  v_and_b32 v19, 4294967168, v19
  s_getreg_b32 s3, hwreg(HW_REG_XCC_ID, 0, 4)
  buffer_load_dwordx4 v2, s[8:11], s38 offen sc1 lds
  buffer_load_dwordx4 v2, s[8:11], s38 offen offset:1024 sc1 lds
  buffer_load_dword v35, v19, s[8:11], s37 offen sc1
  s_add_u32 s38, s38, 16384
  s_add_u32 s3, s3, 1
  v_cmp_ne_u32 s[94:95], s3, v33
  s_waitcnt vmcnt(12) lgkmcnt(0)
  ds_read_b64_tr_b16 v[192:193], v24 offset:16384
  ds_read_b64_tr_b16 v[194:195], v24 offset:18432
  ds_read_b64_tr_b16 v[196:197], v24 offset:20480
  ds_read_b64_tr_b16 v[198:199], v24 offset:22528
  ds_read_b64_tr_b16 v[200:201], v25 offset:16384
  ds_read_b64_tr_b16 v[202:203], v25 offset:18432
  ds_read_b64_tr_b16 v[204:205], v25 offset:20480
  ds_read_b64_tr_b16 v[206:207], v25 offset:22528
  s_waitcnt lgkmcnt(4)
  ds_read_b64_tr_b16 v[48:49], v26 offset:16384
  ds_read_b64_tr_b16 v[50:51], v26 offset:18432
  ds_read_b64_tr_b16 v[52:53], v26 offset:20480
  ds_read_b64_tr_b16 v[54:55], v26 offset:22528
  ds_read_b64_tr_b16 v[56:57], v27 offset:16384
  ds_read_b64_tr_b16 v[58:59], v27 offset:18432
  ds_read_b64_tr_b16 v[60:61], v27 offset:20480
  ds_read_b64_tr_b16 v[62:63], v27 offset:22528
  s_waitcnt lgkmcnt(0)
  ds_write_b128 v8, v[112:115] offset:16384
  ds_write_b128 v8, v[116:119] offset:17408
  ds_write_b128 v8, v[120:123] offset:18432
  ds_write_b128 v8, v[124:127] offset:19456
  ds_write_b128 v8, v[48:51] offset:20480
  ds_write_b128 v8, v[52:55] offset:21504
  ds_write_b128 v8, v[56:59] offset:22528
  ds_write_b128 v8, v[60:63] offset:23552
  s_add_u32 s12, s8, s37
  s_addc_u32 s13, s9, 0
  s_mov_b32 s14, 8192
  s_mov_b32 s15, 0x20000
  s_add_u32 s16, s8, s38
  s_addc_u32 s17, s9, 0
  s_mov_b32 s18, 8192
  s_mov_b32 s19, 0x20000
  s_add_u32 s20, s8, s39
  s_addc_u32 s21, s9, 0
  s_mov_b32 s22, 8192
  s_mov_b32 s23, 0x20000
  s_add_u32 s24, s8, s31
  s_addc_u32 s25, s9, 0
  s_mov_b32 s26, 8192
  s_mov_b32 s27, 0x20000
  s_lshl_b32 s40, s29, 11
  s_add_u32 s40, s40, 16384
  s_mov_b32 s6, 0x05040100
  s_mov_b32 s7, 0x07060302
  v_bfe_u32 v10, v17, 4, 1
  v_mul_u32_u24 v10, 0x0202, v10
  v_lshl_or_b32 v10, v10, 16, v10
  v_or_b32 v10, s6, v10
  v_perm_b32 v16, v40, v36, v10
  v_min_u32 v16, -2, v16
  v_perm_b32 v17, v41, v37, v10
  v_min_u32 v17, -2, v17
  v_perm_b32 v18, v42, v38, v10
  v_min_u32 v18, -2, v18
  v_perm_b32 v19, v43, v39, v10
  v_min_u32 v19, -2, v19
  v_perm_b32 v20, v12, v44, v10
  v_min_u32 v20, -2, v20
  v_perm_b32 v21, v13, v45, v10
  v_min_u32 v21, -2, v21
  v_perm_b32 v22, v14, v46, v10
  v_min_u32 v22, -2, v22
  v_perm_b32 v23, v15, v47, v10
  v_min_u32 v23, -2, v23
  s_waitcnt vmcnt(4) lgkmcnt(0)
  ds_read_b64_tr_b16 v[64:65], v24 offset:24576
  ds_read_b64_tr_b16 v[66:67], v24 offset:26624
  ds_read_b64_tr_b16 v[68:69], v24 offset:28672
  ds_read_b64_tr_b16 v[70:71], v24 offset:30720
  ds_read_b64_tr_b16 v[72:73], v25 offset:24576
  ds_read_b64_tr_b16 v[74:75], v25 offset:26624
  ds_read_b64_tr_b16 v[76:77], v25 offset:28672
  ds_read_b64_tr_b16 v[78:79], v25 offset:30720
  s_waitcnt lgkmcnt(4)
  ds_read_b64_tr_b16 v[80:81], v26 offset:24576
  ds_read_b64_tr_b16 v[82:83], v26 offset:26624
  ds_read_b64_tr_b16 v[84:85], v26 offset:28672
  ds_read_b64_tr_b16 v[86:87], v26 offset:30720
  ds_read_b64_tr_b16 v[88:89], v27 offset:24576
  ds_read_b64_tr_b16 v[90:91], v27 offset:26624
  ds_read_b64_tr_b16 v[92:93], v27 offset:28672
  ds_read_b64_tr_b16 v[94:95], v27 offset:30720
  s_waitcnt lgkmcnt(0)
  ds_write_b128 v8, v[64:67] offset:24576
  ds_write_b128 v8, v[68:71] offset:25600
  ds_write_b128 v8, v[72:75] offset:26624
  ds_write_b128 v8, v[76:79] offset:27648
  ds_write_b128 v8, v[80:83] offset:28672
  ds_write_b128 v8, v[84:87] offset:29696
  ds_write_b128 v8, v[88:91] offset:30720
  ds_write_b128 v8, v[92:95] offset:31744
  s_cmp_lg_u32 s94, 0
  s_cbranch_scc1 L_slow
  v_lshrrev_b32 v11, 2, v5
  ds_read_b32 v11, v11 offset:30720
  v_mov_b64 v[48:49], 0
  v_mov_b64 v[50:51], 0
  v_mov_b64 v[52:53], 0
  v_mov_b64 v[54:55], 0
  v_mov_b64 v[56:57], 0
  v_mov_b64 v[58:59], 0
  v_mov_b64 v[60:61], 0
  v_mov_b64 v[62:63], 0
  v_mov_b64 v[64:65], 0
  v_mov_b64 v[66:67], 0
  v_mov_b64 v[68:69], 0
  v_mov_b64 v[70:71], 0
  v_xor_b32 v28, 2048, v2
  v_xor_b32 v36, 4096, v2
  v_xor_b32 v44, 6144, v2
  s_waitcnt lgkmcnt(0)
  s_mov_b32 exec_hi, 0
  v_add_u32 v11, s38, v11
  s_mov_b32 exec_hi, -1
  ds_read_b128 v[72:75], v8 offset:4096
  ds_read_b128 v[76:79], v8 offset:5120
  ds_read_b128 v[80:83], v8 offset:6144
  ds_read_b128 v[84:87], v8 offset:7168
  ds_read_b128 v[88:91], v8 offset:0
  ds_read_b128 v[92:95], v8 offset:1024
  ds_read_b128 v[96:99], v8 offset:2048
  ds_read_b128 v[100:103], v8 offset:3072
  ds_read_b128 v[104:107], v8 offset:8192
  ds_read_b128 v[108:111], v8 offset:9216
  ds_read_b128 v[112:115], v8 offset:10240
  ds_read_b128 v[116:119], v8 offset:11264
  s_waitcnt lgkmcnt(0) vmcnt(0)
F_loop:
  s_waitcnt vmcnt(3)
  v_max3_u32 v10, v16, v17, v18
  v_max_u32 v10, v10, v19
  v_cmp_eq_u32 vcc, -1, v10
  ds_write_b128 v2, v[16:19] offset:0
  s_cbranch_vccnz F_rE
F_gE:
  v_smfmac_f32_16x16x64_bf16 v[48:51], v[16:19], v[72:79], v1
  v_smfmac_f32_16x16x64_bf16 v[52:55], v[16:19], a[0:7], v1
  s_waitcnt vmcnt(2)
  v_max3_u32 v10, v20, v21, v22
  v_max_u32 v10, v10, v23
  v_cmp_eq_u32 vcc, -1, v10
  ds_write_b128 v2, v[20:23] offset:1024
  s_cbranch_vccnz F_rL
F_gL:
  v_smfmac_f32_16x16x64_bf16 v[56:59], v[16:19], v[80:87], v1
  buffer_load_dwordx4 v[120:123], v2, s[12:15], 0 offen sc1 nt
  v_smfmac_f32_16x16x64_bf16 v[60:63], v[16:19], a[8:15], v1
  buffer_load_dwordx4 v[124:127], v2, s[12:15], 0 offen offset:1024 sc1 nt
  s_mov_b32 m0, s40
  v_smfmac_f32_16x16x64_bf16 v[48:51], v[20:23], v[88:95], v1
  buffer_load_dwordx4 v2, s[16:19], 0 offen sc1 nt lds
  s_mov_b32 m0, s50
  v_smfmac_f32_16x16x64_bf16 v[52:55], v[20:23], a[32:39], v1
  s_waitcnt lgkmcnt(0)
  s_barrier
  ds_read_b128 v[24:27], v28
  v_smfmac_f32_16x16x64_bf16 v[56:59], v[20:23], v[96:103], v1
  buffer_load_dword v11, s[8:11], 0 offen sc1 lds
  s_mov_b32 m0, s40
  ds_read_b128 v[28:31], v28 offset:1024
  v_smfmac_f32_16x16x64_bf16 v[60:63], v[20:23], a[40:47], v1
  ds_read_b128 v[32:35], v36
  v_smfmac_f32_16x16x64_bf16 v[64:67], v[16:19], a[128:135], v1
  ds_read_b128 v[36:39], v36 offset:1024
  v_smfmac_f32_16x16x64_bf16 v[68:71], v[16:19], a[136:143], v1
  ds_read_b128 v[40:43], v44
  v_smfmac_f32_16x16x64_bf16 v[64:67], v[20:23], a[160:167], v1
  ds_read_b128 v[44:47], v44 offset:1024
  v_smfmac_f32_16x16x64_bf16 v[68:71], v[20:23], a[168:175], v1
  buffer_load_dwordx4 v2, s[16:19], 0 offen offset:1024 sc1 nt lds
  s_waitcnt lgkmcnt(5)
F_qk:
  v_smfmac_f32_16x16x64_bf16 v[48:51], v[24:27], v[104:111], v1
  ds_read_b128 v[72:75], v8 offset:12288
  v_smfmac_f32_16x16x64_bf16 v[52:55], v[24:27], a[16:23], v1
  ds_read_b128 v[76:79], v8 offset:13312
  v_smfmac_f32_16x16x64_bf16 v[56:59], v[24:27], v[112:119], v1
  buffer_store_dwordx4 v[12:15], v5, s[20:23], 0 offen sc1
  v_smfmac_f32_16x16x64_bf16 v[60:63], v[24:27], a[24:31], v1
  ds_read_b128 v[88:91], v8 offset:16384
  s_waitcnt lgkmcnt(7)
  v_smfmac_f32_16x16x64_bf16 v[48:51], v[28:31], v[240:247], v1
  ds_read_b128 v[92:95], v8 offset:17408
  v_smfmac_f32_16x16x64_bf16 v[52:55], v[28:31], a[48:55], v1
  ds_read_b128 v[80:83], v8 offset:14336
  v_smfmac_f32_16x16x64_bf16 v[56:59], v[28:31], v[248:255], v1
  ds_read_b128 v[84:87], v8 offset:15360
  v_smfmac_f32_16x16x64_bf16 v[60:63], v[28:31], a[56:63], v1
  ds_read_b128 v[96:99], v8 offset:18432
  s_waitcnt lgkmcnt(7)
  v_smfmac_f32_16x16x64_bf16 v[48:51], v[32:35], v[208:215], v1
  ds_read_b128 v[100:103], v8 offset:19456
  v_smfmac_f32_16x16x64_bf16 v[48:51], v[40:43], v[224:231], v1
  ds_read_b128 v[104:107], v9 offset:0
  s_waitcnt lgkmcnt(5)
  v_smfmac_f32_16x16x64_bf16 v[48:51], v[36:39], v[72:79], v1
  ds_read_b128 v[108:111], v9 offset:1024
  v_smfmac_f32_16x16x64_bf16 v[48:51], v[44:47], v[88:95], v1
  ds_read_b128 v[112:115], v9 offset:2048
  v_smfmac_f32_16x16x64_bf16 v[52:55], v[32:35], a[64:71], v1
  ds_read_b128 v[116:119], v9 offset:3072
  v_smfmac_f32_16x16x64_bf16 v[52:55], v[40:43], a[80:87], v1
  ds_read_b128 v[72:75], v9 offset:4096
  v_mul_f32_e64 v48, s41, v48
  v_smfmac_f32_16x16x64_bf16 v[52:55], v[36:39], a[96:103], v1
  ds_read_b128 v[76:79], v9 offset:5120
  v_mul_f32_e64 v49, s41, v49
  v_smfmac_f32_16x16x64_bf16 v[52:55], v[44:47], a[112:119], v1
  ds_read_b128 v[88:91], v9 offset:6144
  v_fmac_f32_e64 v48, s41, v50
  v_smfmac_f32_16x16x64_bf16 v[56:59], v[32:35], v[216:223], v1
  ds_read_b128 v[92:95], v9 offset:7168
  v_fmac_f32_e64 v49, s41, v51
  v_smfmac_f32_16x16x64_bf16 v[56:59], v[40:43], v[232:239], v1
  s_waitcnt lgkmcnt(8)
  v_cvt_pk_bf16_f32 v51, v48, v49
  v_smfmac_f32_16x16x64_bf16 v[56:59], v[36:39], v[80:87], v1
  v_add_f32 v52, v52, v54
  v_smfmac_f32_16x16x64_bf16 v[56:59], v[44:47], v[96:103], v1
  v_add_f32_e64 v53, v53, v55
  v_smfmac_f32_16x16x64_bf16 v[60:63], v[32:35], a[72:79], v1
  v_cvt_pk_bf16_f32 v50, v52, v53
  v_smfmac_f32_16x16x64_bf16 v[60:63], v[40:43], a[88:95], v1
  ds_write_b64 v3, v[50:51]
  v_mul_f32_e64 v56, s41, v56
  v_smfmac_f32_16x16x64_bf16 v[60:63], v[36:39], a[104:111], v1
  v_mul_f32_e64 v57, s41, v57
  v_smfmac_f32_16x16x64_bf16 v[60:63], v[44:47], a[120:127], v1
  v_fmac_f32_e64 v56, s41, v58
  v_smfmac_f32_16x16x64_bf16 v[64:67], v[24:27], a[144:151], v1
  v_fmac_f32_e64 v57, s41, v59
  v_cvt_pk_bf16_f32 v59, v56, v57
  v_smfmac_f32_16x16x64_bf16 v[68:71], v[24:27], a[152:159], v1
  v_add_f32 v60, v60, v62
  v_add_f32 v61, v61, v63
  v_smfmac_f32_16x16x64_bf16 v[64:67], v[28:31], a[176:183], v1
  v_cvt_pk_bf16_f32 v58, v60, v61
  v_smfmac_f32_16x16x64_bf16 v[68:71], v[28:31], a[184:191], v1
  ds_write_b64 v3, v[58:59] offset:512
  v_smfmac_f32_16x16x64_bf16 v[64:67], v[32:35], a[192:199], v1
  v_cvt_pk_bf16_f32 v13, v60, v61
  v_smfmac_f32_16x16x64_bf16 v[68:71], v[32:35], a[200:207], v1
  v_mov_b64_e64 v[24:25], s[46:47]
  v_smfmac_f32_16x16x64_bf16 v[64:67], v[36:39], a[224:231], v1
  v_mov_b64_e64 v[26:27], s[46:47]
  v_smfmac_f32_16x16x64_bf16 v[68:71], v[36:39], a[232:239], v1
  s_waitcnt lgkmcnt(0) vmcnt(6)
  s_barrier
  ds_read_b64_tr_b16 v[80:81], v4 offset:0
  v_smfmac_f32_16x16x64_bf16 v[64:67], v[40:43], a[208:215], v1
  ds_read_b64_tr_b16 v[82:83], v4 offset:512
  ds_read_b64_tr_b16 v[84:85], v4 offset:1024
  v_smfmac_f32_16x16x64_bf16 v[68:71], v[40:43], a[216:223], v1
  ds_read_b64_tr_b16 v[86:87], v4 offset:1536
  ds_read_b64_tr_b16 v[96:97], v4 offset:2048
  v_smfmac_f32_16x16x64_bf16 v[64:67], v[44:47], a[240:247], v1
  ds_read_b64_tr_b16 v[98:99], v4 offset:2560
  ds_read_b64_tr_b16 v[100:101], v4 offset:3072
  v_smfmac_f32_16x16x64_bf16 v[68:71], v[44:47], a[248:255], v1
  ds_read_b64_tr_b16 v[102:103], v4 offset:3584
  v_cvt_pk_bf16_f32 v12, v52, v53
  s_waitcnt lgkmcnt(6)
  v_mfma_f32_16x16x32_bf16 v[56:59], v[80:83], v[80:83], 0
  s_waitcnt lgkmcnt(4)
  v_mov_b32 v29, 0
  v_mov_b32 v30, 0
  v_mfma_f32_16x16x32_bf16 v[56:59], v[84:87], v[84:87], v[56:59]
  s_waitcnt lgkmcnt(2)
  v_add_f32 v64, v64, v66
  v_add_f32_e64 v65, v65, v67
  v_mfma_f32_16x16x32_bf16 v[56:59], v[96:99], v[96:99], v[56:59]
  s_waitcnt lgkmcnt(0)
  v_cvt_pk_bf16_f32 v14, v64, v65
  v_add_f32 v68, v68, v70
  v_mfma_f32_16x16x32_bf16 v[56:59], v[100:103], v[100:103], v[56:59]
  v_add_f32_e64 v69, v69, v71
  v_cvt_pk_bf16_f32 v15, v68, v69
  v_mfma_f32_16x16x32_bf16 v[48:51], v[104:107], v[80:83], 0
  v_mov_b64 v[60:61], 0
  v_mov_b64 v[62:63], 0
  v_mfma_f32_16x16x32_bf16 v[48:51], v[108:111], v[84:87], v[48:51]
  v_exp_f32_e64 v56, v56
  v_mfma_f32_16x16x32_bf16 v[48:51], v[112:115], v[96:99], v[48:51]
  v_exp_f32_e64 v57, v57
  v_mfma_f32_16x16x32_bf16 v[48:51], v[116:119], v[100:103], v[48:51]
  v_cvt_pk_bf16_f32 v28, v56, v57
  v_cvt_pk_bf16_f32 v31, v56, v57
  v_mfma_f32_16x16x32_bf16 v[52:55], v[72:75], v[80:83], 0
  v_mov_b64 v[56:57], 0
  v_mov_b64 v[58:59], 0
  v_mfma_f32_16x16x32_bf16 v[52:55], v[76:79], v[84:87], v[52:55]
  v_exp_f32_e64 v48, v48
  v_mfma_f32_16x16x32_bf16 v[52:55], v[88:91], v[96:99], v[52:55]
  v_exp_f32_e64 v49, v49
  v_mfma_f32_16x16x32_bf16 v[52:55], v[92:95], v[100:103], v[52:55]
  v_exp_f32_e64 v50, v50
  v_mfma_f32_16x16x16_bf16 v[36:39], v[24:25], v[28:29], 0
  v_exp_f32_e64 v51, v51
  v_mfma_f32_16x16x16_bf16 v[40:43], v[14:15], v[28:29], 0
  v_cvt_pk_bf16_f32 v32, v48, v49
  v_cvt_pk_bf16_f32 v33, v50, v51
  v_mfma_f32_16x16x16_bf16 v[44:47], v[14:15], v[30:31], 0
  s_waitcnt vmcnt(4)
  v_exp_f32 v52, v52
  v_exp_f32 v53, v53
  v_exp_f32 v54, v54
  v_exp_f32_e64 v55, v55
  v_cvt_pk_bf16_f32 v34, v52, v53
  v_cvt_pk_bf16_f32 v35, v54, v55
  v_mov_b64 v[48:49], 0
  v_mov_b64 v[50:51], 0
  v_mfma_f32_16x16x32_bf16 v[36:39], v[24:27], v[32:35], v[36:39]
  v_mov_b64 v[52:53], 0
  v_mov_b64 v[54:55], 0
  v_mfma_f32_16x16x32_bf16 v[40:43], v[120:123], v[32:35], v[40:43]
  v_xor_b32 v24, 1024, v5
  v_xor_b32 v28, 2048, v5
  v_mfma_f32_16x16x32_bf16 v[44:47], v[124:127], v[32:35], v[44:47]
  v_rcp_f32_dpp v10, v36 quad_perm:[2,3,2,3] row_mask:0xf bank_mask:0xf
  v_xor_b32 v32, 3072, v5
  v_max_f32_dpp v11, v36, v10 quad_perm:[2,3,2,3] row_mask:0xf bank_mask:0xf
  v_cmp_nge_f32_e64 vcc, s56, v11
  v_mul_f32_dpp v40, v40, v10 quad_perm:[2,3,2,3] row_mask:0xf bank_mask:0xf
  v_mul_f32_dpp v41, v41, v10 quad_perm:[2,3,2,3] row_mask:0xf bank_mask:0xf
  v_mul_f32_dpp v42, v42, v10 quad_perm:[2,3,2,3] row_mask:0xf bank_mask:0xf
  v_mul_f32_dpp v43, v43, v10 quad_perm:[2,3,2,3] row_mask:0xf bank_mask:0xf
  v_mul_f32_dpp v44, v44, v10 quad_perm:[2,3,2,3] row_mask:0xf bank_mask:0xf
  v_mul_f32_dpp v45, v45, v10 quad_perm:[2,3,2,3] row_mask:0xf bank_mask:0xf
  v_mul_f32_dpp v46, v46, v10 quad_perm:[2,3,2,3] row_mask:0xf bank_mask:0xf
  v_mul_f32_dpp v47, v47, v10 quad_perm:[2,3,2,3] row_mask:0xf bank_mask:0xf
  v_cvt_pk_bf16_f32 v64, v40, v41
  v_cvt_pk_bf16_f32 v65, v42, v43
  v_cvt_pk_bf16_f32 v66, v44, v45
  v_cvt_pk_bf16_f32 v67, v46, v47
  s_cbranch_vccnz F_redo
F_ow:
  ds_write_b128 v5, v[64:67]
  v_smfmac_f32_16x16x64_bf16 v[48:51], v[64:67], v[128:135], v1
  ds_read_b128 v[104:107], v8 offset:24576
  v_smfmac_f32_16x16x64_bf16 v[52:55], v[64:67], v[136:143], v1
  ds_read_b128 v[108:111], v8 offset:25600
  s_waitcnt lgkmcnt(2)
  s_barrier
  ds_read_b128 v[24:27], v24
  ds_read_b128 v[28:31], v28
  ds_read_b128 v[32:35], v32
  v_smfmac_f32_16x16x64_bf16 v[56:59], v[64:67], v[144:151], v1
  ds_read_b128 v[112:115], v8 offset:26624
  v_smfmac_f32_16x16x64_bf16 v[60:63], v[64:67], v[152:159], v1
  ds_read_b128 v[116:119], v8 offset:27648
  s_waitcnt lgkmcnt(4)
  v_smfmac_f32_16x16x64_bf16 v[48:51], v[24:27], v[160:167], v1
  ds_read_b128 v[72:75], v8 offset:20480
  s_waitcnt lgkmcnt(4)
  v_smfmac_f32_16x16x64_bf16 v[48:51], v[28:31], v[192:199], v1
  ds_read_b128 v[76:79], v8 offset:21504
  s_waitcnt lgkmcnt(4)
  v_smfmac_f32_16x16x64_bf16 v[48:51], v[32:35], v[104:111], v1
  ds_read_b128 v[88:91], v8 offset:28672
  v_smfmac_f32_16x16x64_bf16 v[52:55], v[24:27], v[168:175], v1
  ds_read_b128 v[92:95], v8 offset:29696
  v_smfmac_f32_16x16x64_bf16 v[52:55], v[28:31], v[200:207], v1
  ds_read_b128 v[80:83], v8 offset:22528
  s_waitcnt lgkmcnt(5)
  v_cvt_pk_bf16_f32 v16, v48, v49
  v_and_or_b32 v16, v16, -2, s34
  v_cvt_pk_bf16_f32 v17, v50, v51
  v_smfmac_f32_16x16x64_bf16 v[52:55], v[32:35], v[112:119], v1
  buffer_store_dwordx2 v[16:17], v6, s[8:11], 0 offen offset:0
  ds_read_b128 v[84:87], v8 offset:23552
  v_smfmac_f32_16x16x64_bf16 v[56:59], v[24:27], v[176:183], v1
  ds_read_b128 v[96:99], v8 offset:30720
  s_waitcnt lgkmcnt(5)
  v_smfmac_f32_16x16x64_bf16 v[56:59], v[28:31], v[72:79], v1
  ds_read_b128 v[100:103], v8 offset:31744
  s_waitcnt lgkmcnt(4)
  v_cvt_pk_bf16_f32 v18, v52, v53
  v_and_or_b32 v18, v18, -2, s34
  v_cvt_pk_bf16_f32 v19, v54, v55
  v_smfmac_f32_16x16x64_bf16 v[56:59], v[32:35], v[88:95], v1
  buffer_store_dwordx2 v[18:19], v6, s[8:11], 0 offen offset:64
  v_smfmac_f32_16x16x64_bf16 v[60:63], v[24:27], v[184:191], v1
  s_waitcnt lgkmcnt(2)
  v_smfmac_f32_16x16x64_bf16 v[60:63], v[28:31], v[80:87], v1
  s_waitcnt lgkmcnt(0)
  v_cvt_pk_bf16_f32 v20, v56, v57
  v_and_or_b32 v20, v20, -2, s34
  v_cvt_pk_bf16_f32 v21, v58, v59
  v_smfmac_f32_16x16x64_bf16 v[60:63], v[32:35], v[96:103], v1
  buffer_store_dwordx2 v[20:21], v6, s[8:11], s35 offen offset:0
  v_mov_b64 v[48:49], 0
  v_mov_b64 v[50:51], 0
  v_mov_b64 v[52:53], 0
  v_mov_b64 v[54:55], 0
  v_mov_b64 v[56:57], 0
  s_nop 1
  v_cvt_pk_bf16_f32 v22, v60, v61
  v_and_or_b32 v22, v22, -2, s34
  v_cvt_pk_bf16_f32 v23, v62, v63
  buffer_store_dwordx2 v[22:23], v6, s[8:11], s35 offen offset:64
  v_lshrrev_b32 v11, 2, v5
  v_and_b32 v10, 0x3ff, v5
  v_mov_b64 v[120:121], -1
  v_mov_b64 v[58:59], 0
  v_mov_b64 v[60:61], 0
  v_mov_b64 v[62:63], 0
  v_mov_b64 v[64:65], 0
  v_mov_b64 v[66:67], 0
  v_mov_b64 v[68:69], 0
  v_mov_b64 v[70:71], 0
  v_xor_b32 v28, 2048, v2
  v_xor_b32 v36, 4096, v2
  v_xor_b32 v44, 6144, v2
  v_xor_b32 v9, 24576, v9
  ds_read_b32 v11, v11 offset:30720
  ds_read_b128 v[40:43], v10 offset:29696
  s_add_u32 s30, s30, 1
  s_add_u32 s37, s37, 16384
  s_add_u32 s38, s38, 16384
  s_add_u32 s39, s39, 4096
  s_xor_b32 s40, s40, 24576
  s_add_u32 s31, s31, 8192
  s_andn2_b32 s31, s31, 0x8000
  s_add_u32 s12, s8, s37
  s_addc_u32 s13, s9, 0
  s_add_u32 s16, s8, s38
  s_addc_u32 s17, s9, 0
  s_add_u32 s20, s8, s39
  s_addc_u32 s21, s9, 0
  s_add_u32 s24, s8, s31
  s_addc_u32 s25, s9, 0
  s_waitcnt lgkmcnt(0)
  s_mov_b32 exec_hi, 0
  v_add_u32 v11, s38, v11
  s_mov_b32 exec_hi, -1
  ds_read_b128 v[72:75], v8 offset:4096
  ds_read_b128 v[76:79], v8 offset:5120
  ds_read_b128 v[80:83], v8 offset:6144
  ds_read_b128 v[84:87], v8 offset:7168
  ds_read_b128 v[88:91], v8 offset:0
  ds_read_b128 v[92:95], v8 offset:1024
  ds_read_b128 v[96:99], v8 offset:2048
  ds_read_b128 v[100:103], v8 offset:3072
  s_cmp_eq_u32 s29, 1
  s_cbranch_scc1 F_w1
  s_cmp_ge_u32 s29, 2
  s_cbranch_scc1 F_w2
F_w0:
  s_barrier
  buffer_load_dwordx4 v[16:19], v0, s[8:11], 0 offen offset:0 sc1
  buffer_load_dwordx4 v[20:23], v0, s[8:11], 0 offen offset:1024 sc1
  buffer_load_dwordx4 v[24:27], v0, s[8:11], 0 offen offset:2048 sc1
  buffer_load_dwordx4 v[32:35], v0, s[8:11], 0 offen offset:3072 sc1
  ds_read_b128 v[104:107], v8 offset:8192
  ds_read_b128 v[108:111], v8 offset:9216
  ds_read_b128 v[112:115], v8 offset:10240
  ds_read_b128 v[116:119], v8 offset:11264
  s_add_u32 s42, s30, 3
  s_min_u32 s42, s42, 64
  s_cmp_lt_u32 s36, s42
  s_cbranch_scc1 F_peek0
F_peekd0:
F_h1_00:
  s_waitcnt vmcnt(3)
  v_mfma_f32_16x16x32_bf16 v[124:127], v[40:43], v[16:19], 0
  v_bitop3_b32 v10, v16, v18, s34 bitop3:0x7e
  s_waitcnt vmcnt(2)
  v_mfma_f32_16x16x32_bf16 v[124:127], v[40:43], v[20:23], v[124:127]
  v_bitop3_b32 v123, v20, v22, s34 bitop3:0x7e
  s_waitcnt vmcnt(1)
  v_mfma_f32_16x16x32_bf16 v[124:127], v[40:43], v[24:27], v[124:127]
  v_bitop3_b32 v122, v24, v26, s34 bitop3:0x7e
  v_or3_b32 v10, v10, v123, v122
  s_waitcnt vmcnt(0)
  v_mfma_f32_16x16x32_bf16 v[124:127], v[40:43], v[32:35], v[124:127]
  v_bitop3_b32 v122, v32, v34, s34 bitop3:0x7e
  v_bitop3_b32 v10, v10, v122, 1 bitop3:0xa8
  v_cmp_ne_u32_e64 vcc, 0, v10
  v_add_u32 v10, 0x2000, v7
  s_nop 3
  v_add_f32_dpp v120, v124, v124 row_ror:8 row_mask:0x3 bank_mask:0x3
  v_add_f32_dpp v121, v125, v125 row_ror:8 row_mask:0x3 bank_mask:0x3
  v_add_f32_dpp v120, v126, v126 row_ror:8 row_mask:0x3 bank_mask:0xc
  v_add_f32_dpp v121, v127, v127 row_ror:8 row_mask:0x3 bank_mask:0xc
  v_cvt_pk_bf16_f32 v122, v120, v121
  s_cbranch_vccnz F_h1retry_00
F_h1go_00:
  buffer_store_dword v122, v7, s[8:11], 0 offen
  s_barrier
  s_nop 3
  s_nop 3
  s_nop 3
  buffer_load_dwordx4 v[16:19], v2, s[24:27], 0 offen sc1
  s_barrier
  buffer_load_dwordx4 v[20:23], v2, s[24:27], 0 offen offset:1024 sc1
  v_bfi_b32 v7, s32, v10, v7
  s_xor_b32 s34, s34, 1
  s_nop 13
  s_nop 15
  buffer_load_dwordx4 v[16:19], v2, s[24:27], 0 offen sc1
  buffer_load_dwordx4 v[20:23], v2, s[24:27], 0 offen offset:1024 sc1
  s_nop 3
  s_nop 3
  s_waitcnt lgkmcnt(0)
  s_cmp_lg_u32 s30, 63
  s_cbranch_scc1 F_loop
  s_branch F_last
F_h1retry_00:
  s_add_u32 s44, s44, 1
  s_cmp_gt_u32 s44, 400000
  s_cbranch_scc1 F_h1go_00
  buffer_load_dwordx4 v[16:19], v0, s[8:11], 0 offen offset:0 sc1
  buffer_load_dwordx4 v[20:23], v0, s[8:11], 0 offen offset:1024 sc1
  buffer_load_dwordx4 v[24:27], v0, s[8:11], 0 offen offset:2048 sc1
  buffer_load_dwordx4 v[32:35], v0, s[8:11], 0 offen offset:3072 sc1
  s_branch F_h1_00
F_w1:
  s_barrier
  s_nop 15
  s_nop 11
  buffer_load_dwordx4 v[16:19], v0, s[8:11], 0 offen offset:0 sc1
  buffer_load_dwordx4 v[20:23], v0, s[8:11], 0 offen offset:1024 sc1
  buffer_load_dwordx4 v[24:27], v0, s[8:11], 0 offen offset:2048 sc1
  buffer_load_dwordx4 v[32:35], v0, s[8:11], 0 offen offset:3072 sc1
  ds_read_b128 v[104:107], v8 offset:8192
  ds_read_b128 v[108:111], v8 offset:9216
  ds_read_b128 v[112:115], v8 offset:10240
  ds_read_b128 v[116:119], v8 offset:11264
  s_add_u32 s42, s30, 3
  s_min_u32 s42, s42, 64
  s_cmp_lt_u32 s36, s42
  s_cbranch_scc1 F_peek1
F_peekd1:
F_h1_10:
  s_waitcnt vmcnt(3)
  v_mfma_f32_16x16x32_bf16 v[124:127], v[40:43], v[16:19], 0
  v_bitop3_b32 v10, v16, v18, s34 bitop3:0x7e
  s_waitcnt vmcnt(2)
  v_mfma_f32_16x16x32_bf16 v[124:127], v[40:43], v[20:23], v[124:127]
  v_bitop3_b32 v123, v20, v22, s34 bitop3:0x7e
  s_waitcnt vmcnt(1)
  v_mfma_f32_16x16x32_bf16 v[124:127], v[40:43], v[24:27], v[124:127]
  v_bitop3_b32 v122, v24, v26, s34 bitop3:0x7e
  v_or3_b32 v10, v10, v123, v122
  s_waitcnt vmcnt(0)
  v_mfma_f32_16x16x32_bf16 v[124:127], v[40:43], v[32:35], v[124:127]
  v_bitop3_b32 v122, v32, v34, s34 bitop3:0x7e
  v_bitop3_b32 v10, v10, v122, 1 bitop3:0xa8
  v_cmp_ne_u32_e64 vcc, 0, v10
  v_add_u32 v10, 0x2000, v7
  s_nop 3
  v_add_f32_dpp v120, v124, v124 row_ror:8 row_mask:0x3 bank_mask:0x3
  v_add_f32_dpp v121, v125, v125 row_ror:8 row_mask:0x3 bank_mask:0x3
  v_add_f32_dpp v120, v126, v126 row_ror:8 row_mask:0x3 bank_mask:0xc
  v_add_f32_dpp v121, v127, v127 row_ror:8 row_mask:0x3 bank_mask:0xc
  v_cvt_pk_bf16_f32 v122, v120, v121
  s_cbranch_vccnz F_h1retry_10
F_h1go_10:
  buffer_store_dword v122, v7, s[8:11], 0 offen
  s_barrier
  s_nop 3
  s_nop 3
  s_nop 3
  buffer_load_dwordx4 v[16:19], v2, s[24:27], 0 offen sc1
  s_barrier
  buffer_load_dwordx4 v[20:23], v2, s[24:27], 0 offen offset:1024 sc1
  v_bfi_b32 v7, s32, v10, v7
  s_xor_b32 s34, s34, 1
  s_nop 13
  s_nop 15
  buffer_load_dwordx4 v[16:19], v2, s[24:27], 0 offen sc1
  buffer_load_dwordx4 v[20:23], v2, s[24:27], 0 offen offset:1024 sc1
  s_nop 3
  s_nop 3
  s_waitcnt lgkmcnt(0)
  s_cmp_lg_u32 s30, 63
  s_cbranch_scc1 F_loop
  s_branch F_last
F_h1retry_10:
  s_add_u32 s44, s44, 1
  s_cmp_gt_u32 s44, 400000
  s_cbranch_scc1 F_h1go_10
  buffer_load_dwordx4 v[16:19], v0, s[8:11], 0 offen offset:0 sc1
  buffer_load_dwordx4 v[20:23], v0, s[8:11], 0 offen offset:1024 sc1
  buffer_load_dwordx4 v[24:27], v0, s[8:11], 0 offen offset:2048 sc1
  buffer_load_dwordx4 v[32:35], v0, s[8:11], 0 offen offset:3072 sc1
  s_branch F_h1_10
F_w2:
  s_barrier
  s_add_u32 s42, s30, 3
  s_min_u32 s42, s42, 64
  s_cmp_lt_u32 s36, s42
  s_cbranch_scc1 F_peek2
F_peekd2:
  ds_read_b128 v[104:107], v8 offset:8192
  ds_read_b128 v[108:111], v8 offset:9216
  ds_read_b128 v[112:115], v8 offset:10240
  ds_read_b128 v[116:119], v8 offset:11264
  s_xor_b32 s34, s34, 1
  s_barrier
  s_nop 3
  s_nop 3
  s_nop 3
  buffer_load_dwordx4 v[16:19], v2, s[24:27], 0 offen sc1
  s_barrier
  buffer_load_dwordx4 v[20:23], v2, s[24:27], 0 offen offset:1024 sc1
  s_nop 15
  s_nop 15
  buffer_load_dwordx4 v[16:19], v2, s[24:27], 0 offen sc1
  buffer_load_dwordx4 v[20:23], v2, s[24:27], 0 offen offset:1024 sc1
  s_nop 3
  s_nop 3
  s_waitcnt lgkmcnt(0)
  s_cmp_lg_u32 s30, 63
  s_cbranch_scc1 F_loop
  s_branch F_last
F_peek0:
  v_bfe_u32 v37, v2, 4, 3
  v_min_u32 v37, 5, v37
  v_lshl_add_u32 v38, v37, 2, s50
  s_waitcnt vmcnt(10)
  ds_read_b32 v38, v38 offset:128
  s_waitcnt lgkmcnt(0)
  v_mad_u32_u24 v37, v38, 6, v37
  s_nop 1
  v_min_u32_dpp v37, v37, v37 quad_perm:[1,0,3,2] row_mask:0xf bank_mask:0xf
  s_nop 1
  v_min_u32_dpp v37, v37, v37 quad_perm:[2,3,0,1] row_mask:0xf bank_mask:0xf
  s_nop 1
  v_min_u32_dpp v37, v37, v37 row_half_mirror row_mask:0xf bank_mask:0xf
  s_nop 0
  v_readfirstlane_b32 s3, v37
  s_nop 0
  s_min_u32 s3, s3, 64
  s_max_u32 s36, s36, s3
  s_add_u32 s42, s30, 3
  s_min_u32 s42, s42, 64
  s_cmp_ge_u32 s36, s42
  s_cbranch_scc1 F_peekd0
  v_bfe_u32 v37, v2, 4, 6
  v_min_u32 v37, 5, v37
  v_lshlrev_b32 v37, 2, v37
  s_lshl_b32 s7, s28, 7
  s_add_u32 s7, s7, 589824
T_prog_5:
  buffer_load_dword v38, v37, s[8:11], s7 offen sc1
  s_waitcnt vmcnt(0)
T_prog_5h:
  s_add_u32 s44, s44, 1
  s_mov_b32 s36, 64
  s_cmp_gt_u32 s44, 400000
  s_cbranch_scc1 T_prog_5x
  v_mul_u32_u24 v38, 24, v38
  v_add_u32 v38, v38, v37
  v_lshrrev_b32 v38, 2, v38
  s_nop 0
  v_readlane_b32 s3, v38, 0
  s_nop 0
  s_min_u32 s36, s36, s3
  v_readlane_b32 s3, v38, 1
  s_nop 0
  s_min_u32 s36, s36, s3
  v_readlane_b32 s3, v38, 2
  s_nop 0
  s_min_u32 s36, s36, s3
  v_readlane_b32 s3, v38, 3
  s_nop 0
  s_min_u32 s36, s36, s3
  v_readlane_b32 s3, v38, 4
  s_nop 0
  s_min_u32 s36, s36, s3
  v_readlane_b32 s3, v38, 5
  s_nop 0
  s_min_u32 s36, s36, s3
  s_cmp_lt_u32 s36, s42
  s_cbranch_scc1 T_prog_5
T_prog_5x:
  s_branch F_peekd0
F_peek1:
  v_bfe_u32 v37, v2, 4, 3
  v_min_u32 v37, 5, v37
  v_lshl_add_u32 v38, v37, 2, s50
  s_waitcnt vmcnt(10)
  ds_read_b32 v38, v38 offset:128
  s_waitcnt lgkmcnt(0)
  v_mad_u32_u24 v37, v38, 6, v37
  s_nop 1
  v_min_u32_dpp v37, v37, v37 quad_perm:[1,0,3,2] row_mask:0xf bank_mask:0xf
  s_nop 1
  v_min_u32_dpp v37, v37, v37 quad_perm:[2,3,0,1] row_mask:0xf bank_mask:0xf
  s_nop 1
  v_min_u32_dpp v37, v37, v37 row_half_mirror row_mask:0xf bank_mask:0xf
  s_nop 0
  v_readfirstlane_b32 s3, v37
  s_nop 0
  s_min_u32 s3, s3, 64
  s_max_u32 s36, s36, s3
  s_add_u32 s42, s30, 3
  s_min_u32 s42, s42, 64
  s_cmp_ge_u32 s36, s42
  s_cbranch_scc1 F_peekd1
  v_bfe_u32 v37, v2, 4, 6
  v_min_u32 v37, 5, v37
  v_lshlrev_b32 v37, 2, v37
  s_lshl_b32 s7, s28, 7
  s_add_u32 s7, s7, 589824
T_prog_6:
  buffer_load_dword v38, v37, s[8:11], s7 offen sc1
  s_waitcnt vmcnt(0)
T_prog_6h:
  s_add_u32 s44, s44, 1
  s_mov_b32 s36, 64
  s_cmp_gt_u32 s44, 400000
  s_cbranch_scc1 T_prog_6x
  v_mul_u32_u24 v38, 24, v38
  v_add_u32 v38, v38, v37
  v_lshrrev_b32 v38, 2, v38
  s_nop 0
  v_readlane_b32 s3, v38, 0
  s_nop 0
  s_min_u32 s36, s36, s3
  v_readlane_b32 s3, v38, 1
  s_nop 0
  s_min_u32 s36, s36, s3
  v_readlane_b32 s3, v38, 2
  s_nop 0
  s_min_u32 s36, s36, s3
  v_readlane_b32 s3, v38, 3
  s_nop 0
  s_min_u32 s36, s36, s3
  v_readlane_b32 s3, v38, 4
  s_nop 0
  s_min_u32 s36, s36, s3
  v_readlane_b32 s3, v38, 5
  s_nop 0
  s_min_u32 s36, s36, s3
  s_cmp_lt_u32 s36, s42
  s_cbranch_scc1 T_prog_6
T_prog_6x:
  s_branch F_peekd1
F_peek2:
  v_bfe_u32 v37, v2, 4, 3
  v_min_u32 v37, 5, v37
  v_lshl_add_u32 v38, v37, 2, s50
  s_waitcnt vmcnt(6)
  ds_read_b32 v38, v38 offset:128
  s_waitcnt lgkmcnt(0)
  v_mad_u32_u24 v37, v38, 6, v37
  s_nop 1
  v_min_u32_dpp v37, v37, v37 quad_perm:[1,0,3,2] row_mask:0xf bank_mask:0xf
  s_nop 1
  v_min_u32_dpp v37, v37, v37 quad_perm:[2,3,0,1] row_mask:0xf bank_mask:0xf
  s_nop 1
  v_min_u32_dpp v37, v37, v37 row_half_mirror row_mask:0xf bank_mask:0xf
  s_nop 0
  v_readfirstlane_b32 s3, v37
  s_nop 0
  s_min_u32 s3, s3, 64
  s_max_u32 s36, s36, s3
  s_add_u32 s42, s30, 3
  s_min_u32 s42, s42, 64
  s_cmp_ge_u32 s36, s42
  s_cbranch_scc1 F_peekd2
  v_bfe_u32 v37, v2, 4, 6
  v_min_u32 v37, 5, v37
  v_lshlrev_b32 v37, 2, v37
  s_lshl_b32 s7, s28, 7
  s_add_u32 s7, s7, 589824
T_prog_7:
  buffer_load_dword v38, v37, s[8:11], s7 offen sc1
  s_waitcnt vmcnt(0)
T_prog_7h:
  s_add_u32 s44, s44, 1
  s_mov_b32 s36, 64
  s_cmp_gt_u32 s44, 400000
  s_cbranch_scc1 T_prog_7x
  v_mul_u32_u24 v38, 24, v38
  v_add_u32 v38, v38, v37
  v_lshrrev_b32 v38, 2, v38
  s_nop 0
  v_readlane_b32 s3, v38, 0
  s_nop 0
  s_min_u32 s36, s36, s3
  v_readlane_b32 s3, v38, 1
  s_nop 0
  s_min_u32 s36, s36, s3
  v_readlane_b32 s3, v38, 2
  s_nop 0
  s_min_u32 s36, s36, s3
  v_readlane_b32 s3, v38, 3
  s_nop 0
  s_min_u32 s36, s36, s3
  v_readlane_b32 s3, v38, 4
  s_nop 0
  s_min_u32 s36, s36, s3
  v_readlane_b32 s3, v38, 5
  s_nop 0
  s_min_u32 s36, s36, s3
  s_cmp_lt_u32 s36, s42
  s_cbranch_scc1 T_prog_7
T_prog_7x:
  s_branch F_peekd2
F_redo:
  v_mfma_f32_16x16x32_bf16 v[56:59], v[80:83], v[80:83], 0
  v_mfma_f32_16x16x32_bf16 v[56:59], v[84:87], v[84:87], v[56:59]
  v_mfma_f32_16x16x32_bf16 v[56:59], v[96:99], v[96:99], v[56:59]
  v_mfma_f32_16x16x32_bf16 v[56:59], v[100:103], v[100:103], v[56:59]
  v_mfma_f32_16x16x32_bf16 v[48:51], v[104:107], v[80:83], 0
  v_mfma_f32_16x16x32_bf16 v[48:51], v[108:111], v[84:87], v[48:51]
  v_mfma_f32_16x16x32_bf16 v[48:51], v[112:115], v[96:99], v[48:51]
  v_mfma_f32_16x16x32_bf16 v[48:51], v[116:119], v[100:103], v[48:51]
  v_mfma_f32_16x16x32_bf16 v[52:55], v[72:75], v[80:83], 0
  v_mfma_f32_16x16x32_bf16 v[52:55], v[76:79], v[84:87], v[52:55]
  v_mfma_f32_16x16x32_bf16 v[52:55], v[88:91], v[96:99], v[52:55]
  v_mfma_f32_16x16x32_bf16 v[52:55], v[92:95], v[100:103], v[52:55]
  v_mov_b64 v[24:25], s[46:47]
  v_max3_f32 v10, v56, v57, v48
  v_max3_f32 v10, v10, v49, v50
  s_nop 4
  v_max3_f32 v10, v10, v51, v52
  v_max3_f32 v10, v10, v53, v54
  v_max_f32 v10, v10, v55
  v_mov_b32 v11, v10
  s_nop 1
  v_permlane16_swap_b32 v10, v11
  v_max_f32 v10, v10, v11
  v_mov_b32 v11, v10
  s_nop 1
  v_permlane32_swap_b32 v10, v11
  v_max_f32 v10, v10, v11
  v_sub_f32 v56, v56, v10
  v_sub_f32 v57, v57, v10
  v_sub_f32 v48, v48, v10
  v_sub_f32 v49, v49, v10
  v_sub_f32 v50, v50, v10
  v_sub_f32 v51, v51, v10
  v_sub_f32 v52, v52, v10
  v_sub_f32 v53, v53, v10
  v_sub_f32 v54, v54, v10
  v_sub_f32 v55, v55, v10
  v_exp_f32 v56, v56
  v_exp_f32 v57, v57
  v_exp_f32 v48, v48
  v_exp_f32 v49, v49
  v_exp_f32 v50, v50
  v_exp_f32 v51, v51
  v_exp_f32 v52, v52
  v_exp_f32 v53, v53
  v_exp_f32 v54, v54
  v_exp_f32 v55, v55
  v_cvt_pk_bf16_f32 v28, v56, v57
  v_cvt_pk_bf16_f32 v31, v56, v57
  v_cvt_pk_bf16_f32 v32, v48, v49
  v_cvt_pk_bf16_f32 v33, v50, v51
  v_cvt_pk_bf16_f32 v34, v52, v53
  v_cvt_pk_bf16_f32 v35, v54, v55
  v_mfma_f32_16x16x16_bf16 v[36:39], v[24:25], v[28:29], 0
  v_mfma_f32_16x16x16_bf16 v[40:43], v[14:15], v[28:29], 0
  v_mfma_f32_16x16x16_bf16 v[44:47], v[14:15], v[30:31], 0
  v_mfma_f32_16x16x32_bf16 v[36:39], v[24:27], v[32:35], v[36:39]
  v_mfma_f32_16x16x32_bf16 v[40:43], v[120:123], v[32:35], v[40:43]
  v_mfma_f32_16x16x32_bf16 v[44:47], v[124:127], v[32:35], v[44:47]
  v_mov_b64 v[48:49], 0
  v_mov_b64 v[50:51], 0
  v_mov_b64 v[52:53], 0
  v_mov_b64 v[54:55], 0
  v_mov_b64 v[56:57], 0
  v_mov_b64 v[58:59], 0
  v_rcp_f32_dpp v10, v36 quad_perm:[2,3,2,3] row_mask:0xf bank_mask:0xf
  v_xor_b32 v24, 1024, v5
  v_xor_b32 v28, 2048, v5
  v_xor_b32 v32, 3072, v5
  v_mul_f32_dpp v40, v40, v10 quad_perm:[2,3,2,3] row_mask:0xf bank_mask:0xf
  v_mul_f32_dpp v41, v41, v10 quad_perm:[2,3,2,3] row_mask:0xf bank_mask:0xf
  v_mul_f32_dpp v42, v42, v10 quad_perm:[2,3,2,3] row_mask:0xf bank_mask:0xf
  v_mul_f32_dpp v43, v43, v10 quad_perm:[2,3,2,3] row_mask:0xf bank_mask:0xf
  v_mul_f32_dpp v44, v44, v10 quad_perm:[2,3,2,3] row_mask:0xf bank_mask:0xf
  v_mul_f32_dpp v45, v45, v10 quad_perm:[2,3,2,3] row_mask:0xf bank_mask:0xf
  v_mul_f32_dpp v46, v46, v10 quad_perm:[2,3,2,3] row_mask:0xf bank_mask:0xf
  v_mul_f32_dpp v47, v47, v10 quad_perm:[2,3,2,3] row_mask:0xf bank_mask:0xf
  v_cvt_pk_bf16_f32 v64, v40, v41
  v_cvt_pk_bf16_f32 v65, v42, v43
  v_cvt_pk_bf16_f32 v66, v44, v45
  v_cvt_pk_bf16_f32 v67, v46, v47
  s_branch F_ow
F_rE:
  buffer_load_dwordx4 v[16:19], v2, s[24:27], 0 offen sc1
  buffer_load_dwordx4 v[20:23], v2, s[24:27], 0 offen offset:1024 sc1
  s_waitcnt vmcnt(2)
  v_max3_u32 v10, v16, v17, v18
  v_max_u32 v10, v10, v19
  v_max3_u32 v10, v10, v20, v21
  v_max3_u32 v10, v10, v22, v23
  v_cmp_eq_u32 vcc, -1, v10
  ds_write_b128 v2, v[16:19] offset:0
  ds_write_b128 v2, v[20:23] offset:1024
  s_cbranch_vccnz F_nE0
  v_smfmac_f32_16x16x64_bf16 v[48:51], v[16:19], v[72:79], v1
  v_smfmac_f32_16x16x64_bf16 v[52:55], v[16:19], a[0:7], v1
  s_branch F_gL
F_nE0:
F_qE:
  buffer_load_dwordx4 v[16:19], v2, s[24:27], 0 offen sc1
  buffer_load_dwordx4 v[20:23], v2, s[24:27], 0 offen offset:1024 sc1
  s_add_u32 s44, s44, 1
  s_cmp_gt_u32 s44, 400000
  s_cbranch_scc1 F_gE
  s_waitcnt vmcnt(2)
  v_max3_u32 v10, v16, v17, v18
  v_max_u32 v10, v10, v19
  v_max3_u32 v10, v10, v20, v21
  v_max3_u32 v10, v10, v22, v23
  v_cmp_eq_u32 vcc, -1, v10
  ds_write_b128 v2, v[16:19] offset:0
  ds_write_b128 v2, v[20:23] offset:1024
  s_cbranch_vccnz F_qE
  v_smfmac_f32_16x16x64_bf16 v[48:51], v[16:19], v[72:79], v1
  v_smfmac_f32_16x16x64_bf16 v[52:55], v[16:19], a[0:7], v1
  s_branch F_gL
F_rL:
  buffer_load_dwordx4 v[20:23], v2, s[24:27], 0 offen offset:1024 sc1
  s_waitcnt vmcnt(1)
  v_max3_u32 v10, v20, v21, v22
  v_max_u32 v10, v10, v23
  v_cmp_eq_u32 vcc, -1, v10
  ds_write_b128 v2, v[20:23] offset:1024
  s_cbranch_vccnz F_nL0
  s_branch F_gL
F_nL0:
F_qL:
  buffer_load_dwordx4 v[20:23], v2, s[24:27], 0 offen offset:1024 sc1
  s_add_u32 s44, s44, 1
  s_cmp_gt_u32 s44, 400000
  s_cbranch_scc1 F_gL
  s_waitcnt vmcnt(1)
  v_max3_u32 v10, v20, v21, v22
  v_max_u32 v10, v10, v23
  v_cmp_eq_u32 vcc, -1, v10
  ds_write_b128 v2, v[20:23] offset:1024
  s_cbranch_vccnz F_qL
  s_branch F_gL
F_rEz:
  buffer_load_dwordx4 v[16:19], v2, s[24:27], 0 offen sc1
  buffer_load_dwordx4 v[20:23], v2, s[24:27], 0 offen offset:1024 sc1
  s_waitcnt vmcnt(2)
  v_max3_u32 v10, v16, v17, v18
  v_max_u32 v10, v10, v19
  v_max3_u32 v10, v10, v20, v21
  v_max3_u32 v10, v10, v22, v23
  v_cmp_eq_u32 vcc, -1, v10
  ds_write_b128 v2, v[16:19] offset:0
  ds_write_b128 v2, v[20:23] offset:1024
  s_cbranch_vccnz F_nEz0
  s_branch F_gLz
F_nEz0:
F_qEz:
  buffer_load_dwordx4 v[16:19], v2, s[24:27], 0 offen sc1
  buffer_load_dwordx4 v[20:23], v2, s[24:27], 0 offen offset:1024 sc1
  s_add_u32 s44, s44, 1
  s_cmp_gt_u32 s44, 400000
  s_cbranch_scc1 F_gEz
  s_waitcnt vmcnt(2)
  v_max3_u32 v10, v16, v17, v18
  v_max_u32 v10, v10, v19
  v_max3_u32 v10, v10, v20, v21
  v_max3_u32 v10, v10, v22, v23
  v_cmp_eq_u32 vcc, -1, v10
  ds_write_b128 v2, v[16:19] offset:0
  ds_write_b128 v2, v[20:23] offset:1024
  s_cbranch_vccnz F_qEz
  s_branch F_gLz
F_rLz:
  buffer_load_dwordx4 v[20:23], v2, s[24:27], 0 offen offset:1024 sc1
  s_waitcnt vmcnt(1)
  v_max3_u32 v10, v20, v21, v22
  v_max_u32 v10, v10, v23
  v_cmp_eq_u32 vcc, -1, v10
  ds_write_b128 v2, v[20:23] offset:1024
  s_cbranch_vccnz F_nLz0
  s_branch F_gLz
F_nLz0:
F_qLz:
  buffer_load_dwordx4 v[20:23], v2, s[24:27], 0 offen offset:1024 sc1
  s_add_u32 s44, s44, 1
  s_cmp_gt_u32 s44, 400000
  s_cbranch_scc1 F_gLz
  s_waitcnt vmcnt(1)
  v_max3_u32 v10, v20, v21, v22
  v_max_u32 v10, v10, v23
  v_cmp_eq_u32 vcc, -1, v10
  ds_write_b128 v2, v[20:23] offset:1024
  s_cbranch_vccnz F_qLz
  s_branch F_gLz
F_last:
  s_waitcnt vmcnt(3)
  v_max3_u32 v10, v16, v17, v18
  v_max_u32 v10, v10, v19
  v_cmp_eq_u32 vcc, -1, v10
  ds_write_b128 v2, v[16:19] offset:0
  s_cbranch_vccnz F_rEz
F_gEz:
  s_waitcnt vmcnt(2)
  v_max3_u32 v10, v20, v21, v22
  v_max_u32 v10, v10, v23
  v_cmp_eq_u32 vcc, -1, v10
  ds_write_b128 v2, v[20:23] offset:1024
  s_cbranch_vccnz F_rLz
F_gLz:
  v_smfmac_f32_16x16x64_bf16 v[52:55], v[16:19], a[0:7], v1
  v_smfmac_f32_16x16x64_bf16 v[60:63], v[16:19], a[8:15], v1
  v_smfmac_f32_16x16x64_bf16 v[64:67], v[16:19], a[128:135], v1
  s_waitcnt lgkmcnt(0)
  s_barrier
  ds_read_b128 v[24:27], v28
  v_smfmac_f32_16x16x64_bf16 v[68:71], v[16:19], a[136:143], v1
  ds_read_b128 v[28:31], v28 offset:1024
  v_smfmac_f32_16x16x64_bf16 v[52:55], v[20:23], a[32:39], v1
  ds_read_b128 v[32:35], v36
  v_smfmac_f32_16x16x64_bf16 v[60:63], v[20:23], a[40:47], v1
  ds_read_b128 v[36:39], v36 offset:1024
  v_smfmac_f32_16x16x64_bf16 v[64:67], v[20:23], a[160:167], v1
  ds_read_b128 v[40:43], v44
  v_smfmac_f32_16x16x64_bf16 v[68:71], v[20:23], a[168:175], v1
  ds_read_b128 v[44:47], v44 offset:1024
  s_waitcnt lgkmcnt(5)
  v_smfmac_f32_16x16x64_bf16 v[52:55], v[24:27], a[16:23], v1
  v_smfmac_f32_16x16x64_bf16 v[60:63], v[24:27], a[24:31], v1
  v_smfmac_f32_16x16x64_bf16 v[64:67], v[24:27], a[144:151], v1
  v_smfmac_f32_16x16x64_bf16 v[68:71], v[24:27], a[152:159], v1
  s_waitcnt lgkmcnt(0)
  v_smfmac_f32_16x16x64_bf16 v[52:55], v[28:31], a[48:55], v1
  buffer_store_dwordx4 v[12:15], v5, s[20:23], 0 offen sc1
  v_smfmac_f32_16x16x64_bf16 v[60:63], v[28:31], a[56:63], v1
  s_add_u32 s39, s39, 4096
  s_add_u32 s20, s20, 4096
  s_addc_u32 s21, s21, 0
  v_smfmac_f32_16x16x64_bf16 v[64:67], v[28:31], a[176:183], v1
  v_smfmac_f32_16x16x64_bf16 v[68:71], v[28:31], a[184:191], v1
  v_smfmac_f32_16x16x64_bf16 v[52:55], v[32:35], a[64:71], v1
  v_smfmac_f32_16x16x64_bf16 v[60:63], v[32:35], a[72:79], v1
  v_smfmac_f32_16x16x64_bf16 v[64:67], v[32:35], a[192:199], v1
  v_smfmac_f32_16x16x64_bf16 v[68:71], v[32:35], a[200:207], v1
  v_smfmac_f32_16x16x64_bf16 v[52:55], v[36:39], a[96:103], v1
  v_smfmac_f32_16x16x64_bf16 v[60:63], v[36:39], a[104:111], v1
  v_smfmac_f32_16x16x64_bf16 v[64:67], v[36:39], a[224:231], v1
  v_smfmac_f32_16x16x64_bf16 v[68:71], v[36:39], a[232:239], v1
  v_smfmac_f32_16x16x64_bf16 v[52:55], v[40:43], a[80:87], v1
  v_smfmac_f32_16x16x64_bf16 v[60:63], v[40:43], a[88:95], v1
  v_smfmac_f32_16x16x64_bf16 v[64:67], v[40:43], a[208:215], v1
  v_smfmac_f32_16x16x64_bf16 v[68:71], v[40:43], a[216:223], v1
  v_smfmac_f32_16x16x64_bf16 v[52:55], v[44:47], a[112:119], v1
  v_smfmac_f32_16x16x64_bf16 v[60:63], v[44:47], a[120:127], v1
  v_smfmac_f32_16x16x64_bf16 v[64:67], v[44:47], a[240:247], v1
  v_smfmac_f32_16x16x64_bf16 v[68:71], v[44:47], a[248:255], v1
  v_add_f32 v52, v52, v54
  v_add_f32 v53, v53, v55
  v_cvt_pk_bf16_f32 v12, v52, v53
  v_add_f32 v60, v60, v62
  v_add_f32 v61, v61, v63
  v_cvt_pk_bf16_f32 v13, v60, v61
  v_add_f32 v64, v64, v66
  v_add_f32 v65, v65, v67
  v_cvt_pk_bf16_f32 v14, v64, v65
  v_add_f32 v68, v68, v70
  v_add_f32 v69, v69, v71
  v_cvt_pk_bf16_f32 v15, v68, v69
  buffer_store_dwordx4 v[12:15], v5, s[20:23], 0 offen sc1
  s_endpgm
L_slow:
  v_lshrrev_b32 v11, 2, v5
  ds_read_b32 v11, v11 offset:30720
  v_mov_b64 v[48:49], 0
  v_mov_b64 v[50:51], 0
  v_mov_b64 v[52:53], 0
  v_mov_b64 v[54:55], 0
  v_mov_b64 v[56:57], 0
  v_mov_b64 v[58:59], 0
  v_mov_b64 v[60:61], 0
  v_mov_b64 v[62:63], 0
  v_mov_b64 v[64:65], 0
  v_mov_b64 v[66:67], 0
  v_mov_b64 v[68:69], 0
  v_mov_b64 v[70:71], 0
  v_xor_b32 v28, 2048, v2
  v_xor_b32 v36, 4096, v2
  v_xor_b32 v44, 6144, v2
  s_waitcnt lgkmcnt(0)
  s_mov_b32 exec_hi, 0
  v_add_u32 v11, s38, v11
  s_mov_b32 exec_hi, -1
  ds_read_b128 v[72:75], v8 offset:4096
  ds_read_b128 v[76:79], v8 offset:5120
  ds_read_b128 v[80:83], v8 offset:6144
  ds_read_b128 v[84:87], v8 offset:7168
  ds_read_b128 v[88:91], v8 offset:0
  ds_read_b128 v[92:95], v8 offset:1024
  ds_read_b128 v[96:99], v8 offset:2048
  ds_read_b128 v[100:103], v8 offset:3072
  ds_read_b128 v[104:107], v8 offset:8192
  ds_read_b128 v[108:111], v8 offset:9216
  ds_read_b128 v[112:115], v8 offset:10240
  ds_read_b128 v[116:119], v8 offset:11264
  s_waitcnt lgkmcnt(0) vmcnt(0)
S_loop:
  s_waitcnt vmcnt(3)
  v_max3_u32 v10, v16, v17, v18
  v_max_u32 v10, v10, v19
  v_cmp_eq_u32 vcc, -1, v10
  ds_write_b128 v2, v[16:19] offset:0
  s_cbranch_vccnz S_rE
S_gE:
  v_smfmac_f32_16x16x64_bf16 v[48:51], v[16:19], v[72:79], v1
  v_smfmac_f32_16x16x64_bf16 v[52:55], v[16:19], a[0:7], v1
  s_waitcnt vmcnt(2)
  v_max3_u32 v10, v20, v21, v22
  v_max_u32 v10, v10, v23
  v_cmp_eq_u32 vcc, -1, v10
  ds_write_b128 v2, v[20:23] offset:1024
  s_cbranch_vccnz S_rL
S_gL:
  v_smfmac_f32_16x16x64_bf16 v[56:59], v[16:19], v[80:87], v1
  buffer_load_dwordx4 v[120:123], v2, s[12:15], 0 offen sc1 nt
  v_smfmac_f32_16x16x64_bf16 v[60:63], v[16:19], a[8:15], v1
  buffer_load_dwordx4 v[124:127], v2, s[12:15], 0 offen offset:1024 sc1 nt
  s_mov_b32 m0, s40
  v_smfmac_f32_16x16x64_bf16 v[48:51], v[20:23], v[88:95], v1
  buffer_load_dwordx4 v2, s[16:19], 0 offen sc1 nt lds
  s_mov_b32 m0, s50
  v_smfmac_f32_16x16x64_bf16 v[52:55], v[20:23], a[32:39], v1
  s_waitcnt lgkmcnt(0)
  s_barrier
  ds_read_b128 v[24:27], v28
  v_smfmac_f32_16x16x64_bf16 v[56:59], v[20:23], v[96:103], v1
  buffer_load_dword v11, s[8:11], 0 offen sc1 lds
  s_mov_b32 m0, s40
  ds_read_b128 v[28:31], v28 offset:1024
  v_smfmac_f32_16x16x64_bf16 v[60:63], v[20:23], a[40:47], v1
  ds_read_b128 v[32:35], v36
  v_smfmac_f32_16x16x64_bf16 v[64:67], v[16:19], a[128:135], v1
  ds_read_b128 v[36:39], v36 offset:1024
  v_smfmac_f32_16x16x64_bf16 v[68:71], v[16:19], a[136:143], v1
  ds_read_b128 v[40:43], v44
  v_smfmac_f32_16x16x64_bf16 v[64:67], v[20:23], a[160:167], v1
  ds_read_b128 v[44:47], v44 offset:1024
  v_smfmac_f32_16x16x64_bf16 v[68:71], v[20:23], a[168:175], v1
  buffer_load_dwordx4 v2, s[16:19], 0 offen offset:1024 sc1 nt lds
  s_waitcnt lgkmcnt(5)
S_qk:
  v_smfmac_f32_16x16x64_bf16 v[48:51], v[24:27], v[104:111], v1
  ds_read_b128 v[72:75], v8 offset:12288
  v_smfmac_f32_16x16x64_bf16 v[52:55], v[24:27], a[16:23], v1
  ds_read_b128 v[76:79], v8 offset:13312
  v_smfmac_f32_16x16x64_bf16 v[56:59], v[24:27], v[112:119], v1
  buffer_store_dwordx4 v[12:15], v5, s[20:23], 0 offen sc1
  v_smfmac_f32_16x16x64_bf16 v[60:63], v[24:27], a[24:31], v1
  ds_read_b128 v[88:91], v8 offset:16384
  s_waitcnt lgkmcnt(7)
  v_smfmac_f32_16x16x64_bf16 v[48:51], v[28:31], v[240:247], v1
  ds_read_b128 v[92:95], v8 offset:17408
  v_smfmac_f32_16x16x64_bf16 v[52:55], v[28:31], a[48:55], v1
  ds_read_b128 v[80:83], v8 offset:14336
  v_smfmac_f32_16x16x64_bf16 v[56:59], v[28:31], v[248:255], v1
  ds_read_b128 v[84:87], v8 offset:15360
  v_smfmac_f32_16x16x64_bf16 v[60:63], v[28:31], a[56:63], v1
  ds_read_b128 v[96:99], v8 offset:18432
  s_waitcnt lgkmcnt(7)
  v_smfmac_f32_16x16x64_bf16 v[48:51], v[32:35], v[208:215], v1
  ds_read_b128 v[100:103], v8 offset:19456
  v_smfmac_f32_16x16x64_bf16 v[48:51], v[40:43], v[224:231], v1
  ds_read_b128 v[104:107], v9 offset:0
  s_waitcnt lgkmcnt(5)
  v_smfmac_f32_16x16x64_bf16 v[48:51], v[36:39], v[72:79], v1
  ds_read_b128 v[108:111], v9 offset:1024
  v_smfmac_f32_16x16x64_bf16 v[48:51], v[44:47], v[88:95], v1
  ds_read_b128 v[112:115], v9 offset:2048
  v_smfmac_f32_16x16x64_bf16 v[52:55], v[32:35], a[64:71], v1
  ds_read_b128 v[116:119], v9 offset:3072
  v_smfmac_f32_16x16x64_bf16 v[52:55], v[40:43], a[80:87], v1
  ds_read_b128 v[72:75], v9 offset:4096
  v_mul_f32_e64 v48, s41, v48
  v_smfmac_f32_16x16x64_bf16 v[52:55], v[36:39], a[96:103], v1
  ds_read_b128 v[76:79], v9 offset:5120
  v_mul_f32_e64 v49, s41, v49
  v_smfmac_f32_16x16x64_bf16 v[52:55], v[44:47], a[112:119], v1
  ds_read_b128 v[88:91], v9 offset:6144
  v_fmac_f32_e64 v48, s41, v50
  v_smfmac_f32_16x16x64_bf16 v[56:59], v[32:35], v[216:223], v1
  ds_read_b128 v[92:95], v9 offset:7168
  v_fmac_f32_e64 v49, s41, v51
  v_smfmac_f32_16x16x64_bf16 v[56:59], v[40:43], v[232:239], v1
  s_waitcnt lgkmcnt(8)
  v_cvt_pk_bf16_f32 v51, v48, v49
  v_smfmac_f32_16x16x64_bf16 v[56:59], v[36:39], v[80:87], v1
  v_add_f32 v52, v52, v54
  v_smfmac_f32_16x16x64_bf16 v[56:59], v[44:47], v[96:103], v1
  v_add_f32_e64 v53, v53, v55
  v_smfmac_f32_16x16x64_bf16 v[60:63], v[32:35], a[72:79], v1
  v_cvt_pk_bf16_f32 v50, v52, v53
  v_smfmac_f32_16x16x64_bf16 v[60:63], v[40:43], a[88:95], v1
  ds_write_b64 v3, v[50:51]
  v_mul_f32_e64 v56, s41, v56
  v_smfmac_f32_16x16x64_bf16 v[60:63], v[36:39], a[104:111], v1
  v_mul_f32_e64 v57, s41, v57
  v_smfmac_f32_16x16x64_bf16 v[60:63], v[44:47], a[120:127], v1
  v_fmac_f32_e64 v56, s41, v58
  v_smfmac_f32_16x16x64_bf16 v[64:67], v[24:27], a[144:151], v1
  v_fmac_f32_e64 v57, s41, v59
  v_cvt_pk_bf16_f32 v59, v56, v57
  v_smfmac_f32_16x16x64_bf16 v[68:71], v[24:27], a[152:159], v1
  v_add_f32 v60, v60, v62
  v_add_f32 v61, v61, v63
  v_smfmac_f32_16x16x64_bf16 v[64:67], v[28:31], a[176:183], v1
  v_cvt_pk_bf16_f32 v58, v60, v61
  v_smfmac_f32_16x16x64_bf16 v[68:71], v[28:31], a[184:191], v1
  ds_write_b64 v3, v[58:59] offset:512
  v_smfmac_f32_16x16x64_bf16 v[64:67], v[32:35], a[192:199], v1
  v_cvt_pk_bf16_f32 v13, v60, v61
  v_smfmac_f32_16x16x64_bf16 v[68:71], v[32:35], a[200:207], v1
  v_mov_b64_e64 v[24:25], s[46:47]
  v_smfmac_f32_16x16x64_bf16 v[64:67], v[36:39], a[224:231], v1
  v_mov_b64_e64 v[26:27], s[46:47]
  v_smfmac_f32_16x16x64_bf16 v[68:71], v[36:39], a[232:239], v1
  s_waitcnt lgkmcnt(0) vmcnt(6)
  s_barrier
  ds_read_b64_tr_b16 v[80:81], v4 offset:0
  v_smfmac_f32_16x16x64_bf16 v[64:67], v[40:43], a[208:215], v1
  ds_read_b64_tr_b16 v[82:83], v4 offset:512
  ds_read_b64_tr_b16 v[84:85], v4 offset:1024
  v_smfmac_f32_16x16x64_bf16 v[68:71], v[40:43], a[216:223], v1
  ds_read_b64_tr_b16 v[86:87], v4 offset:1536
  ds_read_b64_tr_b16 v[96:97], v4 offset:2048
  v_smfmac_f32_16x16x64_bf16 v[64:67], v[44:47], a[240:247], v1
  ds_read_b64_tr_b16 v[98:99], v4 offset:2560
  ds_read_b64_tr_b16 v[100:101], v4 offset:3072
  v_smfmac_f32_16x16x64_bf16 v[68:71], v[44:47], a[248:255], v1
  ds_read_b64_tr_b16 v[102:103], v4 offset:3584
  v_cvt_pk_bf16_f32 v12, v52, v53
  s_waitcnt lgkmcnt(6)
  v_mfma_f32_16x16x32_bf16 v[56:59], v[80:83], v[80:83], 0
  s_waitcnt lgkmcnt(4)
  v_mov_b32 v29, 0
  v_mov_b32 v30, 0
  v_mfma_f32_16x16x32_bf16 v[56:59], v[84:87], v[84:87], v[56:59]
  s_waitcnt lgkmcnt(2)
  v_add_f32 v64, v64, v66
  v_add_f32_e64 v65, v65, v67
  v_mfma_f32_16x16x32_bf16 v[56:59], v[96:99], v[96:99], v[56:59]
  s_waitcnt lgkmcnt(0)
  v_cvt_pk_bf16_f32 v14, v64, v65
  v_add_f32 v68, v68, v70
  v_mfma_f32_16x16x32_bf16 v[56:59], v[100:103], v[100:103], v[56:59]
  v_add_f32_e64 v69, v69, v71
  v_cvt_pk_bf16_f32 v15, v68, v69
  v_mfma_f32_16x16x32_bf16 v[48:51], v[104:107], v[80:83], 0
  v_mov_b64 v[60:61], 0
  v_mov_b64 v[62:63], 0
  v_mfma_f32_16x16x32_bf16 v[48:51], v[108:111], v[84:87], v[48:51]
  v_exp_f32_e64 v56, v56
  v_mfma_f32_16x16x32_bf16 v[48:51], v[112:115], v[96:99], v[48:51]
  v_exp_f32_e64 v57, v57
  v_mfma_f32_16x16x32_bf16 v[48:51], v[116:119], v[100:103], v[48:51]
  v_cvt_pk_bf16_f32 v28, v56, v57
  v_cvt_pk_bf16_f32 v31, v56, v57
  v_mfma_f32_16x16x32_bf16 v[52:55], v[72:75], v[80:83], 0
  v_mov_b64 v[56:57], 0
  v_mov_b64 v[58:59], 0
  v_mfma_f32_16x16x32_bf16 v[52:55], v[76:79], v[84:87], v[52:55]
  v_exp_f32_e64 v48, v48
  v_mfma_f32_16x16x32_bf16 v[52:55], v[88:91], v[96:99], v[52:55]
  v_exp_f32_e64 v49, v49
  v_mfma_f32_16x16x32_bf16 v[52:55], v[92:95], v[100:103], v[52:55]
  v_exp_f32_e64 v50, v50
  v_mfma_f32_16x16x16_bf16 v[36:39], v[24:25], v[28:29], 0
  v_exp_f32_e64 v51, v51
  v_mfma_f32_16x16x16_bf16 v[40:43], v[14:15], v[28:29], 0
  v_cvt_pk_bf16_f32 v32, v48, v49
  v_cvt_pk_bf16_f32 v33, v50, v51
  v_mfma_f32_16x16x16_bf16 v[44:47], v[14:15], v[30:31], 0
  s_waitcnt vmcnt(4)
  v_exp_f32 v52, v52
  v_exp_f32 v53, v53
  v_exp_f32 v54, v54
  v_exp_f32_e64 v55, v55
  v_cvt_pk_bf16_f32 v34, v52, v53
  v_cvt_pk_bf16_f32 v35, v54, v55
  v_mov_b64 v[48:49], 0
  v_mov_b64 v[50:51], 0
  v_mfma_f32_16x16x32_bf16 v[36:39], v[24:27], v[32:35], v[36:39]
  v_mov_b64 v[52:53], 0
  v_mov_b64 v[54:55], 0
  v_mfma_f32_16x16x32_bf16 v[40:43], v[120:123], v[32:35], v[40:43]
  v_xor_b32 v24, 1024, v5
  v_xor_b32 v28, 2048, v5
  v_mfma_f32_16x16x32_bf16 v[44:47], v[124:127], v[32:35], v[44:47]
  v_rcp_f32_dpp v10, v36 quad_perm:[2,3,2,3] row_mask:0xf bank_mask:0xf
  v_xor_b32 v32, 3072, v5
  v_max_f32_dpp v11, v36, v10 quad_perm:[2,3,2,3] row_mask:0xf bank_mask:0xf
  v_cmp_nge_f32_e64 vcc, s56, v11
  v_mul_f32_dpp v40, v40, v10 quad_perm:[2,3,2,3] row_mask:0xf bank_mask:0xf
  v_mul_f32_dpp v41, v41, v10 quad_perm:[2,3,2,3] row_mask:0xf bank_mask:0xf
  v_mul_f32_dpp v42, v42, v10 quad_perm:[2,3,2,3] row_mask:0xf bank_mask:0xf
  v_mul_f32_dpp v43, v43, v10 quad_perm:[2,3,2,3] row_mask:0xf bank_mask:0xf
  v_mul_f32_dpp v44, v44, v10 quad_perm:[2,3,2,3] row_mask:0xf bank_mask:0xf
  v_mul_f32_dpp v45, v45, v10 quad_perm:[2,3,2,3] row_mask:0xf bank_mask:0xf
  v_mul_f32_dpp v46, v46, v10 quad_perm:[2,3,2,3] row_mask:0xf bank_mask:0xf
  v_mul_f32_dpp v47, v47, v10 quad_perm:[2,3,2,3] row_mask:0xf bank_mask:0xf
  v_cvt_pk_bf16_f32 v64, v40, v41
  v_cvt_pk_bf16_f32 v65, v42, v43
  v_cvt_pk_bf16_f32 v66, v44, v45
  v_cvt_pk_bf16_f32 v67, v46, v47
  s_cbranch_vccnz S_redo
S_ow:
  ds_write_b128 v5, v[64:67]
  v_smfmac_f32_16x16x64_bf16 v[48:51], v[64:67], v[128:135], v1
  ds_read_b128 v[104:107], v8 offset:24576
  v_smfmac_f32_16x16x64_bf16 v[52:55], v[64:67], v[136:143], v1
  ds_read_b128 v[108:111], v8 offset:25600
  s_waitcnt lgkmcnt(2)
  s_barrier
  ds_read_b128 v[24:27], v24
  ds_read_b128 v[28:31], v28
  ds_read_b128 v[32:35], v32
  v_smfmac_f32_16x16x64_bf16 v[56:59], v[64:67], v[144:151], v1
  ds_read_b128 v[112:115], v8 offset:26624
  v_smfmac_f32_16x16x64_bf16 v[60:63], v[64:67], v[152:159], v1
  ds_read_b128 v[116:119], v8 offset:27648
  s_waitcnt lgkmcnt(4)
  v_smfmac_f32_16x16x64_bf16 v[48:51], v[24:27], v[160:167], v1
  ds_read_b128 v[72:75], v8 offset:20480
  s_waitcnt lgkmcnt(4)
  v_smfmac_f32_16x16x64_bf16 v[48:51], v[28:31], v[192:199], v1
  ds_read_b128 v[76:79], v8 offset:21504
  s_waitcnt lgkmcnt(4)
  v_smfmac_f32_16x16x64_bf16 v[48:51], v[32:35], v[104:111], v1
  ds_read_b128 v[88:91], v8 offset:28672
  v_smfmac_f32_16x16x64_bf16 v[52:55], v[24:27], v[168:175], v1
  ds_read_b128 v[92:95], v8 offset:29696
  v_smfmac_f32_16x16x64_bf16 v[52:55], v[28:31], v[200:207], v1
  ds_read_b128 v[80:83], v8 offset:22528
  s_waitcnt lgkmcnt(5)
  v_cvt_pk_bf16_f32 v16, v48, v49
  v_and_or_b32 v16, v16, -2, s34
  v_cvt_pk_bf16_f32 v17, v50, v51
  v_smfmac_f32_16x16x64_bf16 v[52:55], v[32:35], v[112:119], v1
  buffer_store_dwordx2 v[16:17], v6, s[8:11], 0 offen offset:0 sc1
  ds_read_b128 v[84:87], v8 offset:23552
  v_smfmac_f32_16x16x64_bf16 v[56:59], v[24:27], v[176:183], v1
  ds_read_b128 v[96:99], v8 offset:30720
  s_waitcnt lgkmcnt(5)
  v_smfmac_f32_16x16x64_bf16 v[56:59], v[28:31], v[72:79], v1
  ds_read_b128 v[100:103], v8 offset:31744
  s_waitcnt lgkmcnt(4)
  v_cvt_pk_bf16_f32 v18, v52, v53
  v_and_or_b32 v18, v18, -2, s34
  v_cvt_pk_bf16_f32 v19, v54, v55
  v_smfmac_f32_16x16x64_bf16 v[56:59], v[32:35], v[88:95], v1
  buffer_store_dwordx2 v[18:19], v6, s[8:11], 0 offen offset:64 sc1
  v_smfmac_f32_16x16x64_bf16 v[60:63], v[24:27], v[184:191], v1
  s_waitcnt lgkmcnt(2)
  v_smfmac_f32_16x16x64_bf16 v[60:63], v[28:31], v[80:87], v1
  s_waitcnt lgkmcnt(0)
  v_cvt_pk_bf16_f32 v20, v56, v57
  v_and_or_b32 v20, v20, -2, s34
  v_cvt_pk_bf16_f32 v21, v58, v59
  v_smfmac_f32_16x16x64_bf16 v[60:63], v[32:35], v[96:103], v1
  buffer_store_dwordx2 v[20:21], v6, s[8:11], s35 offen offset:0 sc1
  v_mov_b64 v[48:49], 0
  v_mov_b64 v[50:51], 0
  v_mov_b64 v[52:53], 0
  v_mov_b64 v[54:55], 0
  v_mov_b64 v[56:57], 0
  s_nop 1
  v_cvt_pk_bf16_f32 v22, v60, v61
  v_and_or_b32 v22, v22, -2, s34
  v_cvt_pk_bf16_f32 v23, v62, v63
  buffer_store_dwordx2 v[22:23], v6, s[8:11], s35 offen offset:64 sc1
  v_lshrrev_b32 v11, 2, v5
  v_and_b32 v10, 0x3ff, v5
  v_mov_b64 v[120:121], -1
  v_mov_b64 v[58:59], 0
  v_mov_b64 v[60:61], 0
  v_mov_b64 v[62:63], 0
  v_mov_b64 v[64:65], 0
  v_mov_b64 v[66:67], 0
  v_mov_b64 v[68:69], 0
  v_mov_b64 v[70:71], 0
  v_xor_b32 v28, 2048, v2
  v_xor_b32 v36, 4096, v2
  v_xor_b32 v44, 6144, v2
  v_xor_b32 v9, 24576, v9
  ds_read_b32 v11, v11 offset:30720
  ds_read_b128 v[40:43], v10 offset:29696
  s_add_u32 s30, s30, 1
  s_add_u32 s37, s37, 16384
  s_add_u32 s38, s38, 16384
  s_add_u32 s39, s39, 4096
  s_xor_b32 s40, s40, 24576
  s_add_u32 s31, s31, 8192
  s_andn2_b32 s31, s31, 0x8000
  s_add_u32 s12, s8, s37
  s_addc_u32 s13, s9, 0
  s_add_u32 s16, s8, s38
  s_addc_u32 s17, s9, 0
  s_add_u32 s20, s8, s39
  s_addc_u32 s21, s9, 0
  s_add_u32 s24, s8, s31
  s_addc_u32 s25, s9, 0
  s_waitcnt lgkmcnt(0)
  s_mov_b32 exec_hi, 0
  v_add_u32 v11, s38, v11
  s_mov_b32 exec_hi, -1
  ds_read_b128 v[72:75], v8 offset:4096
  ds_read_b128 v[76:79], v8 offset:5120
  ds_read_b128 v[80:83], v8 offset:6144
  ds_read_b128 v[84:87], v8 offset:7168
  ds_read_b128 v[88:91], v8 offset:0
  ds_read_b128 v[92:95], v8 offset:1024
  ds_read_b128 v[96:99], v8 offset:2048
  ds_read_b128 v[100:103], v8 offset:3072
  s_cmp_eq_u32 s29, 1
  s_cbranch_scc1 S_w1
  s_cmp_ge_u32 s29, 2
  s_cbranch_scc1 S_w2
S_w0:
  s_barrier
  buffer_load_dwordx4 v[16:19], v0, s[8:11], 0 offen offset:0 sc1
  buffer_load_dwordx4 v[20:23], v0, s[8:11], 0 offen offset:1024 sc1
  buffer_load_dwordx4 v[24:27], v0, s[8:11], 0 offen offset:2048 sc1
  buffer_load_dwordx4 v[32:35], v0, s[8:11], 0 offen offset:3072 sc1
  ds_read_b128 v[104:107], v8 offset:8192
  ds_read_b128 v[108:111], v8 offset:9216
  ds_read_b128 v[112:115], v8 offset:10240
  ds_read_b128 v[116:119], v8 offset:11264
  s_add_u32 s42, s30, 3
  s_min_u32 s42, s42, 64
  s_cmp_lt_u32 s36, s42
  s_cbranch_scc1 S_peek0
S_peekd0:
S_h1_00:
  s_waitcnt vmcnt(3)
  v_mfma_f32_16x16x32_bf16 v[124:127], v[40:43], v[16:19], 0
  v_bitop3_b32 v10, v16, v18, s34 bitop3:0x7e
  s_waitcnt vmcnt(2)
  v_mfma_f32_16x16x32_bf16 v[124:127], v[40:43], v[20:23], v[124:127]
  v_bitop3_b32 v123, v20, v22, s34 bitop3:0x7e
  s_waitcnt vmcnt(1)
  v_mfma_f32_16x16x32_bf16 v[124:127], v[40:43], v[24:27], v[124:127]
  v_bitop3_b32 v122, v24, v26, s34 bitop3:0x7e
  v_or3_b32 v10, v10, v123, v122
  s_waitcnt vmcnt(0)
  v_mfma_f32_16x16x32_bf16 v[124:127], v[40:43], v[32:35], v[124:127]
  v_bitop3_b32 v122, v32, v34, s34 bitop3:0x7e
  v_bitop3_b32 v10, v10, v122, 1 bitop3:0xa8
  v_cmp_ne_u32_e64 vcc, 0, v10
  v_add_u32 v10, 0x2000, v7
  s_nop 3
  v_add_f32_dpp v120, v124, v124 row_ror:8 row_mask:0x3 bank_mask:0x3
  v_add_f32_dpp v121, v125, v125 row_ror:8 row_mask:0x3 bank_mask:0x3
  v_add_f32_dpp v120, v126, v126 row_ror:8 row_mask:0x3 bank_mask:0xc
  v_add_f32_dpp v121, v127, v127 row_ror:8 row_mask:0x3 bank_mask:0xc
  v_cvt_pk_bf16_f32 v122, v120, v121
  s_cbranch_vccnz S_h1retry_00
S_h1go_00:
  buffer_store_dword v122, v7, s[8:11], 0 offen sc1
  s_barrier
  s_nop 3
  s_nop 3
  s_nop 3
  buffer_load_dwordx4 v[16:19], v2, s[24:27], 0 offen sc1
  s_barrier
  buffer_load_dwordx4 v[20:23], v2, s[24:27], 0 offen offset:1024 sc1
  v_bfi_b32 v7, s32, v10, v7
  s_xor_b32 s34, s34, 1
  s_nop 13
  s_nop 15
  buffer_load_dwordx4 v[16:19], v2, s[24:27], 0 offen sc1
  buffer_load_dwordx4 v[20:23], v2, s[24:27], 0 offen offset:1024 sc1
  s_nop 3
  s_nop 3
  s_waitcnt lgkmcnt(0)
  s_cmp_lg_u32 s30, 63
  s_cbranch_scc1 S_loop
  s_branch S_last
S_h1retry_00:
  s_add_u32 s44, s44, 1
  s_cmp_gt_u32 s44, 400000
  s_cbranch_scc1 S_h1go_00
  buffer_load_dwordx4 v[16:19], v0, s[8:11], 0 offen offset:0 sc1
  buffer_load_dwordx4 v[20:23], v0, s[8:11], 0 offen offset:1024 sc1
  buffer_load_dwordx4 v[24:27], v0, s[8:11], 0 offen offset:2048 sc1
  buffer_load_dwordx4 v[32:35], v0, s[8:11], 0 offen offset:3072 sc1
  s_branch S_h1_00
S_w1:
  s_barrier
  s_nop 15
  s_nop 11
  buffer_load_dwordx4 v[16:19], v0, s[8:11], 0 offen offset:0 sc1
  buffer_load_dwordx4 v[20:23], v0, s[8:11], 0 offen offset:1024 sc1
  buffer_load_dwordx4 v[24:27], v0, s[8:11], 0 offen offset:2048 sc1
  buffer_load_dwordx4 v[32:35], v0, s[8:11], 0 offen offset:3072 sc1
  ds_read_b128 v[104:107], v8 offset:8192
  ds_read_b128 v[108:111], v8 offset:9216
  ds_read_b128 v[112:115], v8 offset:10240
  ds_read_b128 v[116:119], v8 offset:11264
  s_add_u32 s42, s30, 3
  s_min_u32 s42, s42, 64
  s_cmp_lt_u32 s36, s42
  s_cbranch_scc1 S_peek1
S_peekd1:
S_h1_10:
  s_waitcnt vmcnt(3)
  v_mfma_f32_16x16x32_bf16 v[124:127], v[40:43], v[16:19], 0
  v_bitop3_b32 v10, v16, v18, s34 bitop3:0x7e
  s_waitcnt vmcnt(2)
  v_mfma_f32_16x16x32_bf16 v[124:127], v[40:43], v[20:23], v[124:127]
  v_bitop3_b32 v123, v20, v22, s34 bitop3:0x7e
  s_waitcnt vmcnt(1)
  v_mfma_f32_16x16x32_bf16 v[124:127], v[40:43], v[24:27], v[124:127]
  v_bitop3_b32 v122, v24, v26, s34 bitop3:0x7e
  v_or3_b32 v10, v10, v123, v122
  s_waitcnt vmcnt(0)
  v_mfma_f32_16x16x32_bf16 v[124:127], v[40:43], v[32:35], v[124:127]
  v_bitop3_b32 v122, v32, v34, s34 bitop3:0x7e
  v_bitop3_b32 v10, v10, v122, 1 bitop3:0xa8
  v_cmp_ne_u32_e64 vcc, 0, v10
  v_add_u32 v10, 0x2000, v7
  s_nop 3
  v_add_f32_dpp v120, v124, v124 row_ror:8 row_mask:0x3 bank_mask:0x3
  v_add_f32_dpp v121, v125, v125 row_ror:8 row_mask:0x3 bank_mask:0x3
  v_add_f32_dpp v120, v126, v126 row_ror:8 row_mask:0x3 bank_mask:0xc
  v_add_f32_dpp v121, v127, v127 row_ror:8 row_mask:0x3 bank_mask:0xc
  v_cvt_pk_bf16_f32 v122, v120, v121
  s_cbranch_vccnz S_h1retry_10
S_h1go_10:
  buffer_store_dword v122, v7, s[8:11], 0 offen sc1
  s_barrier
  s_nop 3
  s_nop 3
  s_nop 3
  buffer_load_dwordx4 v[16:19], v2, s[24:27], 0 offen sc1
  s_barrier
  buffer_load_dwordx4 v[20:23], v2, s[24:27], 0 offen offset:1024 sc1
  v_bfi_b32 v7, s32, v10, v7
  s_xor_b32 s34, s34, 1
  s_nop 13
  s_nop 15
  buffer_load_dwordx4 v[16:19], v2, s[24:27], 0 offen sc1
  buffer_load_dwordx4 v[20:23], v2, s[24:27], 0 offen offset:1024 sc1
  s_nop 3
  s_nop 3
  s_waitcnt lgkmcnt(0)
  s_cmp_lg_u32 s30, 63
  s_cbranch_scc1 S_loop
  s_branch S_last
S_h1retry_10:
  s_add_u32 s44, s44, 1
  s_cmp_gt_u32 s44, 400000
  s_cbranch_scc1 S_h1go_10
  buffer_load_dwordx4 v[16:19], v0, s[8:11], 0 offen offset:0 sc1
  buffer_load_dwordx4 v[20:23], v0, s[8:11], 0 offen offset:1024 sc1
  buffer_load_dwordx4 v[24:27], v0, s[8:11], 0 offen offset:2048 sc1
  buffer_load_dwordx4 v[32:35], v0, s[8:11], 0 offen offset:3072 sc1
  s_branch S_h1_10
S_w2:
  s_barrier
  s_add_u32 s42, s30, 3
  s_min_u32 s42, s42, 64
  s_cmp_lt_u32 s36, s42
  s_cbranch_scc1 S_peek2
S_peekd2:
  ds_read_b128 v[104:107], v8 offset:8192
  ds_read_b128 v[108:111], v8 offset:9216
  ds_read_b128 v[112:115], v8 offset:10240
  ds_read_b128 v[116:119], v8 offset:11264
  s_xor_b32 s34, s34, 1
  s_barrier
  s_nop 3
  s_nop 3
  s_nop 3
  buffer_load_dwordx4 v[16:19], v2, s[24:27], 0 offen sc1
  s_barrier
  buffer_load_dwordx4 v[20:23], v2, s[24:27], 0 offen offset:1024 sc1
  s_nop 15
  s_nop 15
  buffer_load_dwordx4 v[16:19], v2, s[24:27], 0 offen sc1
  buffer_load_dwordx4 v[20:23], v2, s[24:27], 0 offen offset:1024 sc1
  s_nop 3
  s_nop 3
  s_waitcnt lgkmcnt(0)
  s_cmp_lg_u32 s30, 63
  s_cbranch_scc1 S_loop
  s_branch S_last
S_peek0:
  v_bfe_u32 v37, v2, 4, 3
  v_min_u32 v37, 5, v37
  v_lshl_add_u32 v38, v37, 2, s50
  s_waitcnt vmcnt(10)
  ds_read_b32 v38, v38 offset:128
  s_waitcnt lgkmcnt(0)
  v_mad_u32_u24 v37, v38, 6, v37
  s_nop 1
  v_min_u32_dpp v37, v37, v37 quad_perm:[1,0,3,2] row_mask:0xf bank_mask:0xf
  s_nop 1
  v_min_u32_dpp v37, v37, v37 quad_perm:[2,3,0,1] row_mask:0xf bank_mask:0xf
  s_nop 1
  v_min_u32_dpp v37, v37, v37 row_half_mirror row_mask:0xf bank_mask:0xf
  s_nop 0
  v_readfirstlane_b32 s3, v37
  s_nop 0
  s_min_u32 s3, s3, 64
  s_max_u32 s36, s36, s3
  s_add_u32 s42, s30, 3
  s_min_u32 s42, s42, 64
  s_cmp_ge_u32 s36, s42
  s_cbranch_scc1 S_peekd0
  v_bfe_u32 v37, v2, 4, 6
  v_min_u32 v37, 5, v37
  v_lshlrev_b32 v37, 2, v37
  s_lshl_b32 s7, s28, 7
  s_add_u32 s7, s7, 589824
T_prog_8:
  buffer_load_dword v38, v37, s[8:11], s7 offen sc1
  s_waitcnt vmcnt(0)
T_prog_8h:
  s_add_u32 s44, s44, 1
  s_mov_b32 s36, 64
  s_cmp_gt_u32 s44, 400000
  s_cbranch_scc1 T_prog_8x
  v_mul_u32_u24 v38, 24, v38
  v_add_u32 v38, v38, v37
  v_lshrrev_b32 v38, 2, v38
  s_nop 0
  v_readlane_b32 s3, v38, 0
  s_nop 0
  s_min_u32 s36, s36, s3
  v_readlane_b32 s3, v38, 1
  s_nop 0
  s_min_u32 s36, s36, s3
  v_readlane_b32 s3, v38, 2
  s_nop 0
  s_min_u32 s36, s36, s3
  v_readlane_b32 s3, v38, 3
  s_nop 0
  s_min_u32 s36, s36, s3
  v_readlane_b32 s3, v38, 4
  s_nop 0
  s_min_u32 s36, s36, s3
  v_readlane_b32 s3, v38, 5
  s_nop 0
  s_min_u32 s36, s36, s3
  s_cmp_lt_u32 s36, s42
  s_cbranch_scc1 T_prog_8
T_prog_8x:
  s_branch S_peekd0
S_peek1:
  v_bfe_u32 v37, v2, 4, 3
  v_min_u32 v37, 5, v37
  v_lshl_add_u32 v38, v37, 2, s50
  s_waitcnt vmcnt(10)
  ds_read_b32 v38, v38 offset:128
  s_waitcnt lgkmcnt(0)
  v_mad_u32_u24 v37, v38, 6, v37
  s_nop 1
  v_min_u32_dpp v37, v37, v37 quad_perm:[1,0,3,2] row_mask:0xf bank_mask:0xf
  s_nop 1
  v_min_u32_dpp v37, v37, v37 quad_perm:[2,3,0,1] row_mask:0xf bank_mask:0xf
  s_nop 1
  v_min_u32_dpp v37, v37, v37 row_half_mirror row_mask:0xf bank_mask:0xf
  s_nop 0
  v_readfirstlane_b32 s3, v37
  s_nop 0
  s_min_u32 s3, s3, 64
  s_max_u32 s36, s36, s3
  s_add_u32 s42, s30, 3
  s_min_u32 s42, s42, 64
  s_cmp_ge_u32 s36, s42
  s_cbranch_scc1 S_peekd1
  v_bfe_u32 v37, v2, 4, 6
  v_min_u32 v37, 5, v37
  v_lshlrev_b32 v37, 2, v37
  s_lshl_b32 s7, s28, 7
  s_add_u32 s7, s7, 589824
T_prog_9:
  buffer_load_dword v38, v37, s[8:11], s7 offen sc1
  s_waitcnt vmcnt(0)
T_prog_9h:
  s_add_u32 s44, s44, 1
  s_mov_b32 s36, 64
  s_cmp_gt_u32 s44, 400000
  s_cbranch_scc1 T_prog_9x
  v_mul_u32_u24 v38, 24, v38
  v_add_u32 v38, v38, v37
  v_lshrrev_b32 v38, 2, v38
  s_nop 0
  v_readlane_b32 s3, v38, 0
  s_nop 0
  s_min_u32 s36, s36, s3
  v_readlane_b32 s3, v38, 1
  s_nop 0
  s_min_u32 s36, s36, s3
  v_readlane_b32 s3, v38, 2
  s_nop 0
  s_min_u32 s36, s36, s3
  v_readlane_b32 s3, v38, 3
  s_nop 0
  s_min_u32 s36, s36, s3
  v_readlane_b32 s3, v38, 4
  s_nop 0
  s_min_u32 s36, s36, s3
  v_readlane_b32 s3, v38, 5
  s_nop 0
  s_min_u32 s36, s36, s3
  s_cmp_lt_u32 s36, s42
  s_cbranch_scc1 T_prog_9
T_prog_9x:
  s_branch S_peekd1
S_peek2:
  v_bfe_u32 v37, v2, 4, 3
  v_min_u32 v37, 5, v37
  v_lshl_add_u32 v38, v37, 2, s50
  s_waitcnt vmcnt(6)
  ds_read_b32 v38, v38 offset:128
  s_waitcnt lgkmcnt(0)
  v_mad_u32_u24 v37, v38, 6, v37
  s_nop 1
  v_min_u32_dpp v37, v37, v37 quad_perm:[1,0,3,2] row_mask:0xf bank_mask:0xf
  s_nop 1
  v_min_u32_dpp v37, v37, v37 quad_perm:[2,3,0,1] row_mask:0xf bank_mask:0xf
  s_nop 1
  v_min_u32_dpp v37, v37, v37 row_half_mirror row_mask:0xf bank_mask:0xf
  s_nop 0
  v_readfirstlane_b32 s3, v37
  s_nop 0
  s_min_u32 s3, s3, 64
  s_max_u32 s36, s36, s3
  s_add_u32 s42, s30, 3
  s_min_u32 s42, s42, 64
  s_cmp_ge_u32 s36, s42
  s_cbranch_scc1 S_peekd2
  v_bfe_u32 v37, v2, 4, 6
  v_min_u32 v37, 5, v37
  v_lshlrev_b32 v37, 2, v37
  s_lshl_b32 s7, s28, 7
  s_add_u32 s7, s7, 589824
T_prog_10:
  buffer_load_dword v38, v37, s[8:11], s7 offen sc1
  s_waitcnt vmcnt(0)
T_prog_10h:
  s_add_u32 s44, s44, 1
  s_mov_b32 s36, 64
  s_cmp_gt_u32 s44, 400000
  s_cbranch_scc1 T_prog_10x
  v_mul_u32_u24 v38, 24, v38
  v_add_u32 v38, v38, v37
  v_lshrrev_b32 v38, 2, v38
  s_nop 0
  v_readlane_b32 s3, v38, 0
  s_nop 0
  s_min_u32 s36, s36, s3
  v_readlane_b32 s3, v38, 1
  s_nop 0
  s_min_u32 s36, s36, s3
  v_readlane_b32 s3, v38, 2
  s_nop 0
  s_min_u32 s36, s36, s3
  v_readlane_b32 s3, v38, 3
  s_nop 0
  s_min_u32 s36, s36, s3
  v_readlane_b32 s3, v38, 4
  s_nop 0
  s_min_u32 s36, s36, s3
  v_readlane_b32 s3, v38, 5
  s_nop 0
  s_min_u32 s36, s36, s3
  s_cmp_lt_u32 s36, s42
  s_cbranch_scc1 T_prog_10
T_prog_10x:
  s_branch S_peekd2
S_redo:
  v_mfma_f32_16x16x32_bf16 v[56:59], v[80:83], v[80:83], 0
  v_mfma_f32_16x16x32_bf16 v[56:59], v[84:87], v[84:87], v[56:59]
  v_mfma_f32_16x16x32_bf16 v[56:59], v[96:99], v[96:99], v[56:59]
  v_mfma_f32_16x16x32_bf16 v[56:59], v[100:103], v[100:103], v[56:59]
  v_mfma_f32_16x16x32_bf16 v[48:51], v[104:107], v[80:83], 0
  v_mfma_f32_16x16x32_bf16 v[48:51], v[108:111], v[84:87], v[48:51]
  v_mfma_f32_16x16x32_bf16 v[48:51], v[112:115], v[96:99], v[48:51]
  v_mfma_f32_16x16x32_bf16 v[48:51], v[116:119], v[100:103], v[48:51]
  v_mfma_f32_16x16x32_bf16 v[52:55], v[72:75], v[80:83], 0
  v_mfma_f32_16x16x32_bf16 v[52:55], v[76:79], v[84:87], v[52:55]
  v_mfma_f32_16x16x32_bf16 v[52:55], v[88:91], v[96:99], v[52:55]
  v_mfma_f32_16x16x32_bf16 v[52:55], v[92:95], v[100:103], v[52:55]
  v_mov_b64 v[24:25], s[46:47]
  v_max3_f32 v10, v56, v57, v48
  v_max3_f32 v10, v10, v49, v50
  s_nop 4
  v_max3_f32 v10, v10, v51, v52
  v_max3_f32 v10, v10, v53, v54
  v_max_f32 v10, v10, v55
  v_mov_b32 v11, v10
  s_nop 1
  v_permlane16_swap_b32 v10, v11
  v_max_f32 v10, v10, v11
  v_mov_b32 v11, v10
  s_nop 1
  v_permlane32_swap_b32 v10, v11
  v_max_f32 v10, v10, v11
  v_sub_f32 v56, v56, v10
  v_sub_f32 v57, v57, v10
  v_sub_f32 v48, v48, v10
  v_sub_f32 v49, v49, v10
  v_sub_f32 v50, v50, v10
  v_sub_f32 v51, v51, v10
  v_sub_f32 v52, v52, v10
  v_sub_f32 v53, v53, v10
  v_sub_f32 v54, v54, v10
  v_sub_f32 v55, v55, v10
  v_exp_f32 v56, v56
  v_exp_f32 v57, v57
  v_exp_f32 v48, v48
  v_exp_f32 v49, v49
  v_exp_f32 v50, v50
  v_exp_f32 v51, v51
  v_exp_f32 v52, v52
  v_exp_f32 v53, v53
  v_exp_f32 v54, v54
  v_exp_f32 v55, v55
  v_cvt_pk_bf16_f32 v28, v56, v57
  v_cvt_pk_bf16_f32 v31, v56, v57
  v_cvt_pk_bf16_f32 v32, v48, v49
  v_cvt_pk_bf16_f32 v33, v50, v51
  v_cvt_pk_bf16_f32 v34, v52, v53
  v_cvt_pk_bf16_f32 v35, v54, v55
  v_mfma_f32_16x16x16_bf16 v[36:39], v[24:25], v[28:29], 0
  v_mfma_f32_16x16x16_bf16 v[40:43], v[14:15], v[28:29], 0
  v_mfma_f32_16x16x16_bf16 v[44:47], v[14:15], v[30:31], 0
  v_mfma_f32_16x16x32_bf16 v[36:39], v[24:27], v[32:35], v[36:39]
  v_mfma_f32_16x16x32_bf16 v[40:43], v[120:123], v[32:35], v[40:43]
  v_mfma_f32_16x16x32_bf16 v[44:47], v[124:127], v[32:35], v[44:47]
  v_mov_b64 v[48:49], 0
  v_mov_b64 v[50:51], 0
  v_mov_b64 v[52:53], 0
  v_mov_b64 v[54:55], 0
  v_mov_b64 v[56:57], 0
  v_mov_b64 v[58:59], 0
  v_rcp_f32_dpp v10, v36 quad_perm:[2,3,2,3] row_mask:0xf bank_mask:0xf
  v_xor_b32 v24, 1024, v5
  v_xor_b32 v28, 2048, v5
  v_xor_b32 v32, 3072, v5
  v_mul_f32_dpp v40, v40, v10 quad_perm:[2,3,2,3] row_mask:0xf bank_mask:0xf
  v_mul_f32_dpp v41, v41, v10 quad_perm:[2,3,2,3] row_mask:0xf bank_mask:0xf
  v_mul_f32_dpp v42, v42, v10 quad_perm:[2,3,2,3] row_mask:0xf bank_mask:0xf
  v_mul_f32_dpp v43, v43, v10 quad_perm:[2,3,2,3] row_mask:0xf bank_mask:0xf
  v_mul_f32_dpp v44, v44, v10 quad_perm:[2,3,2,3] row_mask:0xf bank_mask:0xf
  v_mul_f32_dpp v45, v45, v10 quad_perm:[2,3,2,3] row_mask:0xf bank_mask:0xf
  v_mul_f32_dpp v46, v46, v10 quad_perm:[2,3,2,3] row_mask:0xf bank_mask:0xf
  v_mul_f32_dpp v47, v47, v10 quad_perm:[2,3,2,3] row_mask:0xf bank_mask:0xf
  v_cvt_pk_bf16_f32 v64, v40, v41
  v_cvt_pk_bf16_f32 v65, v42, v43
  v_cvt_pk_bf16_f32 v66, v44, v45
  v_cvt_pk_bf16_f32 v67, v46, v47
  s_branch S_ow
S_rE:
  buffer_load_dwordx4 v[16:19], v2, s[24:27], 0 offen sc1
  buffer_load_dwordx4 v[20:23], v2, s[24:27], 0 offen offset:1024 sc1
  s_waitcnt vmcnt(2)
  v_max3_u32 v10, v16, v17, v18
  v_max_u32 v10, v10, v19
  v_max3_u32 v10, v10, v20, v21
  v_max3_u32 v10, v10, v22, v23
  v_cmp_eq_u32 vcc, -1, v10
  ds_write_b128 v2, v[16:19] offset:0
  ds_write_b128 v2, v[20:23] offset:1024
  s_cbranch_vccnz S_nE0
  v_smfmac_f32_16x16x64_bf16 v[48:51], v[16:19], v[72:79], v1
  v_smfmac_f32_16x16x64_bf16 v[52:55], v[16:19], a[0:7], v1
  s_branch S_gL
S_nE0:
S_qE:
  buffer_load_dwordx4 v[16:19], v2, s[24:27], 0 offen sc1
  buffer_load_dwordx4 v[20:23], v2, s[24:27], 0 offen offset:1024 sc1
  s_add_u32 s44, s44, 1
  s_cmp_gt_u32 s44, 400000
  s_cbranch_scc1 S_gE
  s_waitcnt vmcnt(2)
  v_max3_u32 v10, v16, v17, v18
  v_max_u32 v10, v10, v19
  v_max3_u32 v10, v10, v20, v21
  v_max3_u32 v10, v10, v22, v23
  v_cmp_eq_u32 vcc, -1, v10
  ds_write_b128 v2, v[16:19] offset:0
  ds_write_b128 v2, v[20:23] offset:1024
  s_cbranch_vccnz S_qE
  v_smfmac_f32_16x16x64_bf16 v[48:51], v[16:19], v[72:79], v1
  v_smfmac_f32_16x16x64_bf16 v[52:55], v[16:19], a[0:7], v1
  s_branch S_gL
S_rL:
  buffer_load_dwordx4 v[20:23], v2, s[24:27], 0 offen offset:1024 sc1
  s_waitcnt vmcnt(1)
  v_max3_u32 v10, v20, v21, v22
  v_max_u32 v10, v10, v23
  v_cmp_eq_u32 vcc, -1, v10
  ds_write_b128 v2, v[20:23] offset:1024
  s_cbranch_vccnz S_nL0
  s_branch S_gL
S_nL0:
S_qL:
  buffer_load_dwordx4 v[20:23], v2, s[24:27], 0 offen offset:1024 sc1
  s_add_u32 s44, s44, 1
  s_cmp_gt_u32 s44, 400000
  s_cbranch_scc1 S_gL
  s_waitcnt vmcnt(1)
  v_max3_u32 v10, v20, v21, v22
  v_max_u32 v10, v10, v23
  v_cmp_eq_u32 vcc, -1, v10
  ds_write_b128 v2, v[20:23] offset:1024
  s_cbranch_vccnz S_qL
  s_branch S_gL
S_rEz:
  buffer_load_dwordx4 v[16:19], v2, s[24:27], 0 offen sc1
  buffer_load_dwordx4 v[20:23], v2, s[24:27], 0 offen offset:1024 sc1
  s_waitcnt vmcnt(2)
  v_max3_u32 v10, v16, v17, v18
  v_max_u32 v10, v10, v19
  v_max3_u32 v10, v10, v20, v21
  v_max3_u32 v10, v10, v22, v23
  v_cmp_eq_u32 vcc, -1, v10
  ds_write_b128 v2, v[16:19] offset:0
  ds_write_b128 v2, v[20:23] offset:1024
  s_cbranch_vccnz S_nEz0
  s_branch S_gLz
S_nEz0:
S_qEz:
  buffer_load_dwordx4 v[16:19], v2, s[24:27], 0 offen sc1
  buffer_load_dwordx4 v[20:23], v2, s[24:27], 0 offen offset:1024 sc1
  s_add_u32 s44, s44, 1
  s_cmp_gt_u32 s44, 400000
  s_cbranch_scc1 S_gEz
  s_waitcnt vmcnt(2)
  v_max3_u32 v10, v16, v17, v18
  v_max_u32 v10, v10, v19
  v_max3_u32 v10, v10, v20, v21
  v_max3_u32 v10, v10, v22, v23
  v_cmp_eq_u32 vcc, -1, v10
  ds_write_b128 v2, v[16:19] offset:0
  ds_write_b128 v2, v[20:23] offset:1024
  s_cbranch_vccnz S_qEz
  s_branch S_gLz
S_rLz:
  buffer_load_dwordx4 v[20:23], v2, s[24:27], 0 offen offset:1024 sc1
  s_waitcnt vmcnt(1)
  v_max3_u32 v10, v20, v21, v22
  v_max_u32 v10, v10, v23
  v_cmp_eq_u32 vcc, -1, v10
  ds_write_b128 v2, v[20:23] offset:1024
  s_cbranch_vccnz S_nLz0
  s_branch S_gLz
S_nLz0:
S_qLz:
  buffer_load_dwordx4 v[20:23], v2, s[24:27], 0 offen offset:1024 sc1
  s_add_u32 s44, s44, 1
  s_cmp_gt_u32 s44, 400000
  s_cbranch_scc1 S_gLz
  s_waitcnt vmcnt(1)
  v_max3_u32 v10, v20, v21, v22
  v_max_u32 v10, v10, v23
  v_cmp_eq_u32 vcc, -1, v10
  ds_write_b128 v2, v[20:23] offset:1024
  s_cbranch_vccnz S_qLz
  s_branch S_gLz
S_last:
  s_waitcnt vmcnt(3)
  v_max3_u32 v10, v16, v17, v18
  v_max_u32 v10, v10, v19
  v_cmp_eq_u32 vcc, -1, v10
  ds_write_b128 v2, v[16:19] offset:0
  s_cbranch_vccnz S_rEz
S_gEz:
  s_waitcnt vmcnt(2)
  v_max3_u32 v10, v20, v21, v22
  v_max_u32 v10, v10, v23
  v_cmp_eq_u32 vcc, -1, v10
  ds_write_b128 v2, v[20:23] offset:1024
  s_cbranch_vccnz S_rLz
S_gLz:
  v_smfmac_f32_16x16x64_bf16 v[52:55], v[16:19], a[0:7], v1
  v_smfmac_f32_16x16x64_bf16 v[60:63], v[16:19], a[8:15], v1
  v_smfmac_f32_16x16x64_bf16 v[64:67], v[16:19], a[128:135], v1
  s_waitcnt lgkmcnt(0)
  s_barrier
  ds_read_b128 v[24:27], v28
  v_smfmac_f32_16x16x64_bf16 v[68:71], v[16:19], a[136:143], v1
  ds_read_b128 v[28:31], v28 offset:1024
  v_smfmac_f32_16x16x64_bf16 v[52:55], v[20:23], a[32:39], v1
  ds_read_b128 v[32:35], v36
  v_smfmac_f32_16x16x64_bf16 v[60:63], v[20:23], a[40:47], v1
  ds_read_b128 v[36:39], v36 offset:1024
  v_smfmac_f32_16x16x64_bf16 v[64:67], v[20:23], a[160:167], v1
  ds_read_b128 v[40:43], v44
  v_smfmac_f32_16x16x64_bf16 v[68:71], v[20:23], a[168:175], v1
  ds_read_b128 v[44:47], v44 offset:1024
  s_waitcnt lgkmcnt(5)
  v_smfmac_f32_16x16x64_bf16 v[52:55], v[24:27], a[16:23], v1
  v_smfmac_f32_16x16x64_bf16 v[60:63], v[24:27], a[24:31], v1
  v_smfmac_f32_16x16x64_bf16 v[64:67], v[24:27], a[144:151], v1
  v_smfmac_f32_16x16x64_bf16 v[68:71], v[24:27], a[152:159], v1
  s_waitcnt lgkmcnt(0)
  v_smfmac_f32_16x16x64_bf16 v[52:55], v[28:31], a[48:55], v1
  buffer_store_dwordx4 v[12:15], v5, s[20:23], 0 offen sc1
  v_smfmac_f32_16x16x64_bf16 v[60:63], v[28:31], a[56:63], v1
  s_add_u32 s39, s39, 4096
  s_add_u32 s20, s20, 4096
  s_addc_u32 s21, s21, 0
  v_smfmac_f32_16x16x64_bf16 v[64:67], v[28:31], a[176:183], v1
  v_smfmac_f32_16x16x64_bf16 v[68:71], v[28:31], a[184:191], v1
  v_smfmac_f32_16x16x64_bf16 v[52:55], v[32:35], a[64:71], v1
  v_smfmac_f32_16x16x64_bf16 v[60:63], v[32:35], a[72:79], v1
  v_smfmac_f32_16x16x64_bf16 v[64:67], v[32:35], a[192:199], v1
  v_smfmac_f32_16x16x64_bf16 v[68:71], v[32:35], a[200:207], v1
  v_smfmac_f32_16x16x64_bf16 v[52:55], v[36:39], a[96:103], v1
  v_smfmac_f32_16x16x64_bf16 v[60:63], v[36:39], a[104:111], v1
  v_smfmac_f32_16x16x64_bf16 v[64:67], v[36:39], a[224:231], v1
  v_smfmac_f32_16x16x64_bf16 v[68:71], v[36:39], a[232:239], v1
  v_smfmac_f32_16x16x64_bf16 v[52:55], v[40:43], a[80:87], v1
  v_smfmac_f32_16x16x64_bf16 v[60:63], v[40:43], a[88:95], v1
  v_smfmac_f32_16x16x64_bf16 v[64:67], v[40:43], a[208:215], v1
  v_smfmac_f32_16x16x64_bf16 v[68:71], v[40:43], a[216:223], v1
  v_smfmac_f32_16x16x64_bf16 v[52:55], v[44:47], a[112:119], v1
  v_smfmac_f32_16x16x64_bf16 v[60:63], v[44:47], a[120:127], v1
  v_smfmac_f32_16x16x64_bf16 v[64:67], v[44:47], a[240:247], v1
  v_smfmac_f32_16x16x64_bf16 v[68:71], v[44:47], a[248:255], v1
  v_add_f32 v52, v52, v54
  v_add_f32 v53, v53, v55
  v_cvt_pk_bf16_f32 v12, v52, v53
  v_add_f32 v60, v60, v62
  v_add_f32 v61, v61, v63
  v_cvt_pk_bf16_f32 v13, v60, v61
  v_add_f32 v64, v64, v66
  v_add_f32 v65, v65, v67
  v_cvt_pk_bf16_f32 v14, v64, v65
  v_add_f32 v68, v68, v70
  v_add_f32 v69, v69, v71
  v_cvt_pk_bf16_f32 v15, v68, v69
  buffer_store_dwordx4 v[12:15], v5, s[20:23], 0 offen sc1
  s_endpgm
L_worker:
  s_load_dwordx2 s[8:9], s[0:1], 120
  s_mov_b32 s10, 268435456
  s_mov_b32 s11, 0x20000
  s_load_dwordx2 s[52:53], s[0:1], 112
  s_mov_b32 s54, 256
  s_mov_b32 s55, 0x20000
  s_and_b32 s28, s2, 7
  s_add_u32 s28, s28, 5
  s_sub_u32 s3, s28, 7
  s_min_u32 s28, s28, s3
  s_lshr_b32 s30, s2, 3
  s_lshl_b32 s31, s28, 5
  s_add_u32 s31, s31, s30
  s_mul_i32 s32, s31, 10923
  s_lshr_b32 s32, s32, 16
  s_mul_i32 s3, s32, 6
  s_sub_u32 s33, s31, s3
  v_lshrrev_b32 v4, 6, v0
  v_and_b32 v0, 63, v0
  v_readfirstlane_b32 s29, v4
  v_lshlrev_b32 v1, 4, v0
  s_mov_b32 s44, 0
  s_lshl_b32 s3, s29, 10
  v_add_u32 v2, s3, v1
  s_lshl_b32 s3, s29, 11
  v_add_u32 v3, s3, v1
  s_cmp_eq_u32 s28, 6
  s_cbranch_scc0 L_proj
  s_load_dwordx2 s[24:25], s[0:1], 0
  s_mov_b32 s26, 2097152
  s_mov_b32 s27, 0x20000
  s_load_dwordx2 s[12:13], s[0:1], 64
  s_mov_b32 s14, 7340032
  s_mov_b32 s15, 0x20000
  s_load_dwordx2 s[4:5], s[0:1], 96
  s_lshl_b32 s40, s30, 2
  s_add_u32 s40, s40, s29
  s_lshl_b32 s40, s40, 4
  s_lshl_b32 s7, s40, 10
  s_lshl_b32 s36, s29, 14
  v_and_b32 v8, 0xf0, v1
  v_lshrrev_b32 v9, 4, v0
  v_lshl_add_u32 v7, v9, 10, v8
  v_lshlrev_b32 v9, 2, v9
  v_add_u32 v6, s36, v7
  s_add_u32 s41, s40, 16
  s_waitcnt lgkmcnt(0)
  global_load_dwordx4 v[32:35], v8, s[4:5] offset:0
  global_load_dwordx4 v[36:39], v8, s[4:5] offset:256
  global_load_dwordx4 v[40:43], v8, s[4:5] offset:512
  global_load_dwordx4 v[44:47], v8, s[4:5] offset:768
  s_add_u32 m0, s36, 0
  s_add_u32 s3, s7, 0
  buffer_load_dwordx4 v1, s[24:27], s3 offen offset:0 lds
  buffer_load_dwordx4 v1, s[24:27], s3 offen offset:1024 lds
  buffer_load_dwordx4 v1, s[24:27], s3 offen offset:2048 lds
  buffer_load_dwordx4 v1, s[24:27], s3 offen offset:3072 lds
  s_add_u32 m0, s36, 4096
  s_add_u32 s3, s7, 4096
  buffer_load_dwordx4 v1, s[24:27], s3 offen offset:0 lds
  buffer_load_dwordx4 v1, s[24:27], s3 offen offset:1024 lds
  buffer_load_dwordx4 v1, s[24:27], s3 offen offset:2048 lds
  buffer_load_dwordx4 v1, s[24:27], s3 offen offset:3072 lds
  s_add_u32 m0, s36, 8192
  s_add_u32 s3, s7, 8192
  buffer_load_dwordx4 v1, s[24:27], s3 offen offset:0 lds
  buffer_load_dwordx4 v1, s[24:27], s3 offen offset:1024 lds
  buffer_load_dwordx4 v1, s[24:27], s3 offen offset:2048 lds
  buffer_load_dwordx4 v1, s[24:27], s3 offen offset:3072 lds
  s_add_u32 m0, s36, 12288
  s_add_u32 s3, s7, 12288
  buffer_load_dwordx4 v1, s[24:27], s3 offen offset:0 lds
  buffer_load_dwordx4 v1, s[24:27], s3 offen offset:1024 lds
  buffer_load_dwordx4 v1, s[24:27], s3 offen offset:2048 lds
  buffer_load_dwordx4 v1, s[24:27], s3 offen offset:3072 lds
  v_lshrrev_b32 v4, 6, v2
  v_mul_u32_u24 v4, 3584, v4
  v_and_b32 v5, 3, v0
  v_lshl_add_u32 v4, v5, 7, v4
  s_mul_i32 s3, s30, 229376
  s_add_u32 s3, s3, 3072
  buffer_load_dword v200, v4, s[12:15], s3 offen
  s_waitcnt vmcnt(1)
  v_and_b32 v113, 0xffff0000, v32
  v_lshlrev_b32 v112, 16, v32
  v_and_b32 v115, 0xffff0000, v33
  v_lshlrev_b32 v114, 16, v33
  v_and_b32 v117, 0xffff0000, v34
  v_lshlrev_b32 v116, 16, v34
  v_and_b32 v119, 0xffff0000, v35
  v_lshlrev_b32 v118, 16, v35
  v_and_b32 v121, 0xffff0000, v36
  v_lshlrev_b32 v120, 16, v36
  v_and_b32 v123, 0xffff0000, v37
  v_lshlrev_b32 v122, 16, v37
  v_and_b32 v125, 0xffff0000, v38
  v_lshlrev_b32 v124, 16, v38
  v_and_b32 v127, 0xffff0000, v39
  v_lshlrev_b32 v126, 16, v39
  v_and_b32 v129, 0xffff0000, v40
  v_lshlrev_b32 v128, 16, v40
  v_and_b32 v131, 0xffff0000, v41
  v_lshlrev_b32 v130, 16, v41
  v_and_b32 v133, 0xffff0000, v42
  v_lshlrev_b32 v132, 16, v42
  v_and_b32 v135, 0xffff0000, v43
  v_lshlrev_b32 v134, 16, v43
  v_and_b32 v137, 0xffff0000, v44
  v_lshlrev_b32 v136, 16, v44
  v_and_b32 v139, 0xffff0000, v45
  v_lshlrev_b32 v138, 16, v45
  v_and_b32 v141, 0xffff0000, v46
  v_lshlrev_b32 v140, 16, v46
  v_and_b32 v143, 0xffff0000, v47
  v_lshlrev_b32 v142, 16, v47
Q_row_11:
  ds_read_b128 v[16:19], v6 offset:0
  ds_read_b128 v[20:23], v6 offset:256
  ds_read_b128 v[24:27], v6 offset:512
  ds_read_b128 v[28:31], v6 offset:768
  v_add_u32 v6, 4096, v6
  s_waitcnt lgkmcnt(0)
  v_and_b32 v49, 0xffff0000, v16
  v_lshlrev_b32 v48, 16, v16
  v_and_b32 v51, 0xffff0000, v17
  v_lshlrev_b32 v50, 16, v17
  v_and_b32 v53, 0xffff0000, v18
  v_lshlrev_b32 v52, 16, v18
  v_and_b32 v55, 0xffff0000, v19
  v_lshlrev_b32 v54, 16, v19
  v_and_b32 v57, 0xffff0000, v20
  v_lshlrev_b32 v56, 16, v20
  v_and_b32 v59, 0xffff0000, v21
  v_lshlrev_b32 v58, 16, v21
  v_and_b32 v61, 0xffff0000, v22
  v_lshlrev_b32 v60, 16, v22
  v_and_b32 v63, 0xffff0000, v23
  v_lshlrev_b32 v62, 16, v23
  v_and_b32 v65, 0xffff0000, v24
  v_lshlrev_b32 v64, 16, v24
  v_and_b32 v67, 0xffff0000, v25
  v_lshlrev_b32 v66, 16, v25
  v_and_b32 v69, 0xffff0000, v26
  v_lshlrev_b32 v68, 16, v26
  v_and_b32 v71, 0xffff0000, v27
  v_lshlrev_b32 v70, 16, v27
  v_and_b32 v73, 0xffff0000, v28
  v_lshlrev_b32 v72, 16, v28
  v_and_b32 v75, 0xffff0000, v29
  v_lshlrev_b32 v74, 16, v29
  v_and_b32 v77, 0xffff0000, v30
  v_lshlrev_b32 v76, 16, v30
  v_and_b32 v79, 0xffff0000, v31
  v_lshlrev_b32 v78, 16, v31
  v_pk_mul_f32 v[80:81], v[48:49], v[112:113]
  v_pk_mul_f32 v[82:83], v[50:51], v[114:115]
  v_pk_mul_f32 v[84:85], v[52:53], v[116:117]
  v_pk_mul_f32 v[86:87], v[54:55], v[118:119]
  v_pk_mul_f32 v[88:89], v[56:57], v[120:121]
  v_pk_mul_f32 v[90:91], v[58:59], v[122:123]
  v_pk_mul_f32 v[92:93], v[60:61], v[124:125]
  v_pk_mul_f32 v[94:95], v[62:63], v[126:127]
  v_pk_mul_f32 v[96:97], v[64:65], v[128:129]
  v_pk_mul_f32 v[98:99], v[66:67], v[130:131]
  v_pk_mul_f32 v[100:101], v[68:69], v[132:133]
  v_pk_mul_f32 v[102:103], v[70:71], v[134:135]
  v_pk_mul_f32 v[104:105], v[72:73], v[136:137]
  v_pk_mul_f32 v[106:107], v[74:75], v[138:139]
  v_pk_mul_f32 v[108:109], v[76:77], v[140:141]
  v_pk_mul_f32 v[110:111], v[78:79], v[142:143]
  v_cvt_pk_bf16_f32 v16, v80, v81
  v_cvt_pk_bf16_f32 v17, v82, v83
  v_cvt_pk_bf16_f32 v18, v84, v85
  v_cvt_pk_bf16_f32 v19, v86, v87
  v_cvt_pk_bf16_f32 v20, v88, v89
  v_cvt_pk_bf16_f32 v21, v90, v91
  v_cvt_pk_bf16_f32 v22, v92, v93
  v_cvt_pk_bf16_f32 v23, v94, v95
  v_cvt_pk_bf16_f32 v24, v96, v97
  v_cvt_pk_bf16_f32 v25, v98, v99
  v_cvt_pk_bf16_f32 v26, v100, v101
  v_cvt_pk_bf16_f32 v27, v102, v103
  v_cvt_pk_bf16_f32 v28, v104, v105
  v_cvt_pk_bf16_f32 v29, v106, v107
  v_cvt_pk_bf16_f32 v30, v108, v109
  v_cvt_pk_bf16_f32 v31, v110, v111
  v_and_b32 v81, 0xffff0000, v16
  v_lshlrev_b32 v80, 16, v16
  v_and_b32 v83, 0xffff0000, v17
  v_lshlrev_b32 v82, 16, v17
  v_and_b32 v85, 0xffff0000, v18
  v_lshlrev_b32 v84, 16, v18
  v_and_b32 v87, 0xffff0000, v19
  v_lshlrev_b32 v86, 16, v19
  v_and_b32 v89, 0xffff0000, v20
  v_lshlrev_b32 v88, 16, v20
  v_and_b32 v91, 0xffff0000, v21
  v_lshlrev_b32 v90, 16, v21
  v_and_b32 v93, 0xffff0000, v22
  v_lshlrev_b32 v92, 16, v22
  v_and_b32 v95, 0xffff0000, v23
  v_lshlrev_b32 v94, 16, v23
  v_and_b32 v97, 0xffff0000, v24
  v_lshlrev_b32 v96, 16, v24
  v_and_b32 v99, 0xffff0000, v25
  v_lshlrev_b32 v98, 16, v25
  v_and_b32 v101, 0xffff0000, v26
  v_lshlrev_b32 v100, 16, v26
  v_and_b32 v103, 0xffff0000, v27
  v_lshlrev_b32 v102, 16, v27
  v_and_b32 v105, 0xffff0000, v28
  v_lshlrev_b32 v104, 16, v28
  v_and_b32 v107, 0xffff0000, v29
  v_lshlrev_b32 v106, 16, v29
  v_and_b32 v109, 0xffff0000, v30
  v_lshlrev_b32 v108, 16, v30
  v_and_b32 v111, 0xffff0000, v31
  v_lshlrev_b32 v110, 16, v31
  v_pk_add_f32 v[14:15], v[80:81], v[82:83]
  v_pk_add_f32 v[14:15], v[14:15], v[84:85]
  v_pk_add_f32 v[14:15], v[14:15], v[86:87]
  v_pk_add_f32 v[14:15], v[14:15], v[88:89]
  v_pk_add_f32 v[14:15], v[14:15], v[90:91]
  v_pk_add_f32 v[14:15], v[14:15], v[92:93]
  v_pk_add_f32 v[14:15], v[14:15], v[94:95]
  v_pk_add_f32 v[14:15], v[14:15], v[96:97]
  v_pk_add_f32 v[14:15], v[14:15], v[98:99]
  v_pk_add_f32 v[14:15], v[14:15], v[100:101]
  v_pk_add_f32 v[14:15], v[14:15], v[102:103]
  v_pk_add_f32 v[14:15], v[14:15], v[104:105]
  v_pk_add_f32 v[14:15], v[14:15], v[106:107]
  v_pk_add_f32 v[14:15], v[14:15], v[108:109]
  v_pk_add_f32 v[14:15], v[14:15], v[110:111]
  v_add_f32 v14, v14, v15
  s_nop 1
  v_add_f32_dpp v14, v14, v14 quad_perm:[1,0,3,2] row_mask:0xf bank_mask:0xf
  s_nop 1
  v_add_f32_dpp v14, v14, v14 quad_perm:[2,3,0,1] row_mask:0xf bank_mask:0xf
  s_nop 1
  v_add_f32_dpp v14, v14, v14 row_half_mirror row_mask:0xf bank_mask:0xf
  s_nop 1
  v_add_f32_dpp v14, v14, v14 row_mirror row_mask:0xf bank_mask:0xf
  v_cvt_pk_bf16_f32 v14, v14, v14
  v_lshlrev_b32 v14, 16, v14
  v_mul_f32 v14, 0xbfb8aa3b, v14
  v_exp_f32 v14, v14
  s_nop 0
  v_add_f32 v14, 1.0, v14
  v_rcp_f32 v14, v14
  s_nop 0
  v_cvt_pk_bf16_f32 v14, v14, v14
  v_lshlrev_b32 v14, 16, v14
  s_lshl_b32 s3, s40, 2
  s_add_u32 s3, s3, 622592
  s_mov_b32 exec_lo, 0x00010001
  s_mov_b32 exec_hi, 0x00010001
  buffer_store_dword v14, v9, s[8:11], s3 offen sc1
  s_mov_b64 exec, -1
  v_pk_add_f32 v[10:11], v[48:49], v[50:51]
  v_pk_add_f32 v[10:11], v[10:11], v[52:53]
  v_pk_add_f32 v[10:11], v[10:11], v[54:55]
  v_pk_add_f32 v[10:11], v[10:11], v[56:57]
  v_pk_add_f32 v[10:11], v[10:11], v[58:59]
  v_pk_add_f32 v[10:11], v[10:11], v[60:61]
  v_pk_add_f32 v[10:11], v[10:11], v[62:63]
  v_pk_add_f32 v[10:11], v[10:11], v[64:65]
  v_pk_add_f32 v[10:11], v[10:11], v[66:67]
  v_pk_add_f32 v[10:11], v[10:11], v[68:69]
  v_pk_add_f32 v[10:11], v[10:11], v[70:71]
  v_pk_add_f32 v[10:11], v[10:11], v[72:73]
  v_pk_add_f32 v[10:11], v[10:11], v[74:75]
  v_pk_add_f32 v[10:11], v[10:11], v[76:77]
  v_pk_add_f32 v[10:11], v[10:11], v[78:79]
  v_add_f32 v10, v10, v11
  s_nop 1
  v_add_f32_dpp v10, v10, v10 quad_perm:[1,0,3,2] row_mask:0xf bank_mask:0xf
  s_nop 1
  v_add_f32_dpp v10, v10, v10 quad_perm:[2,3,0,1] row_mask:0xf bank_mask:0xf
  s_nop 1
  v_add_f32_dpp v10, v10, v10 row_half_mirror row_mask:0xf bank_mask:0xf
  s_nop 1
  v_add_f32_dpp v10, v10, v10 row_mirror row_mask:0xf bank_mask:0xf
  v_mul_f32 v12, 0x3b000000, v10
  v_pk_add_f32 v[80:81], v[48:49], v[12:13] op_sel_hi:[1,0] neg_lo:[0,1] neg_hi:[0,1]
  v_pk_add_f32 v[82:83], v[50:51], v[12:13] op_sel_hi:[1,0] neg_lo:[0,1] neg_hi:[0,1]
  v_pk_add_f32 v[84:85], v[52:53], v[12:13] op_sel_hi:[1,0] neg_lo:[0,1] neg_hi:[0,1]
  v_pk_add_f32 v[86:87], v[54:55], v[12:13] op_sel_hi:[1,0] neg_lo:[0,1] neg_hi:[0,1]
  v_pk_add_f32 v[88:89], v[56:57], v[12:13] op_sel_hi:[1,0] neg_lo:[0,1] neg_hi:[0,1]
  v_pk_add_f32 v[90:91], v[58:59], v[12:13] op_sel_hi:[1,0] neg_lo:[0,1] neg_hi:[0,1]
  v_pk_add_f32 v[92:93], v[60:61], v[12:13] op_sel_hi:[1,0] neg_lo:[0,1] neg_hi:[0,1]
  v_pk_add_f32 v[94:95], v[62:63], v[12:13] op_sel_hi:[1,0] neg_lo:[0,1] neg_hi:[0,1]
  v_pk_add_f32 v[96:97], v[64:65], v[12:13] op_sel_hi:[1,0] neg_lo:[0,1] neg_hi:[0,1]
  v_pk_add_f32 v[98:99], v[66:67], v[12:13] op_sel_hi:[1,0] neg_lo:[0,1] neg_hi:[0,1]
  v_pk_add_f32 v[100:101], v[68:69], v[12:13] op_sel_hi:[1,0] neg_lo:[0,1] neg_hi:[0,1]
  v_pk_add_f32 v[102:103], v[70:71], v[12:13] op_sel_hi:[1,0] neg_lo:[0,1] neg_hi:[0,1]
  v_pk_add_f32 v[104:105], v[72:73], v[12:13] op_sel_hi:[1,0] neg_lo:[0,1] neg_hi:[0,1]
  v_pk_add_f32 v[106:107], v[74:75], v[12:13] op_sel_hi:[1,0] neg_lo:[0,1] neg_hi:[0,1]
  v_pk_add_f32 v[108:109], v[76:77], v[12:13] op_sel_hi:[1,0] neg_lo:[0,1] neg_hi:[0,1]
  v_pk_add_f32 v[110:111], v[78:79], v[12:13] op_sel_hi:[1,0] neg_lo:[0,1] neg_hi:[0,1]
  v_pk_mul_f32 v[80:81], v[80:81], v[80:81]
  v_pk_mul_f32 v[82:83], v[82:83], v[82:83]
  v_pk_mul_f32 v[84:85], v[84:85], v[84:85]
  v_pk_mul_f32 v[86:87], v[86:87], v[86:87]
  v_pk_mul_f32 v[88:89], v[88:89], v[88:89]
  v_pk_mul_f32 v[90:91], v[90:91], v[90:91]
  v_pk_mul_f32 v[92:93], v[92:93], v[92:93]
  v_pk_mul_f32 v[94:95], v[94:95], v[94:95]
  v_pk_mul_f32 v[96:97], v[96:97], v[96:97]
  v_pk_mul_f32 v[98:99], v[98:99], v[98:99]
  v_pk_mul_f32 v[100:101], v[100:101], v[100:101]
  v_pk_mul_f32 v[102:103], v[102:103], v[102:103]
  v_pk_mul_f32 v[104:105], v[104:105], v[104:105]
  v_pk_mul_f32 v[106:107], v[106:107], v[106:107]
  v_pk_mul_f32 v[108:109], v[108:109], v[108:109]
  v_pk_mul_f32 v[110:111], v[110:111], v[110:111]
  v_pk_add_f32 v[10:11], v[80:81], v[82:83]
  v_pk_add_f32 v[10:11], v[10:11], v[84:85]
  v_pk_add_f32 v[10:11], v[10:11], v[86:87]
  v_pk_add_f32 v[10:11], v[10:11], v[88:89]
  v_pk_add_f32 v[10:11], v[10:11], v[90:91]
  v_pk_add_f32 v[10:11], v[10:11], v[92:93]
  v_pk_add_f32 v[10:11], v[10:11], v[94:95]
  v_pk_add_f32 v[10:11], v[10:11], v[96:97]
  v_pk_add_f32 v[10:11], v[10:11], v[98:99]
  v_pk_add_f32 v[10:11], v[10:11], v[100:101]
  v_pk_add_f32 v[10:11], v[10:11], v[102:103]
  v_pk_add_f32 v[10:11], v[10:11], v[104:105]
  v_pk_add_f32 v[10:11], v[10:11], v[106:107]
  v_pk_add_f32 v[10:11], v[10:11], v[108:109]
  v_pk_add_f32 v[10:11], v[10:11], v[110:111]
  v_add_f32 v10, v10, v11
  s_nop 1
  v_add_f32_dpp v10, v10, v10 quad_perm:[1,0,3,2] row_mask:0xf bank_mask:0xf
  s_nop 1
  v_add_f32_dpp v10, v10, v10 quad_perm:[2,3,0,1] row_mask:0xf bank_mask:0xf
  s_nop 1
  v_add_f32_dpp v10, v10, v10 row_half_mirror row_mask:0xf bank_mask:0xf
  s_nop 1
  v_add_f32_dpp v10, v10, v10 row_mirror row_mask:0xf bank_mask:0xf
  v_mul_f32 v10, 0x3b000000, v10
  v_cvt_pk_bf16_f32 v10, v10, v10
  v_lshlrev_b32 v10, 16, v10
  v_add_f32 v10, 0x3727c5ac, v10
  v_cvt_pk_bf16_f32 v10, v10, v10
  v_lshlrev_b32 v10, 16, v10
  v_sqrt_f32 v10, v10
  s_nop 0
  v_cvt_pk_bf16_f32 v10, v10, v10
  v_lshlrev_b32 v10, 16, v10
  v_rcp_f32 v10, v10
  v_cvt_pk_bf16_f32 v12, v12, v12
  v_lshlrev_b32 v12, 16, v12
  v_pk_add_f32 v[80:81], v[48:49], v[12:13] op_sel_hi:[1,0] neg_lo:[0,1] neg_hi:[0,1]
  v_pk_add_f32 v[82:83], v[50:51], v[12:13] op_sel_hi:[1,0] neg_lo:[0,1] neg_hi:[0,1]
  v_pk_add_f32 v[84:85], v[52:53], v[12:13] op_sel_hi:[1,0] neg_lo:[0,1] neg_hi:[0,1]
  v_pk_add_f32 v[86:87], v[54:55], v[12:13] op_sel_hi:[1,0] neg_lo:[0,1] neg_hi:[0,1]
  v_pk_add_f32 v[88:89], v[56:57], v[12:13] op_sel_hi:[1,0] neg_lo:[0,1] neg_hi:[0,1]
  v_pk_add_f32 v[90:91], v[58:59], v[12:13] op_sel_hi:[1,0] neg_lo:[0,1] neg_hi:[0,1]
  v_pk_add_f32 v[92:93], v[60:61], v[12:13] op_sel_hi:[1,0] neg_lo:[0,1] neg_hi:[0,1]
  v_pk_add_f32 v[94:95], v[62:63], v[12:13] op_sel_hi:[1,0] neg_lo:[0,1] neg_hi:[0,1]
  v_pk_add_f32 v[96:97], v[64:65], v[12:13] op_sel_hi:[1,0] neg_lo:[0,1] neg_hi:[0,1]
  v_pk_add_f32 v[98:99], v[66:67], v[12:13] op_sel_hi:[1,0] neg_lo:[0,1] neg_hi:[0,1]
  v_pk_add_f32 v[100:101], v[68:69], v[12:13] op_sel_hi:[1,0] neg_lo:[0,1] neg_hi:[0,1]
  v_pk_add_f32 v[102:103], v[70:71], v[12:13] op_sel_hi:[1,0] neg_lo:[0,1] neg_hi:[0,1]
  v_pk_add_f32 v[104:105], v[72:73], v[12:13] op_sel_hi:[1,0] neg_lo:[0,1] neg_hi:[0,1]
  v_pk_add_f32 v[106:107], v[74:75], v[12:13] op_sel_hi:[1,0] neg_lo:[0,1] neg_hi:[0,1]
  v_pk_add_f32 v[108:109], v[76:77], v[12:13] op_sel_hi:[1,0] neg_lo:[0,1] neg_hi:[0,1]
  v_pk_add_f32 v[110:111], v[78:79], v[12:13] op_sel_hi:[1,0] neg_lo:[0,1] neg_hi:[0,1]
  v_cvt_pk_bf16_f32 v16, v80, v81
  v_cvt_pk_bf16_f32 v17, v82, v83
  v_cvt_pk_bf16_f32 v18, v84, v85
  v_cvt_pk_bf16_f32 v19, v86, v87
  v_cvt_pk_bf16_f32 v20, v88, v89
  v_cvt_pk_bf16_f32 v21, v90, v91
  v_cvt_pk_bf16_f32 v22, v92, v93
  v_cvt_pk_bf16_f32 v23, v94, v95
  v_cvt_pk_bf16_f32 v24, v96, v97
  v_cvt_pk_bf16_f32 v25, v98, v99
  v_cvt_pk_bf16_f32 v26, v100, v101
  v_cvt_pk_bf16_f32 v27, v102, v103
  v_cvt_pk_bf16_f32 v28, v104, v105
  v_cvt_pk_bf16_f32 v29, v106, v107
  v_cvt_pk_bf16_f32 v30, v108, v109
  v_cvt_pk_bf16_f32 v31, v110, v111
  v_and_b32 v81, 0xffff0000, v16
  v_lshlrev_b32 v80, 16, v16
  v_and_b32 v83, 0xffff0000, v17
  v_lshlrev_b32 v82, 16, v17
  v_and_b32 v85, 0xffff0000, v18
  v_lshlrev_b32 v84, 16, v18
  v_and_b32 v87, 0xffff0000, v19
  v_lshlrev_b32 v86, 16, v19
  v_and_b32 v89, 0xffff0000, v20
  v_lshlrev_b32 v88, 16, v20
  v_and_b32 v91, 0xffff0000, v21
  v_lshlrev_b32 v90, 16, v21
  v_and_b32 v93, 0xffff0000, v22
  v_lshlrev_b32 v92, 16, v22
  v_and_b32 v95, 0xffff0000, v23
  v_lshlrev_b32 v94, 16, v23
  v_and_b32 v97, 0xffff0000, v24
  v_lshlrev_b32 v96, 16, v24
  v_and_b32 v99, 0xffff0000, v25
  v_lshlrev_b32 v98, 16, v25
  v_and_b32 v101, 0xffff0000, v26
  v_lshlrev_b32 v100, 16, v26
  v_and_b32 v103, 0xffff0000, v27
  v_lshlrev_b32 v102, 16, v27
  v_and_b32 v105, 0xffff0000, v28
  v_lshlrev_b32 v104, 16, v28
  v_and_b32 v107, 0xffff0000, v29
  v_lshlrev_b32 v106, 16, v29
  v_and_b32 v109, 0xffff0000, v30
  v_lshlrev_b32 v108, 16, v30
  v_and_b32 v111, 0xffff0000, v31
  v_lshlrev_b32 v110, 16, v31
  v_pk_mul_f32 v[80:81], v[80:81], v[10:11] op_sel_hi:[1,0]
  v_pk_mul_f32 v[82:83], v[82:83], v[10:11] op_sel_hi:[1,0]
  v_pk_mul_f32 v[84:85], v[84:85], v[10:11] op_sel_hi:[1,0]
  v_pk_mul_f32 v[86:87], v[86:87], v[10:11] op_sel_hi:[1,0]
  v_pk_mul_f32 v[88:89], v[88:89], v[10:11] op_sel_hi:[1,0]
  v_pk_mul_f32 v[90:91], v[90:91], v[10:11] op_sel_hi:[1,0]
  v_pk_mul_f32 v[92:93], v[92:93], v[10:11] op_sel_hi:[1,0]
  v_pk_mul_f32 v[94:95], v[94:95], v[10:11] op_sel_hi:[1,0]
  v_pk_mul_f32 v[96:97], v[96:97], v[10:11] op_sel_hi:[1,0]
  v_pk_mul_f32 v[98:99], v[98:99], v[10:11] op_sel_hi:[1,0]
  v_pk_mul_f32 v[100:101], v[100:101], v[10:11] op_sel_hi:[1,0]
  v_pk_mul_f32 v[102:103], v[102:103], v[10:11] op_sel_hi:[1,0]
  v_pk_mul_f32 v[104:105], v[104:105], v[10:11] op_sel_hi:[1,0]
  v_pk_mul_f32 v[106:107], v[106:107], v[10:11] op_sel_hi:[1,0]
  v_pk_mul_f32 v[108:109], v[108:109], v[10:11] op_sel_hi:[1,0]
  v_pk_mul_f32 v[110:111], v[110:111], v[10:11] op_sel_hi:[1,0]
  v_cvt_pk_bf16_f32 v32, v80, v81
  v_cvt_pk_bf16_f32 v33, v82, v83
  v_cvt_pk_bf16_f32 v34, v84, v85
  v_cvt_pk_bf16_f32 v35, v86, v87
  v_cvt_pk_bf16_f32 v36, v88, v89
  v_cvt_pk_bf16_f32 v37, v90, v91
  v_cvt_pk_bf16_f32 v38, v92, v93
  v_cvt_pk_bf16_f32 v39, v94, v95
  v_cvt_pk_bf16_f32 v40, v96, v97
  v_cvt_pk_bf16_f32 v41, v98, v99
  v_cvt_pk_bf16_f32 v42, v100, v101
  v_cvt_pk_bf16_f32 v43, v102, v103
  v_cvt_pk_bf16_f32 v44, v104, v105
  v_cvt_pk_bf16_f32 v45, v106, v107
  v_cvt_pk_bf16_f32 v46, v108, v109
  v_cvt_pk_bf16_f32 v47, v110, v111
  s_lshl_b32 s3, s40, 10
  s_add_u32 s3, s3, 1048576
  buffer_store_dwordx4 v[32:35], v7, s[8:11], s3 offen offset:0 sc1
  buffer_store_dwordx4 v[36:39], v7, s[8:11], s3 offen offset:256 sc1
  buffer_store_dwordx4 v[40:43], v7, s[8:11], s3 offen offset:512 sc1
  buffer_store_dwordx4 v[44:47], v7, s[8:11], s3 offen offset:768 sc1
  s_add_u32 s40, s40, 4
  s_cmp_lt_u32 s40, s41
  s_cbranch_scc1 Q_row_11
  s_cmp_lg_u32 s29, 0
  s_cbranch_scc1 W_arr_12
  v_lshlrev_b32 v4, 7, v0
  s_mul_i32 s3, s28, 1536
  s_lshl_b32 s6, s30, 2
  s_add_u32 s3, s3, s6
  s_add_u32 s3, s3, 606208
  v_add_u32 v4, s3, v4
  s_lshl_b32 s6, s31, 2
  s_add_u32 s6, s6, 598016
  v_writelane_b32 v4, s6, 12
  s_add_u32 s6, s6, 4096
  v_writelane_b32 v4, s6, 13
  v_mov_b32 v5, 0
  s_getreg_b32 s3, hwreg(HW_REG_XCC_ID, 0, 4)
  v_writelane_b32 v5, s3, 13
  s_mov_b64 exec, 0x3fff
  buffer_store_dword v5, v4, s[8:11], 0 offen sc1
  s_lshl_b32 s3, s28, 2
  s_add_u32 s3, s3, 132
  s_mov_b64 exec, 1
  s_waitcnt vmcnt(0)
  v_mov_b32 v5, 1
  buffer_atomic_add v5, off, s[52:55], s3 sc1
  s_mov_b64 exec, -1
W_arr_12:
  s_waitcnt vmcnt(0)
  s_barrier
  s_lshl_b32 s3, s31, 2
  s_add_u32 s3, s3, 598016
  s_cmp_lg_u32 s29, 0
  s_cbranch_scc1 W_pub_13
  v_mov_b32 v4, 1
  s_mov_b64 exec, 1
  buffer_store_dword v4, off, s[8:11], s3 sc1
  s_mov_b64 exec, -1
W_pub_13:
  s_and_b32 s38, s30, 7
  s_lshr_b32 s39, s31, 3
  s_load_dwordx2 s[12:13], s[0:1], 64
  s_mov_b32 s14, 7340032
  s_mov_b32 s15, 0x20000
  s_load_dwordx2 s[16:17], s[0:1], 72
  s_mov_b32 s18, 3584
  s_mov_b32 s19, 0x20000
  v_lshrrev_b32 v4, 4, v0
  v_lshlrev_b32 v4, 1, v4
  v_and_b32 v5, 7, v0
  v_xor_b32 v5, v5, v4
  v_lshlrev_b32 v5, 4, v5
  v_lshrrev_b32 v4, 3, v0
  v_lshl_add_u32 v6, v4, 10, v5
  v_mul_u32_u24 v4, 3584, v4
  v_add_u32 v7, v4, v5
  s_mul_i32 s36, s29, 40960
  v_bfe_u32 v4, v0, 0, 1
  v_lshlrev_b32 v5, 3, v4
  v_bfe_u32 v4, v0, 1, 1
  v_lshl_add_u32 v5, v4, 4, v5
  v_bfe_u32 v4, v0, 2, 1
  v_lshl_add_u32 v5, v4, 7, v5
  v_bfe_u32 v4, v0, 3, 1
  v_lshl_add_u32 v5, v4, 8, v5
  v_bfe_u32 v4, v0, 4, 1
  v_lshl_add_u32 v5, v4, 9, v5
  v_bfe_u32 v4, v0, 5, 1
  v_lshl_add_u32 v5, v4, 10, v5
  v_add_u32 v5, s36, v5
  v_bfe_u32 v4, v0, 3, 2
  v_xor_b32 v80, 0, v4
  v_lshl_add_u32 v80, v80, 5, v5
  v_xor_b32 v81, 1, v4
  v_lshl_add_u32 v81, v81, 5, v5
  v_xor_b32 v82, 2, v4
  v_lshl_add_u32 v82, v82, 5, v5
  v_xor_b32 v83, 3, v4
  v_lshl_add_u32 v83, v83, 5, v5
  s_mul_i32 s40, s29, 524288
  s_lshl_b32 s3, s38, 7
  s_add_u32 s40, s40, s3
  s_add_u32 s40, s40, 1048576
  s_mul_i32 s41, s29, 1835008
  s_lshl_b32 s3, s39, 7
  s_add_u32 s41, s41, s3
  s_lshl_b32 s6, s29, 5
  s_add_u32 s3, s3, s6
  v_lshrrev_b32 v4, 3, v0
  v_lshlrev_b32 v4, 1, v4
  s_waitcnt lgkmcnt(0)
  buffer_load_ushort v14, v4, s[16:19], s3 offen
  buffer_load_ushort v15, v4, s[16:19], s3 offen offset:16
  s_mul_i32 s34, s38, 16
  s_lshr_b32 s34, s34, 3
  s_mul_i32 s37, s34, 114688
  s_add_u32 s37, s37, s41
  s_add_u32 s34, s34, 1
  s_cmp_eq_u32 s34, 16
  s_cselect_b32 s34, 0, s34
  s_add_u32 m0, s36, 0
  s_add_u32 s3, s37, 0
  buffer_load_dwordx4 v7, s[12:15], s3 offen  lds
  s_add_u32 m0, s36, 1024
  s_add_u32 s3, s37, 28672
  buffer_load_dwordx4 v7, s[12:15], s3 offen  lds
  s_add_u32 m0, s36, 2048
  s_add_u32 s3, s37, 57344
  buffer_load_dwordx4 v7, s[12:15], s3 offen  lds
  s_add_u32 m0, s36, 3072
  s_add_u32 s3, s37, 86016
  buffer_load_dwordx4 v7, s[12:15], s3 offen  lds
  s_mul_i32 s37, s34, 114688
  s_add_u32 s37, s37, s41
  s_add_u32 s34, s34, 1
  s_cmp_eq_u32 s34, 16
  s_cselect_b32 s34, 0, s34
  s_add_u32 m0, s36, 4096
  s_add_u32 s3, s37, 0
  buffer_load_dwordx4 v7, s[12:15], s3 offen  lds
  s_add_u32 m0, s36, 5120
  s_add_u32 s3, s37, 28672
  buffer_load_dwordx4 v7, s[12:15], s3 offen  lds
  s_add_u32 m0, s36, 6144
  s_add_u32 s3, s37, 57344
  buffer_load_dwordx4 v7, s[12:15], s3 offen  lds
  s_add_u32 m0, s36, 7168
  s_add_u32 s3, s37, 86016
  buffer_load_dwordx4 v7, s[12:15], s3 offen  lds
  s_mul_i32 s37, s34, 114688
  s_add_u32 s37, s37, s41
  s_add_u32 s34, s34, 1
  s_cmp_eq_u32 s34, 16
  s_cselect_b32 s34, 0, s34
  s_add_u32 m0, s36, 8192
  s_add_u32 s3, s37, 0
  buffer_load_dwordx4 v7, s[12:15], s3 offen  lds
  s_add_u32 m0, s36, 9216
  s_add_u32 s3, s37, 28672
  buffer_load_dwordx4 v7, s[12:15], s3 offen  lds
  s_add_u32 m0, s36, 10240
  s_add_u32 s3, s37, 57344
  buffer_load_dwordx4 v7, s[12:15], s3 offen  lds
  s_add_u32 m0, s36, 11264
  s_add_u32 s3, s37, 86016
  buffer_load_dwordx4 v7, s[12:15], s3 offen  lds
  s_mul_i32 s37, s34, 114688
  s_add_u32 s37, s37, s41
  s_add_u32 s34, s34, 1
  s_cmp_eq_u32 s34, 16
  s_cselect_b32 s34, 0, s34
  s_add_u32 m0, s36, 12288
  s_add_u32 s3, s37, 0
  buffer_load_dwordx4 v7, s[12:15], s3 offen  lds
  s_add_u32 m0, s36, 13312
  s_add_u32 s3, s37, 28672
  buffer_load_dwordx4 v7, s[12:15], s3 offen  lds
  s_add_u32 m0, s36, 14336
  s_add_u32 s3, s37, 57344
  buffer_load_dwordx4 v7, s[12:15], s3 offen  lds
  s_add_u32 m0, s36, 15360
  s_add_u32 s3, s37, 86016
  buffer_load_dwordx4 v7, s[12:15], s3 offen  lds
  s_mul_i32 s37, s34, 114688
  s_add_u32 s37, s37, s41
  s_add_u32 s34, s34, 1
  s_cmp_eq_u32 s34, 16
  s_cselect_b32 s34, 0, s34
  s_add_u32 m0, s36, 16384
  s_add_u32 s3, s37, 0
  buffer_load_dwordx4 v7, s[12:15], s3 offen  lds
  s_add_u32 m0, s36, 17408
  s_add_u32 s3, s37, 28672
  buffer_load_dwordx4 v7, s[12:15], s3 offen  lds
  s_add_u32 m0, s36, 18432
  s_add_u32 s3, s37, 57344
  buffer_load_dwordx4 v7, s[12:15], s3 offen  lds
  s_add_u32 m0, s36, 19456
  s_add_u32 s3, s37, 86016
  buffer_load_dwordx4 v7, s[12:15], s3 offen  lds
  s_mul_i32 s37, s34, 114688
  s_add_u32 s37, s37, s41
  s_add_u32 s34, s34, 1
  s_cmp_eq_u32 s34, 16
  s_cselect_b32 s34, 0, s34
  s_add_u32 m0, s36, 20480
  s_add_u32 s3, s37, 0
  buffer_load_dwordx4 v7, s[12:15], s3 offen  lds
  s_add_u32 m0, s36, 21504
  s_add_u32 s3, s37, 28672
  buffer_load_dwordx4 v7, s[12:15], s3 offen  lds
  s_add_u32 m0, s36, 22528
  s_add_u32 s3, s37, 57344
  buffer_load_dwordx4 v7, s[12:15], s3 offen  lds
  s_add_u32 m0, s36, 23552
  s_add_u32 s3, s37, 86016
  buffer_load_dwordx4 v7, s[12:15], s3 offen  lds
  s_mul_i32 s37, s34, 114688
  s_add_u32 s37, s37, s41
  s_add_u32 s34, s34, 1
  s_cmp_eq_u32 s34, 16
  s_cselect_b32 s34, 0, s34
  s_add_u32 m0, s36, 24576
  s_add_u32 s3, s37, 0
  buffer_load_dwordx4 v7, s[12:15], s3 offen  lds
  s_add_u32 m0, s36, 25600
  s_add_u32 s3, s37, 28672
  buffer_load_dwordx4 v7, s[12:15], s3 offen  lds
  s_add_u32 m0, s36, 26624
  s_add_u32 s3, s37, 57344
  buffer_load_dwordx4 v7, s[12:15], s3 offen  lds
  s_add_u32 m0, s36, 27648
  s_add_u32 s3, s37, 86016
  buffer_load_dwordx4 v7, s[12:15], s3 offen  lds
  s_mul_i32 s37, s34, 114688
  s_add_u32 s37, s37, s41
  s_add_u32 s34, s34, 1
  s_cmp_eq_u32 s34, 16
  s_cselect_b32 s34, 0, s34
  s_add_u32 m0, s36, 28672
  s_add_u32 s3, s37, 0
  buffer_load_dwordx4 v7, s[12:15], s3 offen  lds
  s_add_u32 m0, s36, 29696
  s_add_u32 s3, s37, 28672
  buffer_load_dwordx4 v7, s[12:15], s3 offen  lds
  s_add_u32 m0, s36, 30720
  s_add_u32 s3, s37, 57344
  buffer_load_dwordx4 v7, s[12:15], s3 offen  lds
  s_add_u32 m0, s36, 31744
  s_add_u32 s3, s37, 86016
  buffer_load_dwordx4 v7, s[12:15], s3 offen  lds
  s_waitcnt vmcnt(28) lgkmcnt(7)
  ds_read_b64_tr_b16 a[0:1], v80 offset:0
  ds_read_b64_tr_b16 a[2:3], v80 offset:2048
  s_mul_i32 s37, s34, 114688
  s_add_u32 s37, s37, s41
  s_add_u32 s34, s34, 1
  s_cmp_eq_u32 s34, 16
  s_cselect_b32 s34, 0, s34
  s_add_u32 m0, s36, 32768
  s_add_u32 s3, s37, 0
  buffer_load_dwordx4 v7, s[12:15], s3 offen  lds
  ds_read_b64_tr_b16 a[4:5], v81 offset:0
  ds_read_b64_tr_b16 a[6:7], v81 offset:2048
  s_add_u32 m0, s36, 33792
  s_add_u32 s3, s37, 28672
  buffer_load_dwordx4 v7, s[12:15], s3 offen  lds
  ds_read_b64_tr_b16 a[8:9], v82 offset:0
  ds_read_b64_tr_b16 a[10:11], v82 offset:2048
  s_add_u32 m0, s36, 34816
  s_add_u32 s3, s37, 57344
  buffer_load_dwordx4 v7, s[12:15], s3 offen  lds
  ds_read_b64_tr_b16 a[12:13], v83 offset:0
  ds_read_b64_tr_b16 a[14:15], v83 offset:2048
  s_add_u32 m0, s36, 35840
  s_add_u32 s3, s37, 86016
  buffer_load_dwordx4 v7, s[12:15], s3 offen  lds
  s_waitcnt vmcnt(28) lgkmcnt(7)
  ds_read_b64_tr_b16 a[16:17], v80 offset:4096
  ds_read_b64_tr_b16 a[18:19], v80 offset:6144
  s_mul_i32 s37, s34, 114688
  s_add_u32 s37, s37, s41
  s_add_u32 s34, s34, 1
  s_cmp_eq_u32 s34, 16
  s_cselect_b32 s34, 0, s34
  s_add_u32 m0, s36, 36864
  s_add_u32 s3, s37, 0
  buffer_load_dwordx4 v7, s[12:15], s3 offen  lds
  ds_read_b64_tr_b16 a[20:21], v81 offset:4096
  ds_read_b64_tr_b16 a[22:23], v81 offset:6144
  s_add_u32 m0, s36, 37888
  s_add_u32 s3, s37, 28672
  buffer_load_dwordx4 v7, s[12:15], s3 offen  lds
  ds_read_b64_tr_b16 a[24:25], v82 offset:4096
  ds_read_b64_tr_b16 a[26:27], v82 offset:6144
  s_add_u32 m0, s36, 38912
  s_add_u32 s3, s37, 57344
  buffer_load_dwordx4 v7, s[12:15], s3 offen  lds
  ds_read_b64_tr_b16 a[28:29], v83 offset:4096
  ds_read_b64_tr_b16 a[30:31], v83 offset:6144
  s_add_u32 m0, s36, 39936
  s_add_u32 s3, s37, 86016
  buffer_load_dwordx4 v7, s[12:15], s3 offen  lds
  s_waitcnt vmcnt(28) lgkmcnt(7)
  ds_read_b64_tr_b16 a[32:33], v80 offset:8192
  ds_read_b64_tr_b16 a[34:35], v80 offset:10240
  s_mul_i32 s37, s34, 114688
  s_add_u32 s37, s37, s41
  s_add_u32 s34, s34, 1
  s_cmp_eq_u32 s34, 16
  s_cselect_b32 s34, 0, s34
  s_add_u32 m0, s36, 0
  s_add_u32 s3, s37, 0
  buffer_load_dwordx4 v7, s[12:15], s3 offen  lds
  ds_read_b64_tr_b16 a[36:37], v81 offset:8192
  ds_read_b64_tr_b16 a[38:39], v81 offset:10240
  s_add_u32 m0, s36, 1024
  s_add_u32 s3, s37, 28672
  buffer_load_dwordx4 v7, s[12:15], s3 offen  lds
  ds_read_b64_tr_b16 a[40:41], v82 offset:8192
  ds_read_b64_tr_b16 a[42:43], v82 offset:10240
  s_add_u32 m0, s36, 2048
  s_add_u32 s3, s37, 57344
  buffer_load_dwordx4 v7, s[12:15], s3 offen  lds
  ds_read_b64_tr_b16 a[44:45], v83 offset:8192
  ds_read_b64_tr_b16 a[46:47], v83 offset:10240
  s_add_u32 m0, s36, 3072
  s_add_u32 s3, s37, 86016
  buffer_load_dwordx4 v7, s[12:15], s3 offen  lds
  s_waitcnt vmcnt(28) lgkmcnt(7)
  ds_read_b64_tr_b16 a[48:49], v80 offset:12288
  ds_read_b64_tr_b16 a[50:51], v80 offset:14336
  s_mul_i32 s37, s34, 114688
  s_add_u32 s37, s37, s41
  s_add_u32 s34, s34, 1
  s_cmp_eq_u32 s34, 16
  s_cselect_b32 s34, 0, s34
  s_add_u32 m0, s36, 4096
  s_add_u32 s3, s37, 0
  buffer_load_dwordx4 v7, s[12:15], s3 offen  lds
  ds_read_b64_tr_b16 a[52:53], v81 offset:12288
  ds_read_b64_tr_b16 a[54:55], v81 offset:14336
  s_add_u32 m0, s36, 5120
  s_add_u32 s3, s37, 28672
  buffer_load_dwordx4 v7, s[12:15], s3 offen  lds
  ds_read_b64_tr_b16 a[56:57], v82 offset:12288
  ds_read_b64_tr_b16 a[58:59], v82 offset:14336
  s_add_u32 m0, s36, 6144
  s_add_u32 s3, s37, 57344
  buffer_load_dwordx4 v7, s[12:15], s3 offen  lds
  ds_read_b64_tr_b16 a[60:61], v83 offset:12288
  ds_read_b64_tr_b16 a[62:63], v83 offset:14336
  s_add_u32 m0, s36, 7168
  s_add_u32 s3, s37, 86016
  buffer_load_dwordx4 v7, s[12:15], s3 offen  lds
  s_waitcnt vmcnt(28) lgkmcnt(7)
  ds_read_b64_tr_b16 a[64:65], v80 offset:16384
  ds_read_b64_tr_b16 a[66:67], v80 offset:18432
  s_mul_i32 s37, s34, 114688
  s_add_u32 s37, s37, s41
  s_add_u32 s34, s34, 1
  s_cmp_eq_u32 s34, 16
  s_cselect_b32 s34, 0, s34
  s_add_u32 m0, s36, 8192
  s_add_u32 s3, s37, 0
  buffer_load_dwordx4 v7, s[12:15], s3 offen  lds
  ds_read_b64_tr_b16 a[68:69], v81 offset:16384
  ds_read_b64_tr_b16 a[70:71], v81 offset:18432
  s_add_u32 m0, s36, 9216
  s_add_u32 s3, s37, 28672
  buffer_load_dwordx4 v7, s[12:15], s3 offen  lds
  ds_read_b64_tr_b16 a[72:73], v82 offset:16384
  ds_read_b64_tr_b16 a[74:75], v82 offset:18432
  s_add_u32 m0, s36, 10240
  s_add_u32 s3, s37, 57344
  buffer_load_dwordx4 v7, s[12:15], s3 offen  lds
  ds_read_b64_tr_b16 a[76:77], v83 offset:16384
  ds_read_b64_tr_b16 a[78:79], v83 offset:18432
  s_add_u32 m0, s36, 11264
  s_add_u32 s3, s37, 86016
  buffer_load_dwordx4 v7, s[12:15], s3 offen  lds
  s_waitcnt vmcnt(28) lgkmcnt(7)
  ds_read_b64_tr_b16 a[80:81], v80 offset:20480
  ds_read_b64_tr_b16 a[82:83], v80 offset:22528
  s_mul_i32 s37, s34, 114688
  s_add_u32 s37, s37, s41
  s_add_u32 s34, s34, 1
  s_cmp_eq_u32 s34, 16
  s_cselect_b32 s34, 0, s34
  s_add_u32 m0, s36, 12288
  s_add_u32 s3, s37, 0
  buffer_load_dwordx4 v7, s[12:15], s3 offen  lds
  ds_read_b64_tr_b16 a[84:85], v81 offset:20480
  ds_read_b64_tr_b16 a[86:87], v81 offset:22528
  s_add_u32 m0, s36, 13312
  s_add_u32 s3, s37, 28672
  buffer_load_dwordx4 v7, s[12:15], s3 offen  lds
  ds_read_b64_tr_b16 a[88:89], v82 offset:20480
  ds_read_b64_tr_b16 a[90:91], v82 offset:22528
  s_add_u32 m0, s36, 14336
  s_add_u32 s3, s37, 57344
  buffer_load_dwordx4 v7, s[12:15], s3 offen  lds
  ds_read_b64_tr_b16 a[92:93], v83 offset:20480
  ds_read_b64_tr_b16 a[94:95], v83 offset:22528
  s_add_u32 m0, s36, 15360
  s_add_u32 s3, s37, 86016
  buffer_load_dwordx4 v7, s[12:15], s3 offen  lds
  s_waitcnt vmcnt(28) lgkmcnt(7)
  ds_read_b64_tr_b16 a[96:97], v80 offset:24576
  ds_read_b64_tr_b16 a[98:99], v80 offset:26624
  s_mul_i32 s37, s34, 114688
  s_add_u32 s37, s37, s41
  s_add_u32 s34, s34, 1
  s_cmp_eq_u32 s34, 16
  s_cselect_b32 s34, 0, s34
  s_add_u32 m0, s36, 16384
  s_add_u32 s3, s37, 0
  buffer_load_dwordx4 v7, s[12:15], s3 offen  lds
  ds_read_b64_tr_b16 a[100:101], v81 offset:24576
  ds_read_b64_tr_b16 a[102:103], v81 offset:26624
  s_add_u32 m0, s36, 17408
  s_add_u32 s3, s37, 28672
  buffer_load_dwordx4 v7, s[12:15], s3 offen  lds
  ds_read_b64_tr_b16 a[104:105], v82 offset:24576
  ds_read_b64_tr_b16 a[106:107], v82 offset:26624
  s_add_u32 m0, s36, 18432
  s_add_u32 s3, s37, 57344
  buffer_load_dwordx4 v7, s[12:15], s3 offen  lds
  ds_read_b64_tr_b16 a[108:109], v83 offset:24576
  ds_read_b64_tr_b16 a[110:111], v83 offset:26624
  s_add_u32 m0, s36, 19456
  s_add_u32 s3, s37, 86016
  buffer_load_dwordx4 v7, s[12:15], s3 offen  lds
  s_waitcnt vmcnt(28) lgkmcnt(7)
  ds_read_b64_tr_b16 a[112:113], v80 offset:28672
  ds_read_b64_tr_b16 a[114:115], v80 offset:30720
  s_mul_i32 s37, s34, 114688
  s_add_u32 s37, s37, s41
  s_add_u32 s34, s34, 1
  s_cmp_eq_u32 s34, 16
  s_cselect_b32 s34, 0, s34
  s_add_u32 m0, s36, 20480
  s_add_u32 s3, s37, 0
  buffer_load_dwordx4 v7, s[12:15], s3 offen  lds
  ds_read_b64_tr_b16 a[116:117], v81 offset:28672
  ds_read_b64_tr_b16 a[118:119], v81 offset:30720
  s_add_u32 m0, s36, 21504
  s_add_u32 s3, s37, 28672
  buffer_load_dwordx4 v7, s[12:15], s3 offen  lds
  ds_read_b64_tr_b16 a[120:121], v82 offset:28672
  ds_read_b64_tr_b16 a[122:123], v82 offset:30720
  s_add_u32 m0, s36, 22528
  s_add_u32 s3, s37, 57344
  buffer_load_dwordx4 v7, s[12:15], s3 offen  lds
  ds_read_b64_tr_b16 a[124:125], v83 offset:28672
  ds_read_b64_tr_b16 a[126:127], v83 offset:30720
  s_add_u32 m0, s36, 23552
  s_add_u32 s3, s37, 86016
  buffer_load_dwordx4 v7, s[12:15], s3 offen  lds
  s_waitcnt vmcnt(28) lgkmcnt(7)
  ds_read_b64_tr_b16 a[128:129], v80 offset:32768
  ds_read_b64_tr_b16 a[130:131], v80 offset:34816
  ds_read_b64_tr_b16 a[132:133], v81 offset:32768
  ds_read_b64_tr_b16 a[134:135], v81 offset:34816
  ds_read_b64_tr_b16 a[136:137], v82 offset:32768
  ds_read_b64_tr_b16 a[138:139], v82 offset:34816
  ds_read_b64_tr_b16 a[140:141], v83 offset:32768
  ds_read_b64_tr_b16 a[142:143], v83 offset:34816
  s_waitcnt vmcnt(24) lgkmcnt(7)
  ds_read_b64_tr_b16 a[144:145], v80 offset:36864
  ds_read_b64_tr_b16 a[146:147], v80 offset:38912
  ds_read_b64_tr_b16 a[148:149], v81 offset:36864
  ds_read_b64_tr_b16 a[150:151], v81 offset:38912
  ds_read_b64_tr_b16 a[152:153], v82 offset:36864
  ds_read_b64_tr_b16 a[154:155], v82 offset:38912
  ds_read_b64_tr_b16 a[156:157], v83 offset:36864
  ds_read_b64_tr_b16 a[158:159], v83 offset:38912
  s_waitcnt vmcnt(20) lgkmcnt(7)
  ds_read_b64_tr_b16 a[160:161], v80 offset:0
  ds_read_b64_tr_b16 a[162:163], v80 offset:2048
  ds_read_b64_tr_b16 a[164:165], v81 offset:0
  ds_read_b64_tr_b16 a[166:167], v81 offset:2048
  ds_read_b64_tr_b16 a[168:169], v82 offset:0
  ds_read_b64_tr_b16 a[170:171], v82 offset:2048
  ds_read_b64_tr_b16 a[172:173], v83 offset:0
  ds_read_b64_tr_b16 a[174:175], v83 offset:2048
  s_waitcnt vmcnt(16) lgkmcnt(7)
  ds_read_b64_tr_b16 a[176:177], v80 offset:4096
  ds_read_b64_tr_b16 a[178:179], v80 offset:6144
  ds_read_b64_tr_b16 a[180:181], v81 offset:4096
  ds_read_b64_tr_b16 a[182:183], v81 offset:6144
  ds_read_b64_tr_b16 a[184:185], v82 offset:4096
  ds_read_b64_tr_b16 a[186:187], v82 offset:6144
  ds_read_b64_tr_b16 a[188:189], v83 offset:4096
  ds_read_b64_tr_b16 a[190:191], v83 offset:6144
  s_waitcnt vmcnt(12) lgkmcnt(7)
  ds_read_b64_tr_b16 a[192:193], v80 offset:8192
  ds_read_b64_tr_b16 a[194:195], v80 offset:10240
  ds_read_b64_tr_b16 a[196:197], v81 offset:8192
  ds_read_b64_tr_b16 a[198:199], v81 offset:10240
  ds_read_b64_tr_b16 a[200:201], v82 offset:8192
  ds_read_b64_tr_b16 a[202:203], v82 offset:10240
  ds_read_b64_tr_b16 a[204:205], v83 offset:8192
  ds_read_b64_tr_b16 a[206:207], v83 offset:10240
  s_waitcnt vmcnt(8) lgkmcnt(7)
  ds_read_b64_tr_b16 a[208:209], v80 offset:12288
  ds_read_b64_tr_b16 a[210:211], v80 offset:14336
  ds_read_b64_tr_b16 a[212:213], v81 offset:12288
  ds_read_b64_tr_b16 a[214:215], v81 offset:14336
  ds_read_b64_tr_b16 a[216:217], v82 offset:12288
  ds_read_b64_tr_b16 a[218:219], v82 offset:14336
  ds_read_b64_tr_b16 a[220:221], v83 offset:12288
  ds_read_b64_tr_b16 a[222:223], v83 offset:14336
  s_waitcnt vmcnt(4) lgkmcnt(7)
  ds_read_b64_tr_b16 a[224:225], v80 offset:16384
  ds_read_b64_tr_b16 a[226:227], v80 offset:18432
  ds_read_b64_tr_b16 a[228:229], v81 offset:16384
  ds_read_b64_tr_b16 a[230:231], v81 offset:18432
  ds_read_b64_tr_b16 a[232:233], v82 offset:16384
  ds_read_b64_tr_b16 a[234:235], v82 offset:18432
  ds_read_b64_tr_b16 a[236:237], v83 offset:16384
  ds_read_b64_tr_b16 a[238:239], v83 offset:18432
  s_waitcnt vmcnt(0) lgkmcnt(7)
  ds_read_b64_tr_b16 a[240:241], v80 offset:20480
  ds_read_b64_tr_b16 a[242:243], v80 offset:22528
  ds_read_b64_tr_b16 a[244:245], v81 offset:20480
  ds_read_b64_tr_b16 a[246:247], v81 offset:22528
  ds_read_b64_tr_b16 a[248:249], v82 offset:20480
  ds_read_b64_tr_b16 a[250:251], v82 offset:22528
  ds_read_b64_tr_b16 a[252:253], v83 offset:20480
  ds_read_b64_tr_b16 a[254:255], v83 offset:22528
  s_waitcnt lgkmcnt(0)
  v_mov_b32 v4, 6
  v_lshlrev_b32 v4, 2, v4
init_14:
  buffer_load_dword v5, v4, s[52:55], 0 offen offset:132 sc1
  s_add_u32 s44, s44, 1
  s_cmp_gt_u32 s44, 400000
  s_cbranch_scc1 init_14x
  s_waitcnt vmcnt(0)
  v_cmp_gt_u32 vcc, 32, v5
  s_cbranch_vccz init_14x
  s_sleep 8
  s_branch init_14
init_14x:
  s_waitcnt vmcnt(0)
  v_min_u32 v5, 55, v0
  v_lshlrev_b32 v5, 4, v5
  v_add_u32 v5, 598016, v5
  v_cmp_le_u32 vcc, 32, v0
  s_nop 1
  v_cndmask_b32 v12, 0, 0, vcc
  v_cmp_le_u32 vcc, 48, v0
  s_nop 1
  v_cndmask_b32 v12, v12, 1, vcc
W_spin_15:
  buffer_load_dwordx4 v[8:11], v5, s[8:11], 0 offen sc1
W_spin_15h:
  s_add_u32 s44, s44, 1
  s_cmp_gt_u32 s44, 400000
  s_cbranch_scc1 W_spin_15x
  s_waitcnt vmcnt(0)
  v_min3_u32 v8, v8, v9, v10
  v_min_u32 v8, v8, v11
  v_cmp_gt_u32 vcc, v12, v8
  s_cbranch_vccz W_spin_15x
  s_sleep 8
  s_branch W_spin_15
W_spin_15x:
  s_waitcnt vmcnt(0)
  s_mul_i32 s34, s38, 16
  s_lshr_b32 s34, s34, 3
  s_mul_i32 s37, s34, 32768
  s_add_u32 s37, s37, s40
  s_add_u32 s34, s34, 1
  s_cmp_eq_u32 s34, 16
  s_cselect_b32 s34, 0, s34
  s_add_u32 m0, s36, 0
  s_add_u32 s3, s37, 0
  buffer_load_dwordx4 v6, s[8:11], s3 offen sc1 lds
  s_add_u32 m0, s36, 1024
  s_add_u32 s3, s37, 8192
  buffer_load_dwordx4 v6, s[8:11], s3 offen sc1 lds
  s_add_u32 m0, s36, 2048
  s_add_u32 s3, s37, 16384
  buffer_load_dwordx4 v6, s[8:11], s3 offen sc1 lds
  s_add_u32 m0, s36, 3072
  s_add_u32 s3, s37, 24576
  buffer_load_dwordx4 v6, s[8:11], s3 offen sc1 lds
  s_mul_i32 s37, s34, 32768
  s_add_u32 s37, s37, s40
  s_add_u32 s34, s34, 1
  s_cmp_eq_u32 s34, 16
  s_cselect_b32 s34, 0, s34
  s_add_u32 m0, s36, 4096
  s_add_u32 s3, s37, 0
  buffer_load_dwordx4 v6, s[8:11], s3 offen sc1 lds
  s_add_u32 m0, s36, 5120
  s_add_u32 s3, s37, 8192
  buffer_load_dwordx4 v6, s[8:11], s3 offen sc1 lds
  s_add_u32 m0, s36, 6144
  s_add_u32 s3, s37, 16384
  buffer_load_dwordx4 v6, s[8:11], s3 offen sc1 lds
  s_add_u32 m0, s36, 7168
  s_add_u32 s3, s37, 24576
  buffer_load_dwordx4 v6, s[8:11], s3 offen sc1 lds
  s_mul_i32 s37, s34, 32768
  s_add_u32 s37, s37, s40
  s_add_u32 s34, s34, 1
  s_cmp_eq_u32 s34, 16
  s_cselect_b32 s34, 0, s34
  s_add_u32 m0, s36, 8192
  s_add_u32 s3, s37, 0
  buffer_load_dwordx4 v6, s[8:11], s3 offen sc1 lds
  s_add_u32 m0, s36, 9216
  s_add_u32 s3, s37, 8192
  buffer_load_dwordx4 v6, s[8:11], s3 offen sc1 lds
  s_add_u32 m0, s36, 10240
  s_add_u32 s3, s37, 16384
  buffer_load_dwordx4 v6, s[8:11], s3 offen sc1 lds
  s_add_u32 m0, s36, 11264
  s_add_u32 s3, s37, 24576
  buffer_load_dwordx4 v6, s[8:11], s3 offen sc1 lds
  s_mul_i32 s37, s34, 32768
  s_add_u32 s37, s37, s40
  s_add_u32 s34, s34, 1
  s_cmp_eq_u32 s34, 16
  s_cselect_b32 s34, 0, s34
  s_add_u32 m0, s36, 12288
  s_add_u32 s3, s37, 0
  buffer_load_dwordx4 v6, s[8:11], s3 offen sc1 lds
  s_add_u32 m0, s36, 13312
  s_add_u32 s3, s37, 8192
  buffer_load_dwordx4 v6, s[8:11], s3 offen sc1 lds
  s_add_u32 m0, s36, 14336
  s_add_u32 s3, s37, 16384
  buffer_load_dwordx4 v6, s[8:11], s3 offen sc1 lds
  s_add_u32 m0, s36, 15360
  s_add_u32 s3, s37, 24576
  buffer_load_dwordx4 v6, s[8:11], s3 offen sc1 lds
  s_mul_i32 s37, s34, 32768
  s_add_u32 s37, s37, s40
  s_add_u32 s34, s34, 1
  s_cmp_eq_u32 s34, 16
  s_cselect_b32 s34, 0, s34
  s_add_u32 m0, s36, 16384
  s_add_u32 s3, s37, 0
  buffer_load_dwordx4 v6, s[8:11], s3 offen sc1 lds
  s_add_u32 m0, s36, 17408
  s_add_u32 s3, s37, 8192
  buffer_load_dwordx4 v6, s[8:11], s3 offen sc1 lds
  s_add_u32 m0, s36, 18432
  s_add_u32 s3, s37, 16384
  buffer_load_dwordx4 v6, s[8:11], s3 offen sc1 lds
  s_add_u32 m0, s36, 19456
  s_add_u32 s3, s37, 24576
  buffer_load_dwordx4 v6, s[8:11], s3 offen sc1 lds
  s_mul_i32 s37, s34, 32768
  s_add_u32 s37, s37, s40
  s_add_u32 s34, s34, 1
  s_cmp_eq_u32 s34, 16
  s_cselect_b32 s34, 0, s34
  s_add_u32 m0, s36, 20480
  s_add_u32 s3, s37, 0
  buffer_load_dwordx4 v6, s[8:11], s3 offen sc1 lds
  s_add_u32 m0, s36, 21504
  s_add_u32 s3, s37, 8192
  buffer_load_dwordx4 v6, s[8:11], s3 offen sc1 lds
  s_add_u32 m0, s36, 22528
  s_add_u32 s3, s37, 16384
  buffer_load_dwordx4 v6, s[8:11], s3 offen sc1 lds
  s_add_u32 m0, s36, 23552
  s_add_u32 s3, s37, 24576
  buffer_load_dwordx4 v6, s[8:11], s3 offen sc1 lds
  s_mul_i32 s37, s34, 32768
  s_add_u32 s37, s37, s40
  s_add_u32 s34, s34, 1
  s_cmp_eq_u32 s34, 16
  s_cselect_b32 s34, 0, s34
  s_add_u32 m0, s36, 24576
  s_add_u32 s3, s37, 0
  buffer_load_dwordx4 v6, s[8:11], s3 offen sc1 lds
  s_add_u32 m0, s36, 25600
  s_add_u32 s3, s37, 8192
  buffer_load_dwordx4 v6, s[8:11], s3 offen sc1 lds
  s_add_u32 m0, s36, 26624
  s_add_u32 s3, s37, 16384
  buffer_load_dwordx4 v6, s[8:11], s3 offen sc1 lds
  s_add_u32 m0, s36, 27648
  s_add_u32 s3, s37, 24576
  buffer_load_dwordx4 v6, s[8:11], s3 offen sc1 lds
  s_mul_i32 s37, s34, 32768
  s_add_u32 s37, s37, s40
  s_add_u32 s34, s34, 1
  s_cmp_eq_u32 s34, 16
  s_cselect_b32 s34, 0, s34
  s_add_u32 m0, s36, 28672
  s_add_u32 s3, s37, 0
  buffer_load_dwordx4 v6, s[8:11], s3 offen sc1 lds
  s_add_u32 m0, s36, 29696
  s_add_u32 s3, s37, 8192
  buffer_load_dwordx4 v6, s[8:11], s3 offen sc1 lds
  s_add_u32 m0, s36, 30720
  s_add_u32 s3, s37, 16384
  buffer_load_dwordx4 v6, s[8:11], s3 offen sc1 lds
  s_add_u32 m0, s36, 31744
  s_add_u32 s3, s37, 24576
  buffer_load_dwordx4 v6, s[8:11], s3 offen sc1 lds
  s_waitcnt vmcnt(28)
  ds_read_b64_tr_b16 v[16:17], v80 offset:0
  ds_read_b64_tr_b16 v[18:19], v80 offset:2048
  ds_read_b64_tr_b16 v[20:21], v81 offset:0
  ds_read_b64_tr_b16 v[22:23], v81 offset:2048
  ds_read_b64_tr_b16 v[24:25], v82 offset:0
  ds_read_b64_tr_b16 v[26:27], v82 offset:2048
  ds_read_b64_tr_b16 v[28:29], v83 offset:0
  ds_read_b64_tr_b16 v[30:31], v83 offset:2048
  s_waitcnt lgkmcnt(0) vmcnt(24)
  v_mfma_f32_16x16x32_bf16 v[128:131], v[16:19], a[0:3], 0
  ds_read_b64_tr_b16 v[32:33], v80 offset:4096
  v_mfma_f32_16x16x32_bf16 v[144:147], v[16:19], a[4:7], 0
  ds_read_b64_tr_b16 v[34:35], v80 offset:6144
  v_mfma_f32_16x16x32_bf16 v[160:163], v[16:19], a[8:11], 0
  ds_read_b64_tr_b16 v[36:37], v81 offset:4096
  v_mfma_f32_16x16x32_bf16 v[176:179], v[16:19], a[12:15], 0
  ds_read_b64_tr_b16 v[38:39], v81 offset:6144
  v_mfma_f32_16x16x32_bf16 v[132:135], v[20:23], a[0:3], 0
  ds_read_b64_tr_b16 v[40:41], v82 offset:4096
  v_mfma_f32_16x16x32_bf16 v[148:151], v[20:23], a[4:7], 0
  ds_read_b64_tr_b16 v[42:43], v82 offset:6144
  v_mfma_f32_16x16x32_bf16 v[164:167], v[20:23], a[8:11], 0
  ds_read_b64_tr_b16 v[44:45], v83 offset:4096
  v_mfma_f32_16x16x32_bf16 v[180:183], v[20:23], a[12:15], 0
  ds_read_b64_tr_b16 v[46:47], v83 offset:6144
  v_mfma_f32_16x16x32_bf16 v[136:139], v[24:27], a[0:3], 0
  v_mfma_f32_16x16x32_bf16 v[152:155], v[24:27], a[4:7], 0
  s_mul_i32 s37, s34, 32768
  s_add_u32 s37, s37, s40
  s_add_u32 s34, s34, 1
  s_cmp_eq_u32 s34, 16
  s_cselect_b32 s34, 0, s34
  s_add_u32 m0, s36, 32768
  s_add_u32 s3, s37, 0
  buffer_load_dwordx4 v6, s[8:11], s3 offen sc1 lds
  v_mfma_f32_16x16x32_bf16 v[168:171], v[24:27], a[8:11], 0
  v_mfma_f32_16x16x32_bf16 v[184:187], v[24:27], a[12:15], 0
  s_add_u32 m0, s36, 33792
  s_add_u32 s3, s37, 8192
  buffer_load_dwordx4 v6, s[8:11], s3 offen sc1 lds
  v_mfma_f32_16x16x32_bf16 v[140:143], v[28:31], a[0:3], 0
  v_mfma_f32_16x16x32_bf16 v[156:159], v[28:31], a[4:7], 0
  s_add_u32 m0, s36, 34816
  s_add_u32 s3, s37, 16384
  buffer_load_dwordx4 v6, s[8:11], s3 offen sc1 lds
  v_mfma_f32_16x16x32_bf16 v[172:175], v[28:31], a[8:11], 0
  v_mfma_f32_16x16x32_bf16 v[188:191], v[28:31], a[12:15], 0
  s_add_u32 m0, s36, 35840
  s_add_u32 s3, s37, 24576
  buffer_load_dwordx4 v6, s[8:11], s3 offen sc1 lds
  s_waitcnt lgkmcnt(0) vmcnt(24)
  v_mfma_f32_16x16x32_bf16 v[128:131], v[32:35], a[16:19], v[128:131]
  ds_read_b64_tr_b16 v[16:17], v80 offset:8192
  v_mfma_f32_16x16x32_bf16 v[144:147], v[32:35], a[20:23], v[144:147]
  ds_read_b64_tr_b16 v[18:19], v80 offset:10240
  v_mfma_f32_16x16x32_bf16 v[160:163], v[32:35], a[24:27], v[160:163]
  ds_read_b64_tr_b16 v[20:21], v81 offset:8192
  v_mfma_f32_16x16x32_bf16 v[176:179], v[32:35], a[28:31], v[176:179]
  ds_read_b64_tr_b16 v[22:23], v81 offset:10240
  v_mfma_f32_16x16x32_bf16 v[132:135], v[36:39], a[16:19], v[132:135]
  ds_read_b64_tr_b16 v[24:25], v82 offset:8192
  v_mfma_f32_16x16x32_bf16 v[148:151], v[36:39], a[20:23], v[148:151]
  ds_read_b64_tr_b16 v[26:27], v82 offset:10240
  v_mfma_f32_16x16x32_bf16 v[164:167], v[36:39], a[24:27], v[164:167]
  ds_read_b64_tr_b16 v[28:29], v83 offset:8192
  v_mfma_f32_16x16x32_bf16 v[180:183], v[36:39], a[28:31], v[180:183]
  ds_read_b64_tr_b16 v[30:31], v83 offset:10240
  v_mfma_f32_16x16x32_bf16 v[136:139], v[40:43], a[16:19], v[136:139]
  v_mfma_f32_16x16x32_bf16 v[152:155], v[40:43], a[20:23], v[152:155]
  s_mul_i32 s37, s34, 32768
  s_add_u32 s37, s37, s40
  s_add_u32 s34, s34, 1
  s_cmp_eq_u32 s34, 16
  s_cselect_b32 s34, 0, s34
  s_add_u32 m0, s36, 36864
  s_add_u32 s3, s37, 0
  buffer_load_dwordx4 v6, s[8:11], s3 offen sc1 lds
  v_mfma_f32_16x16x32_bf16 v[168:171], v[40:43], a[24:27], v[168:171]
  v_mfma_f32_16x16x32_bf16 v[184:187], v[40:43], a[28:31], v[184:187]
  s_add_u32 m0, s36, 37888
  s_add_u32 s3, s37, 8192
  buffer_load_dwordx4 v6, s[8:11], s3 offen sc1 lds
  v_mfma_f32_16x16x32_bf16 v[140:143], v[44:47], a[16:19], v[140:143]
  v_mfma_f32_16x16x32_bf16 v[156:159], v[44:47], a[20:23], v[156:159]
  s_add_u32 m0, s36, 38912
  s_add_u32 s3, s37, 16384
  buffer_load_dwordx4 v6, s[8:11], s3 offen sc1 lds
  v_mfma_f32_16x16x32_bf16 v[172:175], v[44:47], a[24:27], v[172:175]
  v_mfma_f32_16x16x32_bf16 v[188:191], v[44:47], a[28:31], v[188:191]
  s_add_u32 m0, s36, 39936
  s_add_u32 s3, s37, 24576
  buffer_load_dwordx4 v6, s[8:11], s3 offen sc1 lds
  s_waitcnt lgkmcnt(0) vmcnt(24)
  v_mfma_f32_16x16x32_bf16 v[128:131], v[16:19], a[32:35], v[128:131]
  ds_read_b64_tr_b16 v[32:33], v80 offset:12288
  v_mfma_f32_16x16x32_bf16 v[144:147], v[16:19], a[36:39], v[144:147]
  ds_read_b64_tr_b16 v[34:35], v80 offset:14336
  v_mfma_f32_16x16x32_bf16 v[160:163], v[16:19], a[40:43], v[160:163]
  ds_read_b64_tr_b16 v[36:37], v81 offset:12288
  v_mfma_f32_16x16x32_bf16 v[176:179], v[16:19], a[44:47], v[176:179]
  ds_read_b64_tr_b16 v[38:39], v81 offset:14336
  v_mfma_f32_16x16x32_bf16 v[132:135], v[20:23], a[32:35], v[132:135]
  ds_read_b64_tr_b16 v[40:41], v82 offset:12288
  v_mfma_f32_16x16x32_bf16 v[148:151], v[20:23], a[36:39], v[148:151]
  ds_read_b64_tr_b16 v[42:43], v82 offset:14336
  v_mfma_f32_16x16x32_bf16 v[164:167], v[20:23], a[40:43], v[164:167]
  ds_read_b64_tr_b16 v[44:45], v83 offset:12288
  v_mfma_f32_16x16x32_bf16 v[180:183], v[20:23], a[44:47], v[180:183]
  ds_read_b64_tr_b16 v[46:47], v83 offset:14336
  v_mfma_f32_16x16x32_bf16 v[136:139], v[24:27], a[32:35], v[136:139]
  v_mfma_f32_16x16x32_bf16 v[152:155], v[24:27], a[36:39], v[152:155]
  s_mul_i32 s37, s34, 32768
  s_add_u32 s37, s37, s40
  s_add_u32 s34, s34, 1
  s_cmp_eq_u32 s34, 16
  s_cselect_b32 s34, 0, s34
  s_add_u32 m0, s36, 0
  s_add_u32 s3, s37, 0
  buffer_load_dwordx4 v6, s[8:11], s3 offen sc1 lds
  v_mfma_f32_16x16x32_bf16 v[168:171], v[24:27], a[40:43], v[168:171]
  v_mfma_f32_16x16x32_bf16 v[184:187], v[24:27], a[44:47], v[184:187]
  s_add_u32 m0, s36, 1024
  s_add_u32 s3, s37, 8192
  buffer_load_dwordx4 v6, s[8:11], s3 offen sc1 lds
  v_mfma_f32_16x16x32_bf16 v[140:143], v[28:31], a[32:35], v[140:143]
  v_mfma_f32_16x16x32_bf16 v[156:159], v[28:31], a[36:39], v[156:159]
  s_add_u32 m0, s36, 2048
  s_add_u32 s3, s37, 16384
  buffer_load_dwordx4 v6, s[8:11], s3 offen sc1 lds
  v_mfma_f32_16x16x32_bf16 v[172:175], v[28:31], a[40:43], v[172:175]
  v_mfma_f32_16x16x32_bf16 v[188:191], v[28:31], a[44:47], v[188:191]
  s_add_u32 m0, s36, 3072
  s_add_u32 s3, s37, 24576
  buffer_load_dwordx4 v6, s[8:11], s3 offen sc1 lds
  s_waitcnt lgkmcnt(0) vmcnt(24)
  v_mfma_f32_16x16x32_bf16 v[128:131], v[32:35], a[48:51], v[128:131]
  ds_read_b64_tr_b16 v[16:17], v80 offset:16384
  v_mfma_f32_16x16x32_bf16 v[144:147], v[32:35], a[52:55], v[144:147]
  ds_read_b64_tr_b16 v[18:19], v80 offset:18432
  v_mfma_f32_16x16x32_bf16 v[160:163], v[32:35], a[56:59], v[160:163]
  ds_read_b64_tr_b16 v[20:21], v81 offset:16384
  v_mfma_f32_16x16x32_bf16 v[176:179], v[32:35], a[60:63], v[176:179]
  ds_read_b64_tr_b16 v[22:23], v81 offset:18432
  v_mfma_f32_16x16x32_bf16 v[132:135], v[36:39], a[48:51], v[132:135]
  ds_read_b64_tr_b16 v[24:25], v82 offset:16384
  v_mfma_f32_16x16x32_bf16 v[148:151], v[36:39], a[52:55], v[148:151]
  ds_read_b64_tr_b16 v[26:27], v82 offset:18432
  v_mfma_f32_16x16x32_bf16 v[164:167], v[36:39], a[56:59], v[164:167]
  ds_read_b64_tr_b16 v[28:29], v83 offset:16384
  v_mfma_f32_16x16x32_bf16 v[180:183], v[36:39], a[60:63], v[180:183]
  ds_read_b64_tr_b16 v[30:31], v83 offset:18432
  v_mfma_f32_16x16x32_bf16 v[136:139], v[40:43], a[48:51], v[136:139]
  v_mfma_f32_16x16x32_bf16 v[152:155], v[40:43], a[52:55], v[152:155]
  s_mul_i32 s37, s34, 32768
  s_add_u32 s37, s37, s40
  s_add_u32 s34, s34, 1
  s_cmp_eq_u32 s34, 16
  s_cselect_b32 s34, 0, s34
  s_add_u32 m0, s36, 4096
  s_add_u32 s3, s37, 0
  buffer_load_dwordx4 v6, s[8:11], s3 offen sc1 lds
  v_mfma_f32_16x16x32_bf16 v[168:171], v[40:43], a[56:59], v[168:171]
  v_mfma_f32_16x16x32_bf16 v[184:187], v[40:43], a[60:63], v[184:187]
  s_add_u32 m0, s36, 5120
  s_add_u32 s3, s37, 8192
  buffer_load_dwordx4 v6, s[8:11], s3 offen sc1 lds
  v_mfma_f32_16x16x32_bf16 v[140:143], v[44:47], a[48:51], v[140:143]
  v_mfma_f32_16x16x32_bf16 v[156:159], v[44:47], a[52:55], v[156:159]
  s_add_u32 m0, s36, 6144
  s_add_u32 s3, s37, 16384
  buffer_load_dwordx4 v6, s[8:11], s3 offen sc1 lds
  v_mfma_f32_16x16x32_bf16 v[172:175], v[44:47], a[56:59], v[172:175]
  v_mfma_f32_16x16x32_bf16 v[188:191], v[44:47], a[60:63], v[188:191]
  s_add_u32 m0, s36, 7168
  s_add_u32 s3, s37, 24576
  buffer_load_dwordx4 v6, s[8:11], s3 offen sc1 lds
  s_waitcnt lgkmcnt(0) vmcnt(24)
  v_mfma_f32_16x16x32_bf16 v[128:131], v[16:19], a[64:67], v[128:131]
  ds_read_b64_tr_b16 v[32:33], v80 offset:20480
  v_mfma_f32_16x16x32_bf16 v[144:147], v[16:19], a[68:71], v[144:147]
  ds_read_b64_tr_b16 v[34:35], v80 offset:22528
  v_mfma_f32_16x16x32_bf16 v[160:163], v[16:19], a[72:75], v[160:163]
  ds_read_b64_tr_b16 v[36:37], v81 offset:20480
  v_mfma_f32_16x16x32_bf16 v[176:179], v[16:19], a[76:79], v[176:179]
  ds_read_b64_tr_b16 v[38:39], v81 offset:22528
  v_mfma_f32_16x16x32_bf16 v[132:135], v[20:23], a[64:67], v[132:135]
  ds_read_b64_tr_b16 v[40:41], v82 offset:20480
  v_mfma_f32_16x16x32_bf16 v[148:151], v[20:23], a[68:71], v[148:151]
  ds_read_b64_tr_b16 v[42:43], v82 offset:22528
  v_mfma_f32_16x16x32_bf16 v[164:167], v[20:23], a[72:75], v[164:167]
  ds_read_b64_tr_b16 v[44:45], v83 offset:20480
  v_mfma_f32_16x16x32_bf16 v[180:183], v[20:23], a[76:79], v[180:183]
  ds_read_b64_tr_b16 v[46:47], v83 offset:22528
  v_mfma_f32_16x16x32_bf16 v[136:139], v[24:27], a[64:67], v[136:139]
  v_mfma_f32_16x16x32_bf16 v[152:155], v[24:27], a[68:71], v[152:155]
  s_mul_i32 s37, s34, 32768
  s_add_u32 s37, s37, s40
  s_add_u32 s34, s34, 1
  s_cmp_eq_u32 s34, 16
  s_cselect_b32 s34, 0, s34
  s_add_u32 m0, s36, 8192
  s_add_u32 s3, s37, 0
  buffer_load_dwordx4 v6, s[8:11], s3 offen sc1 lds
  v_mfma_f32_16x16x32_bf16 v[168:171], v[24:27], a[72:75], v[168:171]
  v_mfma_f32_16x16x32_bf16 v[184:187], v[24:27], a[76:79], v[184:187]
  s_add_u32 m0, s36, 9216
  s_add_u32 s3, s37, 8192
  buffer_load_dwordx4 v6, s[8:11], s3 offen sc1 lds
  v_mfma_f32_16x16x32_bf16 v[140:143], v[28:31], a[64:67], v[140:143]
  v_mfma_f32_16x16x32_bf16 v[156:159], v[28:31], a[68:71], v[156:159]
  s_add_u32 m0, s36, 10240
  s_add_u32 s3, s37, 16384
  buffer_load_dwordx4 v6, s[8:11], s3 offen sc1 lds
  v_mfma_f32_16x16x32_bf16 v[172:175], v[28:31], a[72:75], v[172:175]
  v_mfma_f32_16x16x32_bf16 v[188:191], v[28:31], a[76:79], v[188:191]
  s_add_u32 m0, s36, 11264
  s_add_u32 s3, s37, 24576
  buffer_load_dwordx4 v6, s[8:11], s3 offen sc1 lds
  s_waitcnt lgkmcnt(0) vmcnt(24)
  v_mfma_f32_16x16x32_bf16 v[128:131], v[32:35], a[80:83], v[128:131]
  ds_read_b64_tr_b16 v[16:17], v80 offset:24576
  v_mfma_f32_16x16x32_bf16 v[144:147], v[32:35], a[84:87], v[144:147]
  ds_read_b64_tr_b16 v[18:19], v80 offset:26624
  v_mfma_f32_16x16x32_bf16 v[160:163], v[32:35], a[88:91], v[160:163]
  ds_read_b64_tr_b16 v[20:21], v81 offset:24576
  v_mfma_f32_16x16x32_bf16 v[176:179], v[32:35], a[92:95], v[176:179]
  ds_read_b64_tr_b16 v[22:23], v81 offset:26624
  v_mfma_f32_16x16x32_bf16 v[132:135], v[36:39], a[80:83], v[132:135]
  ds_read_b64_tr_b16 v[24:25], v82 offset:24576
  v_mfma_f32_16x16x32_bf16 v[148:151], v[36:39], a[84:87], v[148:151]
  ds_read_b64_tr_b16 v[26:27], v82 offset:26624
  v_mfma_f32_16x16x32_bf16 v[164:167], v[36:39], a[88:91], v[164:167]
  ds_read_b64_tr_b16 v[28:29], v83 offset:24576
  v_mfma_f32_16x16x32_bf16 v[180:183], v[36:39], a[92:95], v[180:183]
  ds_read_b64_tr_b16 v[30:31], v83 offset:26624
  v_mfma_f32_16x16x32_bf16 v[136:139], v[40:43], a[80:83], v[136:139]
  v_mfma_f32_16x16x32_bf16 v[152:155], v[40:43], a[84:87], v[152:155]
  s_mul_i32 s37, s34, 32768
  s_add_u32 s37, s37, s40
  s_add_u32 s34, s34, 1
  s_cmp_eq_u32 s34, 16
  s_cselect_b32 s34, 0, s34
  s_add_u32 m0, s36, 12288
  s_add_u32 s3, s37, 0
  buffer_load_dwordx4 v6, s[8:11], s3 offen sc1 lds
  v_mfma_f32_16x16x32_bf16 v[168:171], v[40:43], a[88:91], v[168:171]
  v_mfma_f32_16x16x32_bf16 v[184:187], v[40:43], a[92:95], v[184:187]
  s_add_u32 m0, s36, 13312
  s_add_u32 s3, s37, 8192
  buffer_load_dwordx4 v6, s[8:11], s3 offen sc1 lds
  v_mfma_f32_16x16x32_bf16 v[140:143], v[44:47], a[80:83], v[140:143]
  v_mfma_f32_16x16x32_bf16 v[156:159], v[44:47], a[84:87], v[156:159]
  s_add_u32 m0, s36, 14336
  s_add_u32 s3, s37, 16384
  buffer_load_dwordx4 v6, s[8:11], s3 offen sc1 lds
  v_mfma_f32_16x16x32_bf16 v[172:175], v[44:47], a[88:91], v[172:175]
  v_mfma_f32_16x16x32_bf16 v[188:191], v[44:47], a[92:95], v[188:191]
  s_add_u32 m0, s36, 15360
  s_add_u32 s3, s37, 24576
  buffer_load_dwordx4 v6, s[8:11], s3 offen sc1 lds
  s_waitcnt lgkmcnt(0) vmcnt(24)
  v_mfma_f32_16x16x32_bf16 v[128:131], v[16:19], a[96:99], v[128:131]
  ds_read_b64_tr_b16 v[32:33], v80 offset:28672
  v_mfma_f32_16x16x32_bf16 v[144:147], v[16:19], a[100:103], v[144:147]
  ds_read_b64_tr_b16 v[34:35], v80 offset:30720
  v_mfma_f32_16x16x32_bf16 v[160:163], v[16:19], a[104:107], v[160:163]
  ds_read_b64_tr_b16 v[36:37], v81 offset:28672
  v_mfma_f32_16x16x32_bf16 v[176:179], v[16:19], a[108:111], v[176:179]
  ds_read_b64_tr_b16 v[38:39], v81 offset:30720
  v_mfma_f32_16x16x32_bf16 v[132:135], v[20:23], a[96:99], v[132:135]
  ds_read_b64_tr_b16 v[40:41], v82 offset:28672
  v_mfma_f32_16x16x32_bf16 v[148:151], v[20:23], a[100:103], v[148:151]
  ds_read_b64_tr_b16 v[42:43], v82 offset:30720
  v_mfma_f32_16x16x32_bf16 v[164:167], v[20:23], a[104:107], v[164:167]
  ds_read_b64_tr_b16 v[44:45], v83 offset:28672
  v_mfma_f32_16x16x32_bf16 v[180:183], v[20:23], a[108:111], v[180:183]
  ds_read_b64_tr_b16 v[46:47], v83 offset:30720
  v_mfma_f32_16x16x32_bf16 v[136:139], v[24:27], a[96:99], v[136:139]
  v_mfma_f32_16x16x32_bf16 v[152:155], v[24:27], a[100:103], v[152:155]
  s_mul_i32 s37, s34, 32768
  s_add_u32 s37, s37, s40
  s_add_u32 s34, s34, 1
  s_cmp_eq_u32 s34, 16
  s_cselect_b32 s34, 0, s34
  s_add_u32 m0, s36, 16384
  s_add_u32 s3, s37, 0
  buffer_load_dwordx4 v6, s[8:11], s3 offen sc1 lds
  v_mfma_f32_16x16x32_bf16 v[168:171], v[24:27], a[104:107], v[168:171]
  v_mfma_f32_16x16x32_bf16 v[184:187], v[24:27], a[108:111], v[184:187]
  s_add_u32 m0, s36, 17408
  s_add_u32 s3, s37, 8192
  buffer_load_dwordx4 v6, s[8:11], s3 offen sc1 lds
  v_mfma_f32_16x16x32_bf16 v[140:143], v[28:31], a[96:99], v[140:143]
  v_mfma_f32_16x16x32_bf16 v[156:159], v[28:31], a[100:103], v[156:159]
  s_add_u32 m0, s36, 18432
  s_add_u32 s3, s37, 16384
  buffer_load_dwordx4 v6, s[8:11], s3 offen sc1 lds
  v_mfma_f32_16x16x32_bf16 v[172:175], v[28:31], a[104:107], v[172:175]
  v_mfma_f32_16x16x32_bf16 v[188:191], v[28:31], a[108:111], v[188:191]
  s_add_u32 m0, s36, 19456
  s_add_u32 s3, s37, 24576
  buffer_load_dwordx4 v6, s[8:11], s3 offen sc1 lds
  s_waitcnt lgkmcnt(0) vmcnt(24)
  v_mfma_f32_16x16x32_bf16 v[128:131], v[32:35], a[112:115], v[128:131]
  ds_read_b64_tr_b16 v[16:17], v80 offset:32768
  v_mfma_f32_16x16x32_bf16 v[144:147], v[32:35], a[116:119], v[144:147]
  ds_read_b64_tr_b16 v[18:19], v80 offset:34816
  v_mfma_f32_16x16x32_bf16 v[160:163], v[32:35], a[120:123], v[160:163]
  ds_read_b64_tr_b16 v[20:21], v81 offset:32768
  v_mfma_f32_16x16x32_bf16 v[176:179], v[32:35], a[124:127], v[176:179]
  ds_read_b64_tr_b16 v[22:23], v81 offset:34816
  v_mfma_f32_16x16x32_bf16 v[132:135], v[36:39], a[112:115], v[132:135]
  ds_read_b64_tr_b16 v[24:25], v82 offset:32768
  v_mfma_f32_16x16x32_bf16 v[148:151], v[36:39], a[116:119], v[148:151]
  ds_read_b64_tr_b16 v[26:27], v82 offset:34816
  v_mfma_f32_16x16x32_bf16 v[164:167], v[36:39], a[120:123], v[164:167]
  ds_read_b64_tr_b16 v[28:29], v83 offset:32768
  v_mfma_f32_16x16x32_bf16 v[180:183], v[36:39], a[124:127], v[180:183]
  ds_read_b64_tr_b16 v[30:31], v83 offset:34816
  v_mfma_f32_16x16x32_bf16 v[136:139], v[40:43], a[112:115], v[136:139]
  v_mfma_f32_16x16x32_bf16 v[152:155], v[40:43], a[116:119], v[152:155]
  s_mul_i32 s37, s34, 32768
  s_add_u32 s37, s37, s40
  s_add_u32 s34, s34, 1
  s_cmp_eq_u32 s34, 16
  s_cselect_b32 s34, 0, s34
  s_add_u32 m0, s36, 20480
  s_add_u32 s3, s37, 0
  buffer_load_dwordx4 v6, s[8:11], s3 offen sc1 lds
  v_mfma_f32_16x16x32_bf16 v[168:171], v[40:43], a[120:123], v[168:171]
  v_mfma_f32_16x16x32_bf16 v[184:187], v[40:43], a[124:127], v[184:187]
  s_add_u32 m0, s36, 21504
  s_add_u32 s3, s37, 8192
  buffer_load_dwordx4 v6, s[8:11], s3 offen sc1 lds
  v_mfma_f32_16x16x32_bf16 v[140:143], v[44:47], a[112:115], v[140:143]
  v_mfma_f32_16x16x32_bf16 v[156:159], v[44:47], a[116:119], v[156:159]
  s_add_u32 m0, s36, 22528
  s_add_u32 s3, s37, 16384
  buffer_load_dwordx4 v6, s[8:11], s3 offen sc1 lds
  v_mfma_f32_16x16x32_bf16 v[172:175], v[44:47], a[120:123], v[172:175]
  v_mfma_f32_16x16x32_bf16 v[188:191], v[44:47], a[124:127], v[188:191]
  s_add_u32 m0, s36, 23552
  s_add_u32 s3, s37, 24576
  buffer_load_dwordx4 v6, s[8:11], s3 offen sc1 lds
  s_waitcnt lgkmcnt(0) vmcnt(24)
  v_mfma_f32_16x16x32_bf16 v[128:131], v[16:19], a[128:131], v[128:131]
  ds_read_b64_tr_b16 v[32:33], v80 offset:36864
  v_mfma_f32_16x16x32_bf16 v[144:147], v[16:19], a[132:135], v[144:147]
  ds_read_b64_tr_b16 v[34:35], v80 offset:38912
  v_mfma_f32_16x16x32_bf16 v[160:163], v[16:19], a[136:139], v[160:163]
  ds_read_b64_tr_b16 v[36:37], v81 offset:36864
  v_mfma_f32_16x16x32_bf16 v[176:179], v[16:19], a[140:143], v[176:179]
  ds_read_b64_tr_b16 v[38:39], v81 offset:38912
  v_mfma_f32_16x16x32_bf16 v[132:135], v[20:23], a[128:131], v[132:135]
  ds_read_b64_tr_b16 v[40:41], v82 offset:36864
  v_mfma_f32_16x16x32_bf16 v[148:151], v[20:23], a[132:135], v[148:151]
  ds_read_b64_tr_b16 v[42:43], v82 offset:38912
  v_mfma_f32_16x16x32_bf16 v[164:167], v[20:23], a[136:139], v[164:167]
  ds_read_b64_tr_b16 v[44:45], v83 offset:36864
  v_mfma_f32_16x16x32_bf16 v[180:183], v[20:23], a[140:143], v[180:183]
  ds_read_b64_tr_b16 v[46:47], v83 offset:38912
  v_mfma_f32_16x16x32_bf16 v[136:139], v[24:27], a[128:131], v[136:139]
  v_mfma_f32_16x16x32_bf16 v[152:155], v[24:27], a[132:135], v[152:155]
  v_mfma_f32_16x16x32_bf16 v[168:171], v[24:27], a[136:139], v[168:171]
  v_mfma_f32_16x16x32_bf16 v[184:187], v[24:27], a[140:143], v[184:187]
  v_mfma_f32_16x16x32_bf16 v[140:143], v[28:31], a[128:131], v[140:143]
  v_mfma_f32_16x16x32_bf16 v[156:159], v[28:31], a[132:135], v[156:159]
  v_mfma_f32_16x16x32_bf16 v[172:175], v[28:31], a[136:139], v[172:175]
  v_mfma_f32_16x16x32_bf16 v[188:191], v[28:31], a[140:143], v[188:191]
  s_waitcnt lgkmcnt(0) vmcnt(20)
  v_mfma_f32_16x16x32_bf16 v[128:131], v[32:35], a[144:147], v[128:131]
  ds_read_b64_tr_b16 v[16:17], v80 offset:0
  v_mfma_f32_16x16x32_bf16 v[144:147], v[32:35], a[148:151], v[144:147]
  ds_read_b64_tr_b16 v[18:19], v80 offset:2048
  v_mfma_f32_16x16x32_bf16 v[160:163], v[32:35], a[152:155], v[160:163]
  ds_read_b64_tr_b16 v[20:21], v81 offset:0
  v_mfma_f32_16x16x32_bf16 v[176:179], v[32:35], a[156:159], v[176:179]
  ds_read_b64_tr_b16 v[22:23], v81 offset:2048
  v_mfma_f32_16x16x32_bf16 v[132:135], v[36:39], a[144:147], v[132:135]
  ds_read_b64_tr_b16 v[24:25], v82 offset:0
  v_mfma_f32_16x16x32_bf16 v[148:151], v[36:39], a[148:151], v[148:151]
  ds_read_b64_tr_b16 v[26:27], v82 offset:2048
  v_mfma_f32_16x16x32_bf16 v[164:167], v[36:39], a[152:155], v[164:167]
  ds_read_b64_tr_b16 v[28:29], v83 offset:0
  v_mfma_f32_16x16x32_bf16 v[180:183], v[36:39], a[156:159], v[180:183]
  ds_read_b64_tr_b16 v[30:31], v83 offset:2048
  v_mfma_f32_16x16x32_bf16 v[136:139], v[40:43], a[144:147], v[136:139]
  v_mfma_f32_16x16x32_bf16 v[152:155], v[40:43], a[148:151], v[152:155]
  v_mfma_f32_16x16x32_bf16 v[168:171], v[40:43], a[152:155], v[168:171]
  v_mfma_f32_16x16x32_bf16 v[184:187], v[40:43], a[156:159], v[184:187]
  v_mfma_f32_16x16x32_bf16 v[140:143], v[44:47], a[144:147], v[140:143]
  v_mfma_f32_16x16x32_bf16 v[156:159], v[44:47], a[148:151], v[156:159]
  v_mfma_f32_16x16x32_bf16 v[172:175], v[44:47], a[152:155], v[172:175]
  v_mfma_f32_16x16x32_bf16 v[188:191], v[44:47], a[156:159], v[188:191]
  s_waitcnt lgkmcnt(0) vmcnt(16)
  v_mfma_f32_16x16x32_bf16 v[128:131], v[16:19], a[160:163], v[128:131]
  ds_read_b64_tr_b16 v[32:33], v80 offset:4096
  v_mfma_f32_16x16x32_bf16 v[144:147], v[16:19], a[164:167], v[144:147]
  ds_read_b64_tr_b16 v[34:35], v80 offset:6144
  v_mfma_f32_16x16x32_bf16 v[160:163], v[16:19], a[168:171], v[160:163]
  ds_read_b64_tr_b16 v[36:37], v81 offset:4096
  v_mfma_f32_16x16x32_bf16 v[176:179], v[16:19], a[172:175], v[176:179]
  ds_read_b64_tr_b16 v[38:39], v81 offset:6144
  v_mfma_f32_16x16x32_bf16 v[132:135], v[20:23], a[160:163], v[132:135]
  ds_read_b64_tr_b16 v[40:41], v82 offset:4096
  v_mfma_f32_16x16x32_bf16 v[148:151], v[20:23], a[164:167], v[148:151]
  ds_read_b64_tr_b16 v[42:43], v82 offset:6144
  v_mfma_f32_16x16x32_bf16 v[164:167], v[20:23], a[168:171], v[164:167]
  ds_read_b64_tr_b16 v[44:45], v83 offset:4096
  v_mfma_f32_16x16x32_bf16 v[180:183], v[20:23], a[172:175], v[180:183]
  ds_read_b64_tr_b16 v[46:47], v83 offset:6144
  v_mfma_f32_16x16x32_bf16 v[136:139], v[24:27], a[160:163], v[136:139]
  v_mfma_f32_16x16x32_bf16 v[152:155], v[24:27], a[164:167], v[152:155]
  v_mfma_f32_16x16x32_bf16 v[168:171], v[24:27], a[168:171], v[168:171]
  v_mfma_f32_16x16x32_bf16 v[184:187], v[24:27], a[172:175], v[184:187]
  v_mfma_f32_16x16x32_bf16 v[140:143], v[28:31], a[160:163], v[140:143]
  v_mfma_f32_16x16x32_bf16 v[156:159], v[28:31], a[164:167], v[156:159]
  v_mfma_f32_16x16x32_bf16 v[172:175], v[28:31], a[168:171], v[172:175]
  v_mfma_f32_16x16x32_bf16 v[188:191], v[28:31], a[172:175], v[188:191]
  s_waitcnt lgkmcnt(0) vmcnt(12)
  v_mfma_f32_16x16x32_bf16 v[128:131], v[32:35], a[176:179], v[128:131]
  ds_read_b64_tr_b16 v[16:17], v80 offset:8192
  v_mfma_f32_16x16x32_bf16 v[144:147], v[32:35], a[180:183], v[144:147]
  ds_read_b64_tr_b16 v[18:19], v80 offset:10240
  v_mfma_f32_16x16x32_bf16 v[160:163], v[32:35], a[184:187], v[160:163]
  ds_read_b64_tr_b16 v[20:21], v81 offset:8192
  v_mfma_f32_16x16x32_bf16 v[176:179], v[32:35], a[188:191], v[176:179]
  ds_read_b64_tr_b16 v[22:23], v81 offset:10240
  v_mfma_f32_16x16x32_bf16 v[132:135], v[36:39], a[176:179], v[132:135]
  ds_read_b64_tr_b16 v[24:25], v82 offset:8192
  v_mfma_f32_16x16x32_bf16 v[148:151], v[36:39], a[180:183], v[148:151]
  ds_read_b64_tr_b16 v[26:27], v82 offset:10240
  v_mfma_f32_16x16x32_bf16 v[164:167], v[36:39], a[184:187], v[164:167]
  ds_read_b64_tr_b16 v[28:29], v83 offset:8192
  v_mfma_f32_16x16x32_bf16 v[180:183], v[36:39], a[188:191], v[180:183]
  ds_read_b64_tr_b16 v[30:31], v83 offset:10240
  v_mfma_f32_16x16x32_bf16 v[136:139], v[40:43], a[176:179], v[136:139]
  v_mfma_f32_16x16x32_bf16 v[152:155], v[40:43], a[180:183], v[152:155]
  v_mfma_f32_16x16x32_bf16 v[168:171], v[40:43], a[184:187], v[168:171]
  v_mfma_f32_16x16x32_bf16 v[184:187], v[40:43], a[188:191], v[184:187]
  v_mfma_f32_16x16x32_bf16 v[140:143], v[44:47], a[176:179], v[140:143]
  v_mfma_f32_16x16x32_bf16 v[156:159], v[44:47], a[180:183], v[156:159]
  v_mfma_f32_16x16x32_bf16 v[172:175], v[44:47], a[184:187], v[172:175]
  v_mfma_f32_16x16x32_bf16 v[188:191], v[44:47], a[188:191], v[188:191]
  s_waitcnt lgkmcnt(0) vmcnt(8)
  v_mfma_f32_16x16x32_bf16 v[128:131], v[16:19], a[192:195], v[128:131]
  ds_read_b64_tr_b16 v[32:33], v80 offset:12288
  v_mfma_f32_16x16x32_bf16 v[144:147], v[16:19], a[196:199], v[144:147]
  ds_read_b64_tr_b16 v[34:35], v80 offset:14336
  v_mfma_f32_16x16x32_bf16 v[160:163], v[16:19], a[200:203], v[160:163]
  ds_read_b64_tr_b16 v[36:37], v81 offset:12288
  v_mfma_f32_16x16x32_bf16 v[176:179], v[16:19], a[204:207], v[176:179]
  ds_read_b64_tr_b16 v[38:39], v81 offset:14336
  v_mfma_f32_16x16x32_bf16 v[132:135], v[20:23], a[192:195], v[132:135]
  ds_read_b64_tr_b16 v[40:41], v82 offset:12288
  v_mfma_f32_16x16x32_bf16 v[148:151], v[20:23], a[196:199], v[148:151]
  ds_read_b64_tr_b16 v[42:43], v82 offset:14336
  v_mfma_f32_16x16x32_bf16 v[164:167], v[20:23], a[200:203], v[164:167]
  ds_read_b64_tr_b16 v[44:45], v83 offset:12288
  v_mfma_f32_16x16x32_bf16 v[180:183], v[20:23], a[204:207], v[180:183]
  ds_read_b64_tr_b16 v[46:47], v83 offset:14336
  v_mfma_f32_16x16x32_bf16 v[136:139], v[24:27], a[192:195], v[136:139]
  v_mfma_f32_16x16x32_bf16 v[152:155], v[24:27], a[196:199], v[152:155]
  v_mfma_f32_16x16x32_bf16 v[168:171], v[24:27], a[200:203], v[168:171]
  v_mfma_f32_16x16x32_bf16 v[184:187], v[24:27], a[204:207], v[184:187]
  v_mfma_f32_16x16x32_bf16 v[140:143], v[28:31], a[192:195], v[140:143]
  v_mfma_f32_16x16x32_bf16 v[156:159], v[28:31], a[196:199], v[156:159]
  v_mfma_f32_16x16x32_bf16 v[172:175], v[28:31], a[200:203], v[172:175]
  v_mfma_f32_16x16x32_bf16 v[188:191], v[28:31], a[204:207], v[188:191]
  s_waitcnt lgkmcnt(0) vmcnt(4)
  v_mfma_f32_16x16x32_bf16 v[128:131], v[32:35], a[208:211], v[128:131]
  ds_read_b64_tr_b16 v[16:17], v80 offset:16384
  v_mfma_f32_16x16x32_bf16 v[144:147], v[32:35], a[212:215], v[144:147]
  ds_read_b64_tr_b16 v[18:19], v80 offset:18432
  v_mfma_f32_16x16x32_bf16 v[160:163], v[32:35], a[216:219], v[160:163]
  ds_read_b64_tr_b16 v[20:21], v81 offset:16384
  v_mfma_f32_16x16x32_bf16 v[176:179], v[32:35], a[220:223], v[176:179]
  ds_read_b64_tr_b16 v[22:23], v81 offset:18432
  v_mfma_f32_16x16x32_bf16 v[132:135], v[36:39], a[208:211], v[132:135]
  ds_read_b64_tr_b16 v[24:25], v82 offset:16384
  v_mfma_f32_16x16x32_bf16 v[148:151], v[36:39], a[212:215], v[148:151]
  ds_read_b64_tr_b16 v[26:27], v82 offset:18432
  v_mfma_f32_16x16x32_bf16 v[164:167], v[36:39], a[216:219], v[164:167]
  ds_read_b64_tr_b16 v[28:29], v83 offset:16384
  v_mfma_f32_16x16x32_bf16 v[180:183], v[36:39], a[220:223], v[180:183]
  ds_read_b64_tr_b16 v[30:31], v83 offset:18432
  v_mfma_f32_16x16x32_bf16 v[136:139], v[40:43], a[208:211], v[136:139]
  v_mfma_f32_16x16x32_bf16 v[152:155], v[40:43], a[212:215], v[152:155]
  v_mfma_f32_16x16x32_bf16 v[168:171], v[40:43], a[216:219], v[168:171]
  v_mfma_f32_16x16x32_bf16 v[184:187], v[40:43], a[220:223], v[184:187]
  v_mfma_f32_16x16x32_bf16 v[140:143], v[44:47], a[208:211], v[140:143]
  v_mfma_f32_16x16x32_bf16 v[156:159], v[44:47], a[212:215], v[156:159]
  v_mfma_f32_16x16x32_bf16 v[172:175], v[44:47], a[216:219], v[172:175]
  v_mfma_f32_16x16x32_bf16 v[188:191], v[44:47], a[220:223], v[188:191]
  s_waitcnt lgkmcnt(0) vmcnt(0)
  v_mfma_f32_16x16x32_bf16 v[128:131], v[16:19], a[224:227], v[128:131]
  ds_read_b64_tr_b16 v[32:33], v80 offset:20480
  v_mfma_f32_16x16x32_bf16 v[144:147], v[16:19], a[228:231], v[144:147]
  ds_read_b64_tr_b16 v[34:35], v80 offset:22528
  v_mfma_f32_16x16x32_bf16 v[160:163], v[16:19], a[232:235], v[160:163]
  ds_read_b64_tr_b16 v[36:37], v81 offset:20480
  v_mfma_f32_16x16x32_bf16 v[176:179], v[16:19], a[236:239], v[176:179]
  ds_read_b64_tr_b16 v[38:39], v81 offset:22528
  v_mfma_f32_16x16x32_bf16 v[132:135], v[20:23], a[224:227], v[132:135]
  ds_read_b64_tr_b16 v[40:41], v82 offset:20480
  v_mfma_f32_16x16x32_bf16 v[148:151], v[20:23], a[228:231], v[148:151]
  ds_read_b64_tr_b16 v[42:43], v82 offset:22528
  v_mfma_f32_16x16x32_bf16 v[164:167], v[20:23], a[232:235], v[164:167]
  ds_read_b64_tr_b16 v[44:45], v83 offset:20480
  v_mfma_f32_16x16x32_bf16 v[180:183], v[20:23], a[236:239], v[180:183]
  ds_read_b64_tr_b16 v[46:47], v83 offset:22528
  v_mfma_f32_16x16x32_bf16 v[136:139], v[24:27], a[224:227], v[136:139]
  v_mfma_f32_16x16x32_bf16 v[152:155], v[24:27], a[228:231], v[152:155]
  v_mfma_f32_16x16x32_bf16 v[168:171], v[24:27], a[232:235], v[168:171]
  v_mfma_f32_16x16x32_bf16 v[184:187], v[24:27], a[236:239], v[184:187]
  v_mfma_f32_16x16x32_bf16 v[140:143], v[28:31], a[224:227], v[140:143]
  v_mfma_f32_16x16x32_bf16 v[156:159], v[28:31], a[228:231], v[156:159]
  v_mfma_f32_16x16x32_bf16 v[172:175], v[28:31], a[232:235], v[172:175]
  v_mfma_f32_16x16x32_bf16 v[188:191], v[28:31], a[236:239], v[188:191]
  s_waitcnt lgkmcnt(0)
  v_mfma_f32_16x16x32_bf16 v[128:131], v[32:35], a[240:243], v[128:131]
  v_mfma_f32_16x16x32_bf16 v[144:147], v[32:35], a[244:247], v[144:147]
  v_mfma_f32_16x16x32_bf16 v[160:163], v[32:35], a[248:251], v[160:163]
  v_mfma_f32_16x16x32_bf16 v[176:179], v[32:35], a[252:255], v[176:179]
  v_mfma_f32_16x16x32_bf16 v[132:135], v[36:39], a[240:243], v[132:135]
  v_mfma_f32_16x16x32_bf16 v[148:151], v[36:39], a[244:247], v[148:151]
  v_mfma_f32_16x16x32_bf16 v[164:167], v[36:39], a[248:251], v[164:167]
  v_mfma_f32_16x16x32_bf16 v[180:183], v[36:39], a[252:255], v[180:183]
  v_mfma_f32_16x16x32_bf16 v[136:139], v[40:43], a[240:243], v[136:139]
  v_mfma_f32_16x16x32_bf16 v[152:155], v[40:43], a[244:247], v[152:155]
  v_mfma_f32_16x16x32_bf16 v[168:171], v[40:43], a[248:251], v[168:171]
  v_mfma_f32_16x16x32_bf16 v[184:187], v[40:43], a[252:255], v[184:187]
  v_mfma_f32_16x16x32_bf16 v[140:143], v[44:47], a[240:243], v[140:143]
  v_mfma_f32_16x16x32_bf16 v[156:159], v[44:47], a[244:247], v[156:159]
  v_mfma_f32_16x16x32_bf16 v[172:175], v[44:47], a[248:251], v[172:175]
  v_mfma_f32_16x16x32_bf16 v[188:191], v[44:47], a[252:255], v[188:191]
  s_barrier
  s_lshl_b32 s3, s29, 14
  v_add_u32 v4, s3, v1
  ds_write_b128 v4, v[128:131] offset:0
  ds_write_b128 v4, v[132:135] offset:1024
  ds_write_b128 v4, v[136:139] offset:2048
  ds_write_b128 v4, v[140:143] offset:3072
  ds_write_b128 v4, v[144:147] offset:4096
  ds_write_b128 v4, v[148:151] offset:5120
  ds_write_b128 v4, v[152:155] offset:6144
  ds_write_b128 v4, v[156:159] offset:7168
  s_waitcnt lgkmcnt(0)
  ds_write_b128 v4, v[160:163] offset:8192
  ds_write_b128 v4, v[164:167] offset:9216
  ds_write_b128 v4, v[168:171] offset:10240
  ds_write_b128 v4, v[172:175] offset:11264
  ds_write_b128 v4, v[176:179] offset:12288
  ds_write_b128 v4, v[180:183] offset:13312
  ds_write_b128 v4, v[184:187] offset:14336
  ds_write_b128 v4, v[188:191] offset:15360
  s_waitcnt lgkmcnt(0)
  v_bfe_u32 v4, v0, 0, 1
  v_lshlrev_b32 v5, 9, v4
  v_bfe_u32 v4, v0, 1, 1
  v_lshl_add_u32 v5, v4, 10, v5
  v_bfe_u32 v4, v0, 2, 1
  v_lshl_add_u32 v5, v4, 11, v5
  v_bfe_u32 v4, v0, 3, 1
  v_lshl_add_u32 v5, v4, 4, v5
  v_bfe_u32 v4, v0, 4, 1
  v_lshl_add_u32 v5, v4, 5, v5
  v_bfe_u32 v4, v0, 5, 1
  v_lshl_add_u32 v5, v4, 6, v5
  s_barrier
  s_lshl_b32 s3, s29, 12
  v_add_u32 v4, s3, v5
  ds_read_b128 v[16:19], v4 offset:0
  ds_read_b128 v[20:23], v4 offset:256
  ds_read_b128 v[24:27], v4 offset:128
  ds_read_b128 v[28:31], v4 offset:384
  ds_read_b128 v[32:35], v4 offset:16384
  ds_read_b128 v[36:39], v4 offset:16640
  ds_read_b128 v[40:43], v4 offset:16512
  ds_read_b128 v[44:47], v4 offset:16768
  s_waitcnt lgkmcnt(0)
  ds_read_b128 v[48:51], v4 offset:32768
  ds_read_b128 v[52:55], v4 offset:33024
  ds_read_b128 v[56:59], v4 offset:32896
  ds_read_b128 v[60:63], v4 offset:33152
  ds_read_b128 v[64:67], v4 offset:49152
  ds_read_b128 v[68:71], v4 offset:49408
  ds_read_b128 v[72:75], v4 offset:49280
  ds_read_b128 v[76:79], v4 offset:49536
  s_waitcnt lgkmcnt(0)
  v_lshlrev_b32 v14, 16, v14
  v_lshlrev_b32 v15, 16, v15
  v_add_f32 v16, v16, v32
  v_add_f32 v48, v48, v64
  v_add_f32 v16, v16, v48
  v_add_f32 v17, v17, v33
  v_add_f32 v49, v49, v65
  v_add_f32 v17, v17, v49
  v_add_f32 v18, v18, v34
  v_add_f32 v50, v50, v66
  v_add_f32 v18, v18, v50
  v_add_f32 v19, v19, v35
  v_add_f32 v51, v51, v67
  v_add_f32 v19, v19, v51
  v_add_f32 v20, v20, v36
  v_add_f32 v52, v52, v68
  v_add_f32 v20, v20, v52
  v_add_f32 v21, v21, v37
  v_add_f32 v53, v53, v69
  v_add_f32 v21, v21, v53
  v_add_f32 v22, v22, v38
  v_add_f32 v54, v54, v70
  v_add_f32 v22, v22, v54
  v_add_f32 v23, v23, v39
  v_add_f32 v55, v55, v71
  v_add_f32 v23, v23, v55
  v_add_f32 v24, v24, v40
  v_add_f32 v56, v56, v72
  v_add_f32 v24, v24, v56
  v_add_f32 v25, v25, v41
  v_add_f32 v57, v57, v73
  v_add_f32 v25, v25, v57
  v_add_f32 v26, v26, v42
  v_add_f32 v58, v58, v74
  v_add_f32 v26, v26, v58
  v_add_f32 v27, v27, v43
  v_add_f32 v59, v59, v75
  v_add_f32 v27, v27, v59
  v_add_f32 v28, v28, v44
  v_add_f32 v60, v60, v76
  v_add_f32 v28, v28, v60
  v_add_f32 v29, v29, v45
  v_add_f32 v61, v61, v77
  v_add_f32 v29, v29, v61
  v_add_f32 v30, v30, v46
  v_add_f32 v62, v62, v78
  v_add_f32 v30, v30, v62
  v_add_f32 v31, v31, v47
  v_add_f32 v63, v63, v79
  v_add_f32 v31, v31, v63
  v_cvt_pk_bf16_f32 v32, v16, v17
  v_and_b32 v17, 0xffff0000, v32
  v_lshlrev_b32 v16, 16, v32
  v_add_f32 v16, v16, v14
  v_add_f32 v17, v17, v14
  v_cvt_pk_bf16_f32 v32, v16, v17
  v_and_b32 v17, 0xffff0000, v32
  v_lshlrev_b32 v16, 16, v32
  v_mov_b32 v6, 0xbdd2d3e8
  v_mul_f32 v4, v16, v16
  v_fmaak_f32 v4, v4, v6, 0xc0135761
  v_mul_f32 v4, v4, v16
  v_exp_f32 v4, v4
  s_nop 0
  v_add_f32 v4, 1.0, v4
  v_rcp_f32 v4, v4
  s_nop 0
  v_mul_f32 v16, v16, v4
  v_mul_f32 v5, v17, v17
  v_fmaak_f32 v5, v5, v6, 0xc0135761
  v_mul_f32 v5, v5, v17
  v_exp_f32 v5, v5
  s_nop 0
  v_add_f32 v5, 1.0, v5
  v_rcp_f32 v5, v5
  s_nop 0
  v_mul_f32 v17, v17, v5
  v_cvt_pk_bf16_f32 v32, v16, v17
  v_cvt_pk_bf16_f32 v33, v18, v19
  v_and_b32 v19, 0xffff0000, v33
  v_lshlrev_b32 v18, 16, v33
  v_add_f32 v18, v18, v14
  v_add_f32 v19, v19, v14
  v_cvt_pk_bf16_f32 v33, v18, v19
  v_and_b32 v19, 0xffff0000, v33
  v_lshlrev_b32 v18, 16, v33
  v_mul_f32 v4, v18, v18
  v_fmaak_f32 v4, v4, v6, 0xc0135761
  v_mul_f32 v4, v4, v18
  v_exp_f32 v4, v4
  s_nop 0
  v_add_f32 v4, 1.0, v4
  v_rcp_f32 v4, v4
  s_nop 0
  v_mul_f32 v18, v18, v4
  v_mul_f32 v5, v19, v19
  v_fmaak_f32 v5, v5, v6, 0xc0135761
  v_mul_f32 v5, v5, v19
  v_exp_f32 v5, v5
  s_nop 0
  v_add_f32 v5, 1.0, v5
  v_rcp_f32 v5, v5
  s_nop 0
  v_mul_f32 v19, v19, v5
  v_cvt_pk_bf16_f32 v33, v18, v19
  v_cvt_pk_bf16_f32 v34, v20, v21
  v_and_b32 v21, 0xffff0000, v34
  v_lshlrev_b32 v20, 16, v34
  v_add_f32 v20, v20, v14
  v_add_f32 v21, v21, v14
  v_cvt_pk_bf16_f32 v34, v20, v21
  v_and_b32 v21, 0xffff0000, v34
  v_lshlrev_b32 v20, 16, v34
  v_mul_f32 v4, v20, v20
  v_fmaak_f32 v4, v4, v6, 0xc0135761
  v_mul_f32 v4, v4, v20
  v_exp_f32 v4, v4
  s_nop 0
  v_add_f32 v4, 1.0, v4
  v_rcp_f32 v4, v4
  s_nop 0
  v_mul_f32 v20, v20, v4
  v_mul_f32 v5, v21, v21
  v_fmaak_f32 v5, v5, v6, 0xc0135761
  v_mul_f32 v5, v5, v21
  v_exp_f32 v5, v5
  s_nop 0
  v_add_f32 v5, 1.0, v5
  v_rcp_f32 v5, v5
  s_nop 0
  v_mul_f32 v21, v21, v5
  v_cvt_pk_bf16_f32 v34, v20, v21
  v_cvt_pk_bf16_f32 v35, v22, v23
  v_and_b32 v23, 0xffff0000, v35
  v_lshlrev_b32 v22, 16, v35
  v_add_f32 v22, v22, v14
  v_add_f32 v23, v23, v14
  v_cvt_pk_bf16_f32 v35, v22, v23
  v_and_b32 v23, 0xffff0000, v35
  v_lshlrev_b32 v22, 16, v35
  v_mul_f32 v4, v22, v22
  v_fmaak_f32 v4, v4, v6, 0xc0135761
  v_mul_f32 v4, v4, v22
  v_exp_f32 v4, v4
  s_nop 0
  v_add_f32 v4, 1.0, v4
  v_rcp_f32 v4, v4
  s_nop 0
  v_mul_f32 v22, v22, v4
  v_mul_f32 v5, v23, v23
  v_fmaak_f32 v5, v5, v6, 0xc0135761
  v_mul_f32 v5, v5, v23
  v_exp_f32 v5, v5
  s_nop 0
  v_add_f32 v5, 1.0, v5
  v_rcp_f32 v5, v5
  s_nop 0
  v_mul_f32 v23, v23, v5
  v_cvt_pk_bf16_f32 v35, v22, v23
  v_cvt_pk_bf16_f32 v36, v24, v25
  v_and_b32 v25, 0xffff0000, v36
  v_lshlrev_b32 v24, 16, v36
  v_add_f32 v24, v24, v15
  v_add_f32 v25, v25, v15
  v_cvt_pk_bf16_f32 v36, v24, v25
  v_and_b32 v25, 0xffff0000, v36
  v_lshlrev_b32 v24, 16, v36
  v_mul_f32 v4, v24, v24
  v_fmaak_f32 v4, v4, v6, 0xc0135761
  v_mul_f32 v4, v4, v24
  v_exp_f32 v4, v4
  s_nop 0
  v_add_f32 v4, 1.0, v4
  v_rcp_f32 v4, v4
  s_nop 0
  v_mul_f32 v24, v24, v4
  v_mul_f32 v5, v25, v25
  v_fmaak_f32 v5, v5, v6, 0xc0135761
  v_mul_f32 v5, v5, v25
  v_exp_f32 v5, v5
  s_nop 0
  v_add_f32 v5, 1.0, v5
  v_rcp_f32 v5, v5
  s_nop 0
  v_mul_f32 v25, v25, v5
  v_cvt_pk_bf16_f32 v36, v24, v25
  v_cvt_pk_bf16_f32 v37, v26, v27
  v_and_b32 v27, 0xffff0000, v37
  v_lshlrev_b32 v26, 16, v37
  v_add_f32 v26, v26, v15
  v_add_f32 v27, v27, v15
  v_cvt_pk_bf16_f32 v37, v26, v27
  v_and_b32 v27, 0xffff0000, v37
  v_lshlrev_b32 v26, 16, v37
  v_mul_f32 v4, v26, v26
  v_fmaak_f32 v4, v4, v6, 0xc0135761
  v_mul_f32 v4, v4, v26
  v_exp_f32 v4, v4
  s_nop 0
  v_add_f32 v4, 1.0, v4
  v_rcp_f32 v4, v4
  s_nop 0
  v_mul_f32 v26, v26, v4
  v_mul_f32 v5, v27, v27
  v_fmaak_f32 v5, v5, v6, 0xc0135761
  v_mul_f32 v5, v5, v27
  v_exp_f32 v5, v5
  s_nop 0
  v_add_f32 v5, 1.0, v5
  v_rcp_f32 v5, v5
  s_nop 0
  v_mul_f32 v27, v27, v5
  v_cvt_pk_bf16_f32 v37, v26, v27
  v_cvt_pk_bf16_f32 v38, v28, v29
  v_and_b32 v29, 0xffff0000, v38
  v_lshlrev_b32 v28, 16, v38
  v_add_f32 v28, v28, v15
  v_add_f32 v29, v29, v15
  v_cvt_pk_bf16_f32 v38, v28, v29
  v_and_b32 v29, 0xffff0000, v38
  v_lshlrev_b32 v28, 16, v38
  v_mul_f32 v4, v28, v28
  v_fmaak_f32 v4, v4, v6, 0xc0135761
  v_mul_f32 v4, v4, v28
  v_exp_f32 v4, v4
  s_nop 0
  v_add_f32 v4, 1.0, v4
  v_rcp_f32 v4, v4
  s_nop 0
  v_mul_f32 v28, v28, v4
  v_mul_f32 v5, v29, v29
  v_fmaak_f32 v5, v5, v6, 0xc0135761
  v_mul_f32 v5, v5, v29
  v_exp_f32 v5, v5
  s_nop 0
  v_add_f32 v5, 1.0, v5
  v_rcp_f32 v5, v5
  s_nop 0
  v_mul_f32 v29, v29, v5
  v_cvt_pk_bf16_f32 v38, v28, v29
  v_cvt_pk_bf16_f32 v39, v30, v31
  v_and_b32 v31, 0xffff0000, v39
  v_lshlrev_b32 v30, 16, v39
  v_add_f32 v30, v30, v15
  v_add_f32 v31, v31, v15
  v_cvt_pk_bf16_f32 v39, v30, v31
  v_and_b32 v31, 0xffff0000, v39
  v_lshlrev_b32 v30, 16, v39
  v_mul_f32 v4, v30, v30
  v_fmaak_f32 v4, v4, v6, 0xc0135761
  v_mul_f32 v4, v4, v30
  v_exp_f32 v4, v4
  s_nop 0
  v_add_f32 v4, 1.0, v4
  v_rcp_f32 v4, v4
  s_nop 0
  v_mul_f32 v30, v30, v4
  v_mul_f32 v5, v31, v31
  v_fmaak_f32 v5, v5, v6, 0xc0135761
  v_mul_f32 v5, v5, v31
  v_exp_f32 v5, v5
  s_nop 0
  v_add_f32 v5, 1.0, v5
  v_rcp_f32 v5, v5
  s_nop 0
  v_mul_f32 v31, v31, v5
  v_cvt_pk_bf16_f32 v39, v30, v31
  v_bfe_u32 v4, v0, 0, 1
  v_lshlrev_b32 v5, 4, v4
  v_bfe_u32 v4, v0, 1, 1
  v_lshl_add_u32 v5, v4, 5, v5
  v_bfe_u32 v4, v0, 2, 1
  v_lshl_add_u32 v5, v4, 6, v5
  v_bfe_u32 v4, v0, 3, 1
  v_lshl_add_u32 v5, v4, 10, v5
  v_bfe_u32 v4, v0, 4, 1
  v_lshl_add_u32 v5, v4, 11, v5
  v_bfe_u32 v4, v0, 5, 1
  v_lshl_add_u32 v5, v4, 12, v5
  s_lshl_b32 s3, s39, 16
  s_lshl_b32 s6, s29, 14
  s_add_u32 s3, s3, s6
  s_lshl_b32 s6, s38, 7
  s_add_u32 s3, s3, s6
  s_add_u32 s3, s3, 3145728
  buffer_store_dwordx4 v[32:35], v5, s[8:11], s3 offen sc1
  s_add_u32 s3, s3, 8192
  buffer_store_dwordx4 v[36:39], v5, s[8:11], s3 offen sc1
  s_waitcnt vmcnt(0)
  s_barrier
  s_lshl_b32 s3, s31, 2
  s_add_u32 s3, s3, 598016
  s_cmp_lg_u32 s29, 0
  s_cbranch_scc1 W_pub_16
  v_mov_b32 v4, 2
  s_mov_b64 exec, 1
  buffer_store_dword v4, off, s[8:11], s3 sc1
  s_mov_b64 exec, -1
W_pub_16:
  s_branch L_done
L_proj:
  s_load_dwordx2 s[12:13], s[0:1], 24
  s_mov_b32 s14, 4194304
  s_mov_b32 s15, 0x20000
  s_load_dwordx2 s[16:17], s[0:1], 32
  s_mov_b32 s18, 4194304
  s_mov_b32 s19, 0x20000
  s_load_dwordx2 s[20:21], s[0:1], 16
  s_mov_b32 s22, 4194304
  s_mov_b32 s23, 0x20000
  s_load_dwordx2 s[24:25], s[0:1], 0
  s_mov_b32 s26, 2097152
  s_mov_b32 s27, 0x20000
  s_load_dwordx2 s[48:49], s[0:1], 40
  s_mov_b32 s50, 4194304
  s_mov_b32 s51, 0x20000
  v_lshrrev_b32 v5, 4, v0
  v_bfe_u32 v4, v0, 1, 3
  v_xor_b32 v4, v4, v5
  v_lshlrev_b32 v7, 5, v4
  v_and_b32 v4, 1, v0
  v_lshl_add_u32 v7, v4, 4, v7
  v_lshl_add_u32 v7, v5, 13, v7
  s_lshl_b32 s3, s32, 8
  v_add_u32 v6, s3, v7
  v_xor_b32 v7, 128, v6
  s_lshl_b32 s36, s29, 15
  s_add_u32 s36, s36, 32768
  s_xor_b32 s38, s33, s29
  s_lshl_b32 s38, s38, 19
  s_and_b32 s3, s33, 3
  s_and_b32 s6, s3, 1
  s_lshl_b32 s7, s6, 12
  s_add_u32 s36, s36, s7
  s_lshl_b32 s6, s6, 15
  s_add_u32 s38, s38, s6
  s_and_b32 s6, s3, 2
  s_lshl_b32 s7, s6, 10
  s_add_u32 s36, s36, s7
  s_lshl_b32 s6, s6, 16
  s_add_u32 s38, s38, s6
  s_waitcnt lgkmcnt(0)
  s_xor_b32 m0, s36, 0
  s_xor_b32 s3, s38, 0
  buffer_load_dwordx4 v6, s[12:15], s3 offen lds
  s_xor_b32 m0, s36, 1024
  s_xor_b32 s3, s38, 65536
  buffer_load_dwordx4 v7, s[12:15], s3 offen lds
  s_xor_b32 m0, s36, 2048
  s_xor_b32 s3, s38, 131072
  buffer_load_dwordx4 v6, s[12:15], s3 offen lds
  s_xor_b32 m0, s36, 3072
  s_xor_b32 s3, s38, 196608
  buffer_load_dwordx4 v7, s[12:15], s3 offen lds
  s_xor_b32 m0, s36, 4096
  s_xor_b32 s3, s38, 32768
  buffer_load_dwordx4 v6, s[12:15], s3 offen lds
  s_xor_b32 m0, s36, 5120
  s_xor_b32 s3, s38, 98304
  buffer_load_dwordx4 v7, s[12:15], s3 offen lds
  s_xor_b32 m0, s36, 6144
  s_xor_b32 s3, s38, 163840
  buffer_load_dwordx4 v6, s[12:15], s3 offen lds
  s_xor_b32 m0, s36, 7168
  s_xor_b32 s3, s38, 229376
  buffer_load_dwordx4 v7, s[12:15], s3 offen lds
  v_bfe_u32 v4, v0, 0, 1
  v_lshlrev_b32 v5, 3, v4
  v_bfe_u32 v4, v0, 1, 1
  v_lshl_add_u32 v5, v4, 4, v5
  v_bfe_u32 v4, v0, 2, 1
  v_lshl_add_u32 v5, v4, 8, v5
  v_bfe_u32 v4, v0, 3, 1
  v_lshl_add_u32 v5, v4, 9, v5
  v_bfe_u32 v4, v0, 4, 1
  v_lshl_add_u32 v5, v4, 10, v5
  v_bfe_u32 v4, v0, 5, 1
  v_lshl_add_u32 v5, v4, 11, v5
  s_lshl_b32 s3, s29, 1
  v_bfe_u32 v4, v0, 2, 3
  v_xor_b32 v4, s3, v4
  v_lshl_add_u32 v5, v4, 5, v5
  v_add_u32 v16, 32768, v5
  v_xor_b32 v17, 32, v16
  v_add_u32 v18, 65536, v5
  v_xor_b32 v19, 32, v18
  v_add_u32 v20, 98304, v5
  v_xor_b32 v21, 32, v20
  v_add_u32 v22, 131072, v5
  v_xor_b32 v23, 32, v22
  s_and_b32 s3, s29, 1
  s_lshl_b32 s3, s3, 2
  v_lshrrev_b32 v4, 4, v0
  v_add_u32 v5, s3, v4
  v_and_b32 v8, 7, v0
  v_xor_b32 v8, v8, v5
  v_lshlrev_b32 v8, 4, v8
  v_lshrrev_b32 v5, 3, v0
  v_lshl_add_u32 v8, v5, 10, v8
  s_lshl_b32 s3, s29, 13
  v_add_u32 v8, s3, v8
  v_bfe_u32 v5, v0, 1, 3
  v_xor_b32 v5, v5, v4
  v_lshlrev_b32 v5, 4, v5
  v_and_b32 v4, 15, v0
  v_lshl_add_u32 v9, v4, 7, v5
  v_xor_b32 v10, 64, v9
  s_lshl_b32 s37, s29, 10
  s_mov_b32 s34, s33
  s_mov_b32 s35, 0
  s_lshl_b32 s39, s33, 7
  s_lshl_b32 s43, s32, 7
  s_lshl_b32 s3, s33, 2
  s_add_u32 s43, s43, s3
  s_add_u32 s43, s43, 589824
  s_xor_b32 m0, s36, 8192
  s_xor_b32 s3, s38, 262144
  buffer_load_dwordx4 v6, s[12:15], s3 offen lds
  s_xor_b32 m0, s36, 9216
  s_xor_b32 s3, s38, 327680
  buffer_load_dwordx4 v7, s[12:15], s3 offen lds
  s_xor_b32 m0, s36, 10240
  s_xor_b32 s3, s38, 393216
  buffer_load_dwordx4 v6, s[12:15], s3 offen lds
  s_xor_b32 m0, s36, 11264
  s_xor_b32 s3, s38, 458752
  buffer_load_dwordx4 v7, s[12:15], s3 offen lds
  s_xor_b32 m0, s36, 12288
  s_xor_b32 s3, s38, 294912
  buffer_load_dwordx4 v6, s[12:15], s3 offen lds
  s_xor_b32 m0, s36, 13312
  s_xor_b32 s3, s38, 360448
  buffer_load_dwordx4 v7, s[12:15], s3 offen lds
  s_xor_b32 m0, s36, 14336
  s_xor_b32 s3, s38, 425984
  buffer_load_dwordx4 v6, s[12:15], s3 offen lds
  s_xor_b32 m0, s36, 15360
  s_xor_b32 s3, s38, 491520
  buffer_load_dwordx4 v7, s[12:15], s3 offen lds
  s_xor_b32 m0, s36, 16384
  s_xor_b32 s3, s38, 2097152
  buffer_load_dwordx4 v6, s[12:15], s3 offen lds
  s_xor_b32 m0, s36, 17408
  s_xor_b32 s3, s38, 2162688
  buffer_load_dwordx4 v7, s[12:15], s3 offen lds
  s_xor_b32 m0, s36, 18432
  s_xor_b32 s3, s38, 2228224
  buffer_load_dwordx4 v6, s[12:15], s3 offen lds
  s_xor_b32 m0, s36, 19456
  s_xor_b32 s3, s38, 2293760
  buffer_load_dwordx4 v7, s[12:15], s3 offen lds
  s_xor_b32 m0, s36, 20480
  s_xor_b32 s3, s38, 2129920
  buffer_load_dwordx4 v6, s[12:15], s3 offen lds
  s_xor_b32 m0, s36, 21504
  s_xor_b32 s3, s38, 2195456
  buffer_load_dwordx4 v7, s[12:15], s3 offen lds
  s_xor_b32 m0, s36, 22528
  s_xor_b32 s3, s38, 2260992
  buffer_load_dwordx4 v6, s[12:15], s3 offen lds
  s_xor_b32 m0, s36, 23552
  s_xor_b32 s3, s38, 2326528
  buffer_load_dwordx4 v7, s[12:15], s3 offen lds
  s_waitcnt vmcnt(16) lgkmcnt(0)
  s_barrier
  ds_read_b64_tr_b16 a[0:1], v16 offset:0
  ds_read_b64_tr_b16 a[2:3], v16 offset:4096
  s_xor_b32 m0, s36, 24576
  s_xor_b32 s3, s38, 2359296
  buffer_load_dwordx4 v6, s[12:15], s3 offen lds
  ds_read_b64_tr_b16 a[8:9], v17 offset:0
  ds_read_b64_tr_b16 a[10:11], v17 offset:4096
  s_xor_b32 m0, s36, 25600
  s_xor_b32 s3, s38, 2424832
  buffer_load_dwordx4 v7, s[12:15], s3 offen lds
  ds_read_b64_tr_b16 a[16:17], v18 offset:0
  ds_read_b64_tr_b16 a[18:19], v18 offset:4096
  s_xor_b32 m0, s36, 26624
  s_xor_b32 s3, s38, 2490368
  buffer_load_dwordx4 v6, s[12:15], s3 offen lds
  ds_read_b64_tr_b16 a[24:25], v19 offset:0
  ds_read_b64_tr_b16 a[26:27], v19 offset:4096
  s_xor_b32 m0, s36, 27648
  s_xor_b32 s3, s38, 2555904
  buffer_load_dwordx4 v7, s[12:15], s3 offen lds
  ds_read_b64_tr_b16 a[32:33], v20 offset:0
  ds_read_b64_tr_b16 a[34:35], v20 offset:4096
  s_xor_b32 m0, s36, 28672
  s_xor_b32 s3, s38, 2392064
  buffer_load_dwordx4 v6, s[12:15], s3 offen lds
  ds_read_b64_tr_b16 a[40:41], v21 offset:0
  ds_read_b64_tr_b16 a[42:43], v21 offset:4096
  s_xor_b32 m0, s36, 29696
  s_xor_b32 s3, s38, 2457600
  buffer_load_dwordx4 v7, s[12:15], s3 offen lds
  ds_read_b64_tr_b16 a[48:49], v22 offset:0
  ds_read_b64_tr_b16 a[50:51], v22 offset:4096
  s_xor_b32 m0, s36, 30720
  s_xor_b32 s3, s38, 2523136
  buffer_load_dwordx4 v6, s[12:15], s3 offen lds
  ds_read_b64_tr_b16 a[56:57], v23 offset:0
  ds_read_b64_tr_b16 a[58:59], v23 offset:4096
  s_xor_b32 m0, s36, 31744
  s_xor_b32 s3, s38, 2588672
  buffer_load_dwordx4 v7, s[12:15], s3 offen lds
  s_waitcnt vmcnt(16) lgkmcnt(0)
  s_barrier
  ds_read_b64_tr_b16 a[4:5], v16 offset:8192
  ds_read_b64_tr_b16 a[6:7], v16 offset:12288
  s_xor_b32 m0, s36, 0
  s_xor_b32 s3, s38, 0
  buffer_load_dwordx4 v6, s[16:19], s3 offen lds
  ds_read_b64_tr_b16 a[12:13], v17 offset:8192
  ds_read_b64_tr_b16 a[14:15], v17 offset:12288
  s_xor_b32 m0, s36, 1024
  s_xor_b32 s3, s38, 65536
  buffer_load_dwordx4 v7, s[16:19], s3 offen lds
  ds_read_b64_tr_b16 a[20:21], v18 offset:8192
  ds_read_b64_tr_b16 a[22:23], v18 offset:12288
  s_xor_b32 m0, s36, 2048
  s_xor_b32 s3, s38, 131072
  buffer_load_dwordx4 v6, s[16:19], s3 offen lds
  ds_read_b64_tr_b16 a[28:29], v19 offset:8192
  ds_read_b64_tr_b16 a[30:31], v19 offset:12288
  s_xor_b32 m0, s36, 3072
  s_xor_b32 s3, s38, 196608
  buffer_load_dwordx4 v7, s[16:19], s3 offen lds
  ds_read_b64_tr_b16 a[36:37], v20 offset:8192
  ds_read_b64_tr_b16 a[38:39], v20 offset:12288
  s_xor_b32 m0, s36, 4096
  s_xor_b32 s3, s38, 32768
  buffer_load_dwordx4 v6, s[16:19], s3 offen lds
  ds_read_b64_tr_b16 a[44:45], v21 offset:8192
  ds_read_b64_tr_b16 a[46:47], v21 offset:12288
  s_xor_b32 m0, s36, 5120
  s_xor_b32 s3, s38, 98304
  buffer_load_dwordx4 v7, s[16:19], s3 offen lds
  ds_read_b64_tr_b16 a[52:53], v22 offset:8192
  ds_read_b64_tr_b16 a[54:55], v22 offset:12288
  s_xor_b32 m0, s36, 6144
  s_xor_b32 s3, s38, 163840
  buffer_load_dwordx4 v6, s[16:19], s3 offen lds
  ds_read_b64_tr_b16 a[60:61], v23 offset:8192
  ds_read_b64_tr_b16 a[62:63], v23 offset:12288
  s_xor_b32 m0, s36, 7168
  s_xor_b32 s3, s38, 229376
  buffer_load_dwordx4 v7, s[16:19], s3 offen lds
  s_waitcnt vmcnt(16) lgkmcnt(0)
  s_barrier
  ds_read_b64_tr_b16 a[64:65], v16 offset:16384
  ds_read_b64_tr_b16 a[66:67], v16 offset:20480
  s_xor_b32 m0, s36, 8192
  s_xor_b32 s3, s38, 262144
  buffer_load_dwordx4 v6, s[16:19], s3 offen lds
  ds_read_b64_tr_b16 a[72:73], v17 offset:16384
  ds_read_b64_tr_b16 a[74:75], v17 offset:20480
  s_xor_b32 m0, s36, 9216
  s_xor_b32 s3, s38, 327680
  buffer_load_dwordx4 v7, s[16:19], s3 offen lds
  ds_read_b64_tr_b16 a[80:81], v18 offset:16384
  ds_read_b64_tr_b16 a[82:83], v18 offset:20480
  s_xor_b32 m0, s36, 10240
  s_xor_b32 s3, s38, 393216
  buffer_load_dwordx4 v6, s[16:19], s3 offen lds
  ds_read_b64_tr_b16 a[88:89], v19 offset:16384
  ds_read_b64_tr_b16 a[90:91], v19 offset:20480
  s_xor_b32 m0, s36, 11264
  s_xor_b32 s3, s38, 458752
  buffer_load_dwordx4 v7, s[16:19], s3 offen lds
  ds_read_b64_tr_b16 a[96:97], v20 offset:16384
  ds_read_b64_tr_b16 a[98:99], v20 offset:20480
  s_xor_b32 m0, s36, 12288
  s_xor_b32 s3, s38, 294912
  buffer_load_dwordx4 v6, s[16:19], s3 offen lds
  ds_read_b64_tr_b16 a[104:105], v21 offset:16384
  ds_read_b64_tr_b16 a[106:107], v21 offset:20480
  s_xor_b32 m0, s36, 13312
  s_xor_b32 s3, s38, 360448
  buffer_load_dwordx4 v7, s[16:19], s3 offen lds
  ds_read_b64_tr_b16 a[112:113], v22 offset:16384
  ds_read_b64_tr_b16 a[114:115], v22 offset:20480
  s_xor_b32 m0, s36, 14336
  s_xor_b32 s3, s38, 425984
  buffer_load_dwordx4 v6, s[16:19], s3 offen lds
  ds_read_b64_tr_b16 a[120:121], v23 offset:16384
  ds_read_b64_tr_b16 a[122:123], v23 offset:20480
  s_xor_b32 m0, s36, 15360
  s_xor_b32 s3, s38, 491520
  buffer_load_dwordx4 v7, s[16:19], s3 offen lds
  s_waitcnt vmcnt(16) lgkmcnt(0)
  s_barrier
  ds_read_b64_tr_b16 a[68:69], v16 offset:24576
  ds_read_b64_tr_b16 a[70:71], v16 offset:28672
  s_xor_b32 m0, s36, 16384
  s_xor_b32 s3, s38, 2097152
  buffer_load_dwordx4 v6, s[16:19], s3 offen lds
  ds_read_b64_tr_b16 a[76:77], v17 offset:24576
  ds_read_b64_tr_b16 a[78:79], v17 offset:28672
  s_xor_b32 m0, s36, 17408
  s_xor_b32 s3, s38, 2162688
  buffer_load_dwordx4 v7, s[16:19], s3 offen lds
  ds_read_b64_tr_b16 a[84:85], v18 offset:24576
  ds_read_b64_tr_b16 a[86:87], v18 offset:28672
  s_xor_b32 m0, s36, 18432
  s_xor_b32 s3, s38, 2228224
  buffer_load_dwordx4 v6, s[16:19], s3 offen lds
  ds_read_b64_tr_b16 a[92:93], v19 offset:24576
  ds_read_b64_tr_b16 a[94:95], v19 offset:28672
  s_xor_b32 m0, s36, 19456
  s_xor_b32 s3, s38, 2293760
  buffer_load_dwordx4 v7, s[16:19], s3 offen lds
  ds_read_b64_tr_b16 a[100:101], v20 offset:24576
  ds_read_b64_tr_b16 a[102:103], v20 offset:28672
  s_xor_b32 m0, s36, 20480
  s_xor_b32 s3, s38, 2129920
  buffer_load_dwordx4 v6, s[16:19], s3 offen lds
  ds_read_b64_tr_b16 a[108:109], v21 offset:24576
  ds_read_b64_tr_b16 a[110:111], v21 offset:28672
  s_xor_b32 m0, s36, 21504
  s_xor_b32 s3, s38, 2195456
  buffer_load_dwordx4 v7, s[16:19], s3 offen lds
  ds_read_b64_tr_b16 a[116:117], v22 offset:24576
  ds_read_b64_tr_b16 a[118:119], v22 offset:28672
  s_xor_b32 m0, s36, 22528
  s_xor_b32 s3, s38, 2260992
  buffer_load_dwordx4 v6, s[16:19], s3 offen lds
  ds_read_b64_tr_b16 a[124:125], v23 offset:24576
  ds_read_b64_tr_b16 a[126:127], v23 offset:28672
  s_xor_b32 m0, s36, 23552
  s_xor_b32 s3, s38, 2326528
  buffer_load_dwordx4 v7, s[16:19], s3 offen lds
  s_waitcnt vmcnt(16) lgkmcnt(0)
  s_barrier
  ds_read_b64_tr_b16 a[128:129], v16 offset:0
  ds_read_b64_tr_b16 a[130:131], v16 offset:4096
  s_xor_b32 m0, s36, 24576
  s_xor_b32 s3, s38, 2359296
  buffer_load_dwordx4 v6, s[16:19], s3 offen lds
  ds_read_b64_tr_b16 a[136:137], v17 offset:0
  ds_read_b64_tr_b16 a[138:139], v17 offset:4096
  s_xor_b32 m0, s36, 25600
  s_xor_b32 s3, s38, 2424832
  buffer_load_dwordx4 v7, s[16:19], s3 offen lds
  ds_read_b64_tr_b16 a[144:145], v18 offset:0
  ds_read_b64_tr_b16 a[146:147], v18 offset:4096
  s_xor_b32 m0, s36, 26624
  s_xor_b32 s3, s38, 2490368
  buffer_load_dwordx4 v6, s[16:19], s3 offen lds
  ds_read_b64_tr_b16 a[152:153], v19 offset:0
  ds_read_b64_tr_b16 a[154:155], v19 offset:4096
  s_xor_b32 m0, s36, 27648
  s_xor_b32 s3, s38, 2555904
  buffer_load_dwordx4 v7, s[16:19], s3 offen lds
  ds_read_b64_tr_b16 a[160:161], v20 offset:0
  ds_read_b64_tr_b16 a[162:163], v20 offset:4096
  s_xor_b32 m0, s36, 28672
  s_xor_b32 s3, s38, 2392064
  buffer_load_dwordx4 v6, s[16:19], s3 offen lds
  ds_read_b64_tr_b16 a[168:169], v21 offset:0
  ds_read_b64_tr_b16 a[170:171], v21 offset:4096
  s_xor_b32 m0, s36, 29696
  s_xor_b32 s3, s38, 2457600
  buffer_load_dwordx4 v7, s[16:19], s3 offen lds
  ds_read_b64_tr_b16 a[176:177], v22 offset:0
  ds_read_b64_tr_b16 a[178:179], v22 offset:4096
  s_xor_b32 m0, s36, 30720
  s_xor_b32 s3, s38, 2523136
  buffer_load_dwordx4 v6, s[16:19], s3 offen lds
  ds_read_b64_tr_b16 a[184:185], v23 offset:0
  ds_read_b64_tr_b16 a[186:187], v23 offset:4096
  s_xor_b32 m0, s36, 31744
  s_xor_b32 s3, s38, 2588672
  buffer_load_dwordx4 v7, s[16:19], s3 offen lds
  s_waitcnt vmcnt(16) lgkmcnt(0)
  s_barrier
  ds_read_b64_tr_b16 a[132:133], v16 offset:8192
  ds_read_b64_tr_b16 a[134:135], v16 offset:12288
  s_xor_b32 m0, s36, 0
  s_xor_b32 s3, s38, 0
  buffer_load_dwordx4 v6, s[20:23], s3 offen lds
  ds_read_b64_tr_b16 a[140:141], v17 offset:8192
  ds_read_b64_tr_b16 a[142:143], v17 offset:12288
  s_xor_b32 m0, s36, 1024
  s_xor_b32 s3, s38, 65536
  buffer_load_dwordx4 v7, s[20:23], s3 offen lds
  ds_read_b64_tr_b16 a[148:149], v18 offset:8192
  ds_read_b64_tr_b16 a[150:151], v18 offset:12288
  s_xor_b32 m0, s36, 2048
  s_xor_b32 s3, s38, 131072
  buffer_load_dwordx4 v6, s[20:23], s3 offen lds
  ds_read_b64_tr_b16 a[156:157], v19 offset:8192
  ds_read_b64_tr_b16 a[158:159], v19 offset:12288
  s_xor_b32 m0, s36, 3072
  s_xor_b32 s3, s38, 196608
  buffer_load_dwordx4 v7, s[20:23], s3 offen lds
  ds_read_b64_tr_b16 a[164:165], v20 offset:8192
  ds_read_b64_tr_b16 a[166:167], v20 offset:12288
  s_xor_b32 m0, s36, 4096
  s_xor_b32 s3, s38, 32768
  buffer_load_dwordx4 v6, s[20:23], s3 offen lds
  ds_read_b64_tr_b16 a[172:173], v21 offset:8192
  ds_read_b64_tr_b16 a[174:175], v21 offset:12288
  s_xor_b32 m0, s36, 5120
  s_xor_b32 s3, s38, 98304
  buffer_load_dwordx4 v7, s[20:23], s3 offen lds
  ds_read_b64_tr_b16 a[180:181], v22 offset:8192
  ds_read_b64_tr_b16 a[182:183], v22 offset:12288
  s_xor_b32 m0, s36, 6144
  s_xor_b32 s3, s38, 163840
  buffer_load_dwordx4 v6, s[20:23], s3 offen lds
  ds_read_b64_tr_b16 a[188:189], v23 offset:8192
  ds_read_b64_tr_b16 a[190:191], v23 offset:12288
  s_xor_b32 m0, s36, 7168
  s_xor_b32 s3, s38, 229376
  buffer_load_dwordx4 v7, s[20:23], s3 offen lds
  s_waitcnt vmcnt(16) lgkmcnt(0)
  s_barrier
  ds_read_b64_tr_b16 a[192:193], v16 offset:16384
  ds_read_b64_tr_b16 a[194:195], v16 offset:20480
  s_xor_b32 m0, s36, 8192
  s_xor_b32 s3, s38, 262144
  buffer_load_dwordx4 v6, s[20:23], s3 offen lds
  ds_read_b64_tr_b16 a[200:201], v17 offset:16384
  ds_read_b64_tr_b16 a[202:203], v17 offset:20480
  s_xor_b32 m0, s36, 9216
  s_xor_b32 s3, s38, 327680
  buffer_load_dwordx4 v7, s[20:23], s3 offen lds
  ds_read_b64_tr_b16 a[208:209], v18 offset:16384
  ds_read_b64_tr_b16 a[210:211], v18 offset:20480
  s_xor_b32 m0, s36, 10240
  s_xor_b32 s3, s38, 393216
  buffer_load_dwordx4 v6, s[20:23], s3 offen lds
  ds_read_b64_tr_b16 a[216:217], v19 offset:16384
  ds_read_b64_tr_b16 a[218:219], v19 offset:20480
  s_xor_b32 m0, s36, 11264
  s_xor_b32 s3, s38, 458752
  buffer_load_dwordx4 v7, s[20:23], s3 offen lds
  ds_read_b64_tr_b16 a[224:225], v20 offset:16384
  ds_read_b64_tr_b16 a[226:227], v20 offset:20480
  s_xor_b32 m0, s36, 12288
  s_xor_b32 s3, s38, 294912
  buffer_load_dwordx4 v6, s[20:23], s3 offen lds
  ds_read_b64_tr_b16 a[232:233], v21 offset:16384
  ds_read_b64_tr_b16 a[234:235], v21 offset:20480
  s_xor_b32 m0, s36, 13312
  s_xor_b32 s3, s38, 360448
  buffer_load_dwordx4 v7, s[20:23], s3 offen lds
  ds_read_b64_tr_b16 a[240:241], v22 offset:16384
  ds_read_b64_tr_b16 a[242:243], v22 offset:20480
  s_xor_b32 m0, s36, 14336
  s_xor_b32 s3, s38, 425984
  buffer_load_dwordx4 v6, s[20:23], s3 offen lds
  ds_read_b64_tr_b16 a[248:249], v23 offset:16384
  ds_read_b64_tr_b16 a[250:251], v23 offset:20480
  s_xor_b32 m0, s36, 15360
  s_xor_b32 s3, s38, 491520
  buffer_load_dwordx4 v7, s[20:23], s3 offen lds
  s_waitcnt vmcnt(16) lgkmcnt(0)
  s_barrier
  ds_read_b64_tr_b16 a[196:197], v16 offset:24576
  ds_read_b64_tr_b16 a[198:199], v16 offset:28672
  s_xor_b32 m0, s36, 16384
  s_xor_b32 s3, s38, 2097152
  buffer_load_dwordx4 v6, s[20:23], s3 offen lds
  ds_read_b64_tr_b16 a[204:205], v17 offset:24576
  ds_read_b64_tr_b16 a[206:207], v17 offset:28672
  s_xor_b32 m0, s36, 17408
  s_xor_b32 s3, s38, 2162688
  buffer_load_dwordx4 v7, s[20:23], s3 offen lds
  ds_read_b64_tr_b16 a[212:213], v18 offset:24576
  ds_read_b64_tr_b16 a[214:215], v18 offset:28672
  s_xor_b32 m0, s36, 18432
  s_xor_b32 s3, s38, 2228224
  buffer_load_dwordx4 v6, s[20:23], s3 offen lds
  ds_read_b64_tr_b16 a[220:221], v19 offset:24576
  ds_read_b64_tr_b16 a[222:223], v19 offset:28672
  s_xor_b32 m0, s36, 19456
  s_xor_b32 s3, s38, 2293760
  buffer_load_dwordx4 v7, s[20:23], s3 offen lds
  ds_read_b64_tr_b16 a[228:229], v20 offset:24576
  ds_read_b64_tr_b16 a[230:231], v20 offset:28672
  s_xor_b32 m0, s36, 20480
  s_xor_b32 s3, s38, 2129920
  buffer_load_dwordx4 v6, s[20:23], s3 offen lds
  ds_read_b64_tr_b16 a[236:237], v21 offset:24576
  ds_read_b64_tr_b16 a[238:239], v21 offset:28672
  s_xor_b32 m0, s36, 21504
  s_xor_b32 s3, s38, 2195456
  buffer_load_dwordx4 v7, s[20:23], s3 offen lds
  ds_read_b64_tr_b16 a[244:245], v22 offset:24576
  ds_read_b64_tr_b16 a[246:247], v22 offset:28672
  s_xor_b32 m0, s36, 22528
  s_xor_b32 s3, s38, 2260992
  buffer_load_dwordx4 v6, s[20:23], s3 offen lds
  ds_read_b64_tr_b16 a[252:253], v23 offset:24576
  ds_read_b64_tr_b16 a[254:255], v23 offset:28672
  s_xor_b32 m0, s36, 23552
  s_xor_b32 s3, s38, 2326528
  buffer_load_dwordx4 v7, s[20:23], s3 offen lds
  s_lshl_b32 s7, s34, 15
  s_add_u32 m0, s37, 0
  s_xor_b32 s3, s39, 0
  s_add_u32 s3, s3, s7
  buffer_load_dwordx4 v8, s[24:27], s3 offen lds
  s_add_u32 m0, s37, 4096
  s_xor_b32 s3, s39, 128
  s_add_u32 s3, s3, s7
  buffer_load_dwordx4 v8, s[24:27], s3 offen lds
  s_add_u32 m0, s37, 8192
  s_xor_b32 s3, s39, 256
  s_add_u32 s3, s3, s7
  buffer_load_dwordx4 v8, s[24:27], s3 offen lds
  s_add_u32 m0, s37, 12288
  s_xor_b32 s3, s39, 384
  s_add_u32 s3, s3, s7
  buffer_load_dwordx4 v8, s[24:27], s3 offen lds
  s_add_u32 m0, s37, 16384
  s_xor_b32 s3, s39, 512
  s_add_u32 s3, s3, s7
  buffer_load_dwordx4 v8, s[24:27], s3 offen lds
  s_add_u32 m0, s37, 20480
  s_xor_b32 s3, s39, 640
  s_add_u32 s3, s3, s7
  buffer_load_dwordx4 v8, s[24:27], s3 offen lds
  s_add_u32 m0, s37, 24576
  s_xor_b32 s3, s39, 768
  s_add_u32 s3, s3, s7
  buffer_load_dwordx4 v8, s[24:27], s3 offen lds
  s_add_u32 m0, s37, 28672
  s_xor_b32 s3, s39, 896
  s_add_u32 s3, s3, s7
  buffer_load_dwordx4 v8, s[24:27], s3 offen lds
  s_waitcnt vmcnt(24) lgkmcnt(0)
  s_barrier
  ds_read_b64_tr_b16 v[128:129], v16 offset:0
  ds_read_b64_tr_b16 v[130:131], v16 offset:4096
  s_xor_b32 m0, s36, 24576
  s_xor_b32 s3, s38, 2359296
  buffer_load_dwordx4 v6, s[20:23], s3 offen lds
  ds_read_b64_tr_b16 v[136:137], v17 offset:0
  ds_read_b64_tr_b16 v[138:139], v17 offset:4096
  s_xor_b32 m0, s36, 25600
  s_xor_b32 s3, s38, 2424832
  buffer_load_dwordx4 v7, s[20:23], s3 offen lds
  ds_read_b64_tr_b16 v[144:145], v18 offset:0
  ds_read_b64_tr_b16 v[146:147], v18 offset:4096
  s_xor_b32 m0, s36, 26624
  s_xor_b32 s3, s38, 2490368
  buffer_load_dwordx4 v6, s[20:23], s3 offen lds
  ds_read_b64_tr_b16 v[152:153], v19 offset:0
  ds_read_b64_tr_b16 v[154:155], v19 offset:4096
  s_xor_b32 m0, s36, 27648
  s_xor_b32 s3, s38, 2555904
  buffer_load_dwordx4 v7, s[20:23], s3 offen lds
  ds_read_b64_tr_b16 v[160:161], v20 offset:0
  ds_read_b64_tr_b16 v[162:163], v20 offset:4096
  s_xor_b32 m0, s36, 28672
  s_xor_b32 s3, s38, 2392064
  buffer_load_dwordx4 v6, s[20:23], s3 offen lds
  ds_read_b64_tr_b16 v[168:169], v21 offset:0
  ds_read_b64_tr_b16 v[170:171], v21 offset:4096
  s_xor_b32 m0, s36, 29696
  s_xor_b32 s3, s38, 2457600
  buffer_load_dwordx4 v7, s[20:23], s3 offen lds
  ds_read_b64_tr_b16 v[176:177], v22 offset:0
  ds_read_b64_tr_b16 v[178:179], v22 offset:4096
  s_xor_b32 m0, s36, 30720
  s_xor_b32 s3, s38, 2523136
  buffer_load_dwordx4 v6, s[20:23], s3 offen lds
  ds_read_b64_tr_b16 v[184:185], v23 offset:0
  ds_read_b64_tr_b16 v[186:187], v23 offset:4096
  s_xor_b32 m0, s36, 31744
  s_xor_b32 s3, s38, 2588672
  buffer_load_dwordx4 v7, s[20:23], s3 offen lds
  v_lshrrev_b32 v4, 4, v2
  v_min_u32 v4, 170, v4
  v_lshlrev_b32 v4, 7, v4
  s_mul_i32 s3, s31, 21888
  buffer_load_dword v15, v4, s[48:51], s3 offen
  s_lshl_b32 s3, s32, 2
  s_mov_b64 exec, 1
  buffer_load_dword v11, off, s[52:55], s3 sc1
  s_mov_b64 exec, -1
  s_waitcnt vmcnt(26) lgkmcnt(0)
  s_barrier
  ds_read_b64_tr_b16 v[132:133], v16 offset:8192
  ds_read_b64_tr_b16 v[134:135], v16 offset:12288
  ds_read_b64_tr_b16 v[140:141], v17 offset:8192
  ds_read_b64_tr_b16 v[142:143], v17 offset:12288
  ds_read_b64_tr_b16 v[148:149], v18 offset:8192
  ds_read_b64_tr_b16 v[150:151], v18 offset:12288
  ds_read_b64_tr_b16 v[156:157], v19 offset:8192
  ds_read_b64_tr_b16 v[158:159], v19 offset:12288
  s_waitcnt lgkmcnt(4)
  ds_read_b64_tr_b16 v[164:165], v20 offset:8192
  ds_read_b64_tr_b16 v[166:167], v20 offset:12288
  ds_read_b64_tr_b16 v[172:173], v21 offset:8192
  ds_read_b64_tr_b16 v[174:175], v21 offset:12288
  ds_read_b64_tr_b16 v[180:181], v22 offset:8192
  ds_read_b64_tr_b16 v[182:183], v22 offset:12288
  ds_read_b64_tr_b16 v[188:189], v23 offset:8192
  ds_read_b64_tr_b16 v[190:191], v23 offset:12288
  s_waitcnt vmcnt(18) lgkmcnt(0)
  s_barrier
  ds_read_b64_tr_b16 v[192:193], v16 offset:16384
  ds_read_b64_tr_b16 v[194:195], v16 offset:20480
  ds_read_b64_tr_b16 v[200:201], v17 offset:16384
  ds_read_b64_tr_b16 v[202:203], v17 offset:20480
  ds_read_b64_tr_b16 v[208:209], v18 offset:16384
  ds_read_b64_tr_b16 v[210:211], v18 offset:20480
  ds_read_b64_tr_b16 v[216:217], v19 offset:16384
  ds_read_b64_tr_b16 v[218:219], v19 offset:20480
  s_waitcnt lgkmcnt(4)
  ds_read_b64_tr_b16 v[224:225], v20 offset:16384
  ds_read_b64_tr_b16 v[226:227], v20 offset:20480
  ds_read_b64_tr_b16 v[232:233], v21 offset:16384
  ds_read_b64_tr_b16 v[234:235], v21 offset:20480
  ds_read_b64_tr_b16 v[240:241], v22 offset:16384
  ds_read_b64_tr_b16 v[242:243], v22 offset:20480
  ds_read_b64_tr_b16 v[248:249], v23 offset:16384
  ds_read_b64_tr_b16 v[250:251], v23 offset:20480
  s_waitcnt vmcnt(2) lgkmcnt(0)
  s_barrier
  ds_read_b64_tr_b16 v[196:197], v16 offset:24576
  ds_read_b64_tr_b16 v[198:199], v16 offset:28672
  ds_read_b64_tr_b16 v[204:205], v17 offset:24576
  ds_read_b64_tr_b16 v[206:207], v17 offset:28672
  ds_read_b64_tr_b16 v[212:213], v18 offset:24576
  ds_read_b64_tr_b16 v[214:215], v18 offset:28672
  ds_read_b64_tr_b16 v[220:221], v19 offset:24576
  ds_read_b64_tr_b16 v[222:223], v19 offset:28672
  s_waitcnt lgkmcnt(4)
  ds_read_b64_tr_b16 v[228:229], v20 offset:24576
  ds_read_b64_tr_b16 v[230:231], v20 offset:28672
  ds_read_b64_tr_b16 v[236:237], v21 offset:24576
  ds_read_b64_tr_b16 v[238:239], v21 offset:28672
  ds_read_b64_tr_b16 v[244:245], v22 offset:24576
  ds_read_b64_tr_b16 v[246:247], v22 offset:28672
  ds_read_b64_tr_b16 v[252:253], v23 offset:24576
  ds_read_b64_tr_b16 v[254:255], v23 offset:28672
  s_waitcnt lgkmcnt(0)
  v_mov_b32 v104, -1
  v_mov_b32 v105, -1
  v_mov_b32 v106, -1
  v_mov_b32 v107, -1
  s_mov_b32 s40, 268435456
  s_mov_b32 s41, 268435456
  s_mov_b32 s42, 268435456
  v_mov_b32 v80, 0
  v_mov_b32 v81, 0
  v_mov_b32 v82, 0
  v_mov_b32 v83, 0
  v_mov_b32 v84, 0
  v_mov_b32 v85, 0
  v_mov_b32 v86, 0
  v_mov_b32 v87, 0
  v_mov_b32 v88, 0
  v_mov_b32 v89, 0
  v_mov_b32 v90, 0
  v_mov_b32 v91, 0
  v_mov_b32 v92, 0
  v_mov_b32 v93, 0
  v_mov_b32 v94, 0
  v_mov_b32 v95, 0
  v_mov_b32 v96, 0
  v_mov_b32 v97, 0
  v_mov_b32 v98, 0
  v_mov_b32 v99, 0
  v_mov_b32 v100, 0
  v_mov_b32 v101, 0
  v_mov_b32 v102, 0
  v_mov_b32 v103, 0
A_top_17:
  s_waitcnt vmcnt(0)
  s_barrier
  ds_read_b128 v[64:67], v9 offset:0
  ds_read_b128 v[68:71], v9 offset:2048
  s_sub_u32 s6, s35, 1
  s_cmp_lt_u32 s35, 3
  s_cbranch_scc1 A_np_19
  s_cmp_lg_u32 s29, 0
  s_cbranch_scc1 W_pub_20
  v_mov_b32 v4, s6
  s_mov_b64 exec, 1
  buffer_store_dword v4, off, s[8:11], s43 sc1
  s_mov_b64 exec, -1
W_pub_20:
A_np_19:
  s_xor_b32 s37, s37, 32768
  s_add_u32 s7, s34, 6
  s_lshl_b32 s7, s7, 15
  s_waitcnt lgkmcnt(0)
  v_mfma_f32_16x16x32_bf16 v[16:19], a[0:3], v[64:67], 0
  ds_read_b128 v[72:75], v10 offset:0
  v_mfma_f32_16x16x32_bf16 v[20:23], a[8:11], v[64:67], 0
  ds_read_b128 v[76:79], v10 offset:2048
  v_mfma_f32_16x16x32_bf16 v[24:27], a[0:3], v[68:71], 0
  v_mfma_f32_16x16x32_bf16 v[28:31], a[8:11], v[68:71], 0
  s_add_u32 m0, s37, 0
  s_xor_b32 s3, s39, 0
  s_add_u32 s3, s3, s7
  buffer_load_dwordx4 v8, s[24:27], s3 offen lds
  v_mfma_f32_16x16x32_bf16 v[32:35], v[64:67], a[128:131], 0
  v_mfma_f32_16x16x32_bf16 v[40:43], v[64:67], a[136:139], 0
  v_mfma_f32_16x16x32_bf16 v[36:39], v[68:71], a[128:131], 0
  v_mfma_f32_16x16x32_bf16 v[44:47], v[68:71], a[136:139], 0
  buffer_store_dwordx4 v[80:83], v2, s[8:11], s40 offen sc1
  s_add_u32 s40, s40, 4096
  v_mfma_f32_16x16x32_bf16 v[48:51], v[128:131], v[64:67], 0
  v_mfma_f32_16x16x32_bf16 v[52:55], v[136:139], v[64:67], 0
  v_mfma_f32_16x16x32_bf16 v[56:59], v[128:131], v[68:71], 0
  v_mfma_f32_16x16x32_bf16 v[60:63], v[136:139], v[68:71], 0
  s_waitcnt lgkmcnt(0)
  v_mfma_f32_16x16x32_bf16 v[16:19], a[4:7], v[72:75], v[16:19]
  ds_read_b128 v[64:67], v9 offset:4096
  v_mfma_f32_16x16x32_bf16 v[20:23], a[12:15], v[72:75], v[20:23]
  ds_read_b128 v[68:71], v9 offset:6144
  v_mfma_f32_16x16x32_bf16 v[24:27], a[4:7], v[76:79], v[24:27]
  v_mfma_f32_16x16x32_bf16 v[28:31], a[12:15], v[76:79], v[28:31]
  s_add_u32 m0, s37, 4096
  s_xor_b32 s3, s39, 128
  s_add_u32 s3, s3, s7
  buffer_load_dwordx4 v8, s[24:27], s3 offen lds
  v_mfma_f32_16x16x32_bf16 v[32:35], v[72:75], a[132:135], v[32:35]
  v_mfma_f32_16x16x32_bf16 v[40:43], v[72:75], a[140:143], v[40:43]
  v_mfma_f32_16x16x32_bf16 v[36:39], v[76:79], a[132:135], v[36:39]
  v_mfma_f32_16x16x32_bf16 v[44:47], v[76:79], a[140:143], v[44:47]
  buffer_store_dwordx4 v[84:87], v2, s[8:11], s40 offen sc1
  s_add_u32 s40, s40, 4096
  v_mfma_f32_16x16x32_bf16 v[48:51], v[132:135], v[72:75], v[48:51]
  v_mfma_f32_16x16x32_bf16 v[52:55], v[140:143], v[72:75], v[52:55]
  v_mfma_f32_16x16x32_bf16 v[56:59], v[132:135], v[76:79], v[56:59]
  v_mfma_f32_16x16x32_bf16 v[60:63], v[140:143], v[76:79], v[60:63]
  s_waitcnt lgkmcnt(0)
  v_mfma_f32_16x16x32_bf16 v[16:19], a[16:19], v[64:67], v[16:19]
  ds_read_b128 v[72:75], v10 offset:4096
  v_mfma_f32_16x16x32_bf16 v[20:23], a[24:27], v[64:67], v[20:23]
  ds_read_b128 v[76:79], v10 offset:6144
  v_mfma_f32_16x16x32_bf16 v[24:27], a[16:19], v[68:71], v[24:27]
  v_mfma_f32_16x16x32_bf16 v[28:31], a[24:27], v[68:71], v[28:31]
  s_add_u32 m0, s37, 8192
  s_xor_b32 s3, s39, 256
  s_add_u32 s3, s3, s7
  buffer_load_dwordx4 v8, s[24:27], s3 offen lds
  v_mfma_f32_16x16x32_bf16 v[32:35], v[64:67], a[144:147], v[32:35]
  v_mfma_f32_16x16x32_bf16 v[40:43], v[64:67], a[152:155], v[40:43]
  v_mfma_f32_16x16x32_bf16 v[36:39], v[68:71], a[144:147], v[36:39]
  v_mfma_f32_16x16x32_bf16 v[44:47], v[68:71], a[152:155], v[44:47]
  buffer_store_dwordx4 v[88:91], v3, s[8:11], s40 offen sc1
  v_mfma_f32_16x16x32_bf16 v[48:51], v[144:147], v[64:67], v[48:51]
  v_mfma_f32_16x16x32_bf16 v[52:55], v[152:155], v[64:67], v[52:55]
  v_mfma_f32_16x16x32_bf16 v[56:59], v[144:147], v[68:71], v[56:59]
  v_mfma_f32_16x16x32_bf16 v[60:63], v[152:155], v[68:71], v[60:63]
  s_waitcnt lgkmcnt(0)
  v_mfma_f32_16x16x32_bf16 v[16:19], a[20:23], v[72:75], v[16:19]
  ds_read_b128 v[64:67], v9 offset:8192
  v_mfma_f32_16x16x32_bf16 v[20:23], a[28:31], v[72:75], v[20:23]
  ds_read_b128 v[68:71], v9 offset:10240
  v_mfma_f32_16x16x32_bf16 v[24:27], a[20:23], v[76:79], v[24:27]
  v_mfma_f32_16x16x32_bf16 v[28:31], a[28:31], v[76:79], v[28:31]
  s_add_u32 m0, s37, 12288
  s_xor_b32 s3, s39, 384
  s_add_u32 s3, s3, s7
  buffer_load_dwordx4 v8, s[24:27], s3 offen lds
  v_mfma_f32_16x16x32_bf16 v[32:35], v[72:75], a[148:151], v[32:35]
  v_mfma_f32_16x16x32_bf16 v[40:43], v[72:75], a[156:159], v[40:43]
  v_mfma_f32_16x16x32_bf16 v[36:39], v[76:79], a[148:151], v[36:39]
  v_mfma_f32_16x16x32_bf16 v[44:47], v[76:79], a[156:159], v[44:47]
  buffer_store_dwordx4 v[92:95], v3, s[8:11], s40 offen offset:1024 sc1
  v_mfma_f32_16x16x32_bf16 v[48:51], v[148:151], v[72:75], v[48:51]
  v_mfma_f32_16x16x32_bf16 v[52:55], v[156:159], v[72:75], v[52:55]
  v_mfma_f32_16x16x32_bf16 v[56:59], v[148:151], v[76:79], v[56:59]
  v_mfma_f32_16x16x32_bf16 v[60:63], v[156:159], v[76:79], v[60:63]
  s_waitcnt lgkmcnt(0)
  v_mfma_f32_16x16x32_bf16 v[16:19], a[32:35], v[64:67], v[16:19]
  ds_read_b128 v[72:75], v10 offset:8192
  v_mfma_f32_16x16x32_bf16 v[20:23], a[40:43], v[64:67], v[20:23]
  ds_read_b128 v[76:79], v10 offset:10240
  v_mfma_f32_16x16x32_bf16 v[24:27], a[32:35], v[68:71], v[24:27]
  v_mfma_f32_16x16x32_bf16 v[28:31], a[40:43], v[68:71], v[28:31]
  s_add_u32 m0, s37, 16384
  s_xor_b32 s3, s39, 512
  s_add_u32 s3, s3, s7
  buffer_load_dwordx4 v8, s[24:27], s3 offen lds
  v_mfma_f32_16x16x32_bf16 v[32:35], v[64:67], a[160:163], v[32:35]
  v_mfma_f32_16x16x32_bf16 v[40:43], v[64:67], a[168:171], v[40:43]
  v_mfma_f32_16x16x32_bf16 v[36:39], v[68:71], a[160:163], v[36:39]
  v_mfma_f32_16x16x32_bf16 v[44:47], v[68:71], a[168:171], v[44:47]
  buffer_store_dwordx4 v[104:107], v2, s[8:11], s42 offen sc1
  v_mfma_f32_16x16x32_bf16 v[48:51], v[160:163], v[64:67], v[48:51]
  v_mfma_f32_16x16x32_bf16 v[52:55], v[168:171], v[64:67], v[52:55]
  v_mfma_f32_16x16x32_bf16 v[56:59], v[160:163], v[68:71], v[56:59]
  v_mfma_f32_16x16x32_bf16 v[60:63], v[168:171], v[68:71], v[60:63]
  s_waitcnt lgkmcnt(0)
  v_mfma_f32_16x16x32_bf16 v[16:19], a[36:39], v[72:75], v[16:19]
  ds_read_b128 v[64:67], v9 offset:12288
  v_mfma_f32_16x16x32_bf16 v[20:23], a[44:47], v[72:75], v[20:23]
  ds_read_b128 v[68:71], v9 offset:14336
  v_mfma_f32_16x16x32_bf16 v[24:27], a[36:39], v[76:79], v[24:27]
  v_mfma_f32_16x16x32_bf16 v[28:31], a[44:47], v[76:79], v[28:31]
  s_add_u32 m0, s37, 20480
  s_xor_b32 s3, s39, 640
  s_add_u32 s3, s3, s7
  buffer_load_dwordx4 v8, s[24:27], s3 offen lds
  v_mfma_f32_16x16x32_bf16 v[32:35], v[72:75], a[164:167], v[32:35]
  v_mfma_f32_16x16x32_bf16 v[40:43], v[72:75], a[172:175], v[40:43]
  v_mfma_f32_16x16x32_bf16 v[36:39], v[76:79], a[164:167], v[36:39]
  v_mfma_f32_16x16x32_bf16 v[44:47], v[76:79], a[172:175], v[44:47]
  buffer_store_dwordx4 v[96:99], v2, s[8:11], s41 offen sc1
  s_add_u32 s41, s41, 4096
  v_mfma_f32_16x16x32_bf16 v[48:51], v[164:167], v[72:75], v[48:51]
  v_mfma_f32_16x16x32_bf16 v[52:55], v[172:175], v[72:75], v[52:55]
  v_mfma_f32_16x16x32_bf16 v[56:59], v[164:167], v[76:79], v[56:59]
  v_mfma_f32_16x16x32_bf16 v[60:63], v[172:175], v[76:79], v[60:63]
  s_waitcnt lgkmcnt(0)
  v_mfma_f32_16x16x32_bf16 v[16:19], a[48:51], v[64:67], v[16:19]
  ds_read_b128 v[72:75], v10 offset:12288
  v_mfma_f32_16x16x32_bf16 v[20:23], a[56:59], v[64:67], v[20:23]
  ds_read_b128 v[76:79], v10 offset:14336
  v_mfma_f32_16x16x32_bf16 v[24:27], a[48:51], v[68:71], v[24:27]
  v_mfma_f32_16x16x32_bf16 v[28:31], a[56:59], v[68:71], v[28:31]
  s_add_u32 m0, s37, 24576
  s_xor_b32 s3, s39, 768
  s_add_u32 s3, s3, s7
  buffer_load_dwordx4 v8, s[24:27], s3 offen lds
  v_mfma_f32_16x16x32_bf16 v[32:35], v[64:67], a[176:179], v[32:35]
  v_mfma_f32_16x16x32_bf16 v[40:43], v[64:67], a[184:187], v[40:43]
  v_mfma_f32_16x16x32_bf16 v[36:39], v[68:71], a[176:179], v[36:39]
  v_mfma_f32_16x16x32_bf16 v[44:47], v[68:71], a[184:187], v[44:47]
  buffer_store_dwordx4 v[100:103], v2, s[8:11], s41 offen sc1
  v_mfma_f32_16x16x32_bf16 v[48:51], v[176:179], v[64:67], v[48:51]
  v_mfma_f32_16x16x32_bf16 v[52:55], v[184:187], v[64:67], v[52:55]
  v_mfma_f32_16x16x32_bf16 v[56:59], v[176:179], v[68:71], v[56:59]
  v_mfma_f32_16x16x32_bf16 v[60:63], v[184:187], v[68:71], v[60:63]
  s_waitcnt lgkmcnt(0)
  v_mfma_f32_16x16x32_bf16 v[16:19], a[52:55], v[72:75], v[16:19]
  ds_read_b128 v[64:67], v9 offset:16384
  v_mfma_f32_16x16x32_bf16 v[20:23], a[60:63], v[72:75], v[20:23]
  ds_read_b128 v[68:71], v9 offset:18432
  v_mfma_f32_16x16x32_bf16 v[24:27], a[52:55], v[76:79], v[24:27]
  v_mfma_f32_16x16x32_bf16 v[28:31], a[60:63], v[76:79], v[28:31]
  s_add_u32 m0, s37, 28672
  s_xor_b32 s3, s39, 896
  s_add_u32 s3, s3, s7
  buffer_load_dwordx4 v8, s[24:27], s3 offen lds
  v_mfma_f32_16x16x32_bf16 v[32:35], v[72:75], a[180:183], v[32:35]
  v_mfma_f32_16x16x32_bf16 v[40:43], v[72:75], a[188:191], v[40:43]
  v_mfma_f32_16x16x32_bf16 v[36:39], v[76:79], a[180:183], v[36:39]
  v_mfma_f32_16x16x32_bf16 v[44:47], v[76:79], a[188:191], v[44:47]
  v_mfma_f32_16x16x32_bf16 v[48:51], v[180:183], v[72:75], v[48:51]
  v_mfma_f32_16x16x32_bf16 v[52:55], v[188:191], v[72:75], v[52:55]
  v_mfma_f32_16x16x32_bf16 v[56:59], v[180:183], v[76:79], v[56:59]
  v_mfma_f32_16x16x32_bf16 v[60:63], v[188:191], v[76:79], v[60:63]
  s_waitcnt lgkmcnt(0)
  v_mfma_f32_16x16x32_bf16 v[16:19], a[64:67], v[64:67], v[16:19]
  ds_read_b128 v[72:75], v10 offset:16384
  v_mfma_f32_16x16x32_bf16 v[20:23], a[72:75], v[64:67], v[20:23]
  ds_read_b128 v[76:79], v10 offset:18432
  v_mfma_f32_16x16x32_bf16 v[24:27], a[64:67], v[68:71], v[24:27]
  v_mfma_f32_16x16x32_bf16 v[28:31], a[72:75], v[68:71], v[28:31]
  v_mfma_f32_16x16x32_bf16 v[32:35], v[64:67], a[192:195], v[32:35]
  v_mfma_f32_16x16x32_bf16 v[40:43], v[64:67], a[200:203], v[40:43]
  v_mfma_f32_16x16x32_bf16 v[36:39], v[68:71], a[192:195], v[36:39]
  v_mfma_f32_16x16x32_bf16 v[44:47], v[68:71], a[200:203], v[44:47]
  v_mfma_f32_16x16x32_bf16 v[48:51], v[192:195], v[64:67], v[48:51]
  v_mfma_f32_16x16x32_bf16 v[52:55], v[200:203], v[64:67], v[52:55]
  v_mfma_f32_16x16x32_bf16 v[56:59], v[192:195], v[68:71], v[56:59]
  v_mfma_f32_16x16x32_bf16 v[60:63], v[200:203], v[68:71], v[60:63]
  s_waitcnt lgkmcnt(0)
  v_mfma_f32_16x16x32_bf16 v[16:19], a[68:71], v[72:75], v[16:19]
  ds_read_b128 v[64:67], v9 offset:20480
  v_mfma_f32_16x16x32_bf16 v[20:23], a[76:79], v[72:75], v[20:23]
  ds_read_b128 v[68:71], v9 offset:22528
  v_mfma_f32_16x16x32_bf16 v[24:27], a[68:71], v[76:79], v[24:27]
  v_mfma_f32_16x16x32_bf16 v[28:31], a[76:79], v[76:79], v[28:31]
  v_mfma_f32_16x16x32_bf16 v[32:35], v[72:75], a[196:199], v[32:35]
  v_mfma_f32_16x16x32_bf16 v[40:43], v[72:75], a[204:207], v[40:43]
  v_mfma_f32_16x16x32_bf16 v[36:39], v[76:79], a[196:199], v[36:39]
  v_mfma_f32_16x16x32_bf16 v[44:47], v[76:79], a[204:207], v[44:47]
  v_mfma_f32_16x16x32_bf16 v[48:51], v[196:199], v[72:75], v[48:51]
  v_mfma_f32_16x16x32_bf16 v[52:55], v[204:207], v[72:75], v[52:55]
  v_mfma_f32_16x16x32_bf16 v[56:59], v[196:199], v[76:79], v[56:59]
  v_mfma_f32_16x16x32_bf16 v[60:63], v[204:207], v[76:79], v[60:63]
  s_waitcnt lgkmcnt(0)
  v_mfma_f32_16x16x32_bf16 v[16:19], a[80:83], v[64:67], v[16:19]
  ds_read_b128 v[72:75], v10 offset:20480
  v_mfma_f32_16x16x32_bf16 v[20:23], a[88:91], v[64:67], v[20:23]
  ds_read_b128 v[76:79], v10 offset:22528
  v_mfma_f32_16x16x32_bf16 v[24:27], a[80:83], v[68:71], v[24:27]
  v_mfma_f32_16x16x32_bf16 v[28:31], a[88:91], v[68:71], v[28:31]
  v_mfma_f32_16x16x32_bf16 v[32:35], v[64:67], a[208:211], v[32:35]
  v_mfma_f32_16x16x32_bf16 v[40:43], v[64:67], a[216:219], v[40:43]
  v_mfma_f32_16x16x32_bf16 v[36:39], v[68:71], a[208:211], v[36:39]
  v_mfma_f32_16x16x32_bf16 v[44:47], v[68:71], a[216:219], v[44:47]
  v_mfma_f32_16x16x32_bf16 v[48:51], v[208:211], v[64:67], v[48:51]
  v_mfma_f32_16x16x32_bf16 v[52:55], v[216:219], v[64:67], v[52:55]
  v_mfma_f32_16x16x32_bf16 v[56:59], v[208:211], v[68:71], v[56:59]
  v_mfma_f32_16x16x32_bf16 v[60:63], v[216:219], v[68:71], v[60:63]
  s_waitcnt lgkmcnt(0)
  v_mfma_f32_16x16x32_bf16 v[16:19], a[84:87], v[72:75], v[16:19]
  ds_read_b128 v[64:67], v9 offset:24576
  v_mfma_f32_16x16x32_bf16 v[20:23], a[92:95], v[72:75], v[20:23]
  ds_read_b128 v[68:71], v9 offset:26624
  v_mfma_f32_16x16x32_bf16 v[24:27], a[84:87], v[76:79], v[24:27]
  v_mfma_f32_16x16x32_bf16 v[28:31], a[92:95], v[76:79], v[28:31]
  v_mfma_f32_16x16x32_bf16 v[32:35], v[72:75], a[212:215], v[32:35]
  v_mfma_f32_16x16x32_bf16 v[40:43], v[72:75], a[220:223], v[40:43]
  v_mfma_f32_16x16x32_bf16 v[36:39], v[76:79], a[212:215], v[36:39]
  v_mfma_f32_16x16x32_bf16 v[44:47], v[76:79], a[220:223], v[44:47]
  v_mfma_f32_16x16x32_bf16 v[48:51], v[212:215], v[72:75], v[48:51]
  v_mfma_f32_16x16x32_bf16 v[52:55], v[220:223], v[72:75], v[52:55]
  v_mfma_f32_16x16x32_bf16 v[56:59], v[212:215], v[76:79], v[56:59]
  v_mfma_f32_16x16x32_bf16 v[60:63], v[220:223], v[76:79], v[60:63]
  s_waitcnt lgkmcnt(0)
  v_mfma_f32_16x16x32_bf16 v[16:19], a[96:99], v[64:67], v[16:19]
  ds_read_b128 v[72:75], v10 offset:24576
  v_mfma_f32_16x16x32_bf16 v[20:23], a[104:107], v[64:67], v[20:23]
  ds_read_b128 v[76:79], v10 offset:26624
  v_mfma_f32_16x16x32_bf16 v[24:27], a[96:99], v[68:71], v[24:27]
  v_mfma_f32_16x16x32_bf16 v[28:31], a[104:107], v[68:71], v[28:31]
  v_mfma_f32_16x16x32_bf16 v[32:35], v[64:67], a[224:227], v[32:35]
  v_mfma_f32_16x16x32_bf16 v[40:43], v[64:67], a[232:235], v[40:43]
  v_mfma_f32_16x16x32_bf16 v[36:39], v[68:71], a[224:227], v[36:39]
  v_mfma_f32_16x16x32_bf16 v[44:47], v[68:71], a[232:235], v[44:47]
  v_mfma_f32_16x16x32_bf16 v[48:51], v[224:227], v[64:67], v[48:51]
  v_mfma_f32_16x16x32_bf16 v[52:55], v[232:235], v[64:67], v[52:55]
  v_mfma_f32_16x16x32_bf16 v[56:59], v[224:227], v[68:71], v[56:59]
  v_mfma_f32_16x16x32_bf16 v[60:63], v[232:235], v[68:71], v[60:63]
  s_waitcnt lgkmcnt(0)
  v_mfma_f32_16x16x32_bf16 v[16:19], a[100:103], v[72:75], v[16:19]
  ds_read_b128 v[64:67], v9 offset:28672
  v_mfma_f32_16x16x32_bf16 v[20:23], a[108:111], v[72:75], v[20:23]
  ds_read_b128 v[68:71], v9 offset:30720
  v_mfma_f32_16x16x32_bf16 v[24:27], a[100:103], v[76:79], v[24:27]
  v_mfma_f32_16x16x32_bf16 v[28:31], a[108:111], v[76:79], v[28:31]
  v_mfma_f32_16x16x32_bf16 v[32:35], v[72:75], a[228:231], v[32:35]
  v_mfma_f32_16x16x32_bf16 v[40:43], v[72:75], a[236:239], v[40:43]
  v_mfma_f32_16x16x32_bf16 v[36:39], v[76:79], a[228:231], v[36:39]
  v_mfma_f32_16x16x32_bf16 v[44:47], v[76:79], a[236:239], v[44:47]
  v_mfma_f32_16x16x32_bf16 v[48:51], v[228:231], v[72:75], v[48:51]
  v_mfma_f32_16x16x32_bf16 v[52:55], v[236:239], v[72:75], v[52:55]
  v_mfma_f32_16x16x32_bf16 v[56:59], v[228:231], v[76:79], v[56:59]
  v_mfma_f32_16x16x32_bf16 v[60:63], v[236:239], v[76:79], v[60:63]
  s_waitcnt lgkmcnt(0)
  v_mfma_f32_16x16x32_bf16 v[16:19], a[112:115], v[64:67], v[16:19]
  ds_read_b128 v[72:75], v10 offset:28672
  v_mfma_f32_16x16x32_bf16 v[20:23], a[120:123], v[64:67], v[20:23]
  ds_read_b128 v[76:79], v10 offset:30720
  v_mfma_f32_16x16x32_bf16 v[24:27], a[112:115], v[68:71], v[24:27]
  v_mfma_f32_16x16x32_bf16 v[28:31], a[120:123], v[68:71], v[28:31]
  v_mfma_f32_16x16x32_bf16 v[32:35], v[64:67], a[240:243], v[32:35]
  v_mfma_f32_16x16x32_bf16 v[40:43], v[64:67], a[248:251], v[40:43]
  v_mfma_f32_16x16x32_bf16 v[36:39], v[68:71], a[240:243], v[36:39]
  v_mfma_f32_16x16x32_bf16 v[44:47], v[68:71], a[248:251], v[44:47]
  v_mfma_f32_16x16x32_bf16 v[48:51], v[240:243], v[64:67], v[48:51]
  v_mfma_f32_16x16x32_bf16 v[52:55], v[248:251], v[64:67], v[52:55]
  v_mfma_f32_16x16x32_bf16 v[56:59], v[240:243], v[68:71], v[56:59]
  v_mfma_f32_16x16x32_bf16 v[60:63], v[248:251], v[68:71], v[60:63]
  s_waitcnt lgkmcnt(0)
  v_mfma_f32_16x16x32_bf16 v[16:19], a[116:119], v[72:75], v[16:19]
  v_mfma_f32_16x16x32_bf16 v[20:23], a[124:127], v[72:75], v[20:23]
  v_mfma_f32_16x16x32_bf16 v[24:27], a[116:119], v[76:79], v[24:27]
  v_mfma_f32_16x16x32_bf16 v[28:31], a[124:127], v[76:79], v[28:31]
  v_mfma_f32_16x16x32_bf16 v[32:35], v[72:75], a[244:247], v[32:35]
  v_mfma_f32_16x16x32_bf16 v[40:43], v[72:75], a[252:255], v[40:43]
  v_mfma_f32_16x16x32_bf16 v[36:39], v[76:79], a[244:247], v[36:39]
  v_mfma_f32_16x16x32_bf16 v[44:47], v[76:79], a[252:255], v[44:47]
  v_mfma_f32_16x16x32_bf16 v[48:51], v[244:247], v[72:75], v[48:51]
  v_mfma_f32_16x16x32_bf16 v[52:55], v[252:255], v[72:75], v[52:55]
  v_mfma_f32_16x16x32_bf16 v[56:59], v[244:247], v[76:79], v[56:59]
  v_mfma_f32_16x16x32_bf16 v[60:63], v[252:255], v[76:79], v[60:63]
  s_lshl_b32 s3, s32, 6
  s_add_u32 s3, s3, s34
  s_lshl_b32 s40, s3, 14
  s_add_u32 s40, s40, 8388608
  s_lshl_b32 s41, s3, 13
  s_add_u32 s41, s41, 42991616
  s_add_u32 s3, s3, s32
  s_lshl_b32 s42, s3, 12
  s_add_u32 s42, s42, 59772928
  v_cvt_pk_bf16_f32 v80, v16, v17
  v_cvt_pk_bf16_f32 v81, v18, v19
  v_cvt_pk_bf16_f32 v82, v20, v21
  v_cvt_pk_bf16_f32 v83, v22, v23
  v_cvt_pk_bf16_f32 v84, v24, v25
  v_cvt_pk_bf16_f32 v85, v26, v27
  v_cvt_pk_bf16_f32 v86, v28, v29
  v_cvt_pk_bf16_f32 v87, v30, v31
  v_cvt_pk_bf16_f32 v88, v32, v33
  v_cvt_pk_bf16_f32 v89, v34, v35
  v_cvt_pk_bf16_f32 v90, v36, v37
  v_cvt_pk_bf16_f32 v91, v38, v39
  v_cvt_pk_bf16_f32 v92, v40, v41
  v_cvt_pk_bf16_f32 v93, v42, v43
  v_cvt_pk_bf16_f32 v94, v44, v45
  v_cvt_pk_bf16_f32 v95, v46, v47
  v_cvt_pk_bf16_f32 v96, v48, v49
  v_cvt_pk_bf16_f32 v97, v50, v51
  v_cvt_pk_bf16_f32 v98, v52, v53
  v_cvt_pk_bf16_f32 v99, v54, v55
  v_cvt_pk_bf16_f32 v100, v56, v57
  v_cvt_pk_bf16_f32 v101, v58, v59
  v_cvt_pk_bf16_f32 v102, v60, v61
  v_cvt_pk_bf16_f32 v103, v62, v63
  v_xor_b32 v9, 32768, v9
  v_xor_b32 v10, 32768, v10
  s_add_u32 s35, s35, 1
  s_add_u32 s34, s34, 6
  s_cmp_lg_u32 s35, 1
  s_cbranch_scc1 A_cont_18
  buffer_store_dwordx4 v[80:83], v2, s[8:11], s40 offen sc1
  s_add_u32 s40, s40, 4096
  buffer_store_dwordx4 v[84:87], v2, s[8:11], s40 offen sc1
  s_add_u32 s40, s40, 4096
  buffer_store_dwordx4 v[88:91], v3, s[8:11], s40 offen sc1
  buffer_store_dwordx4 v[92:95], v3, s[8:11], s40 offen offset:1024 sc1
  buffer_store_dwordx4 v[104:107], v2, s[8:11], s42 offen sc1
  buffer_store_dwordx4 v[96:99], v2, s[8:11], s41 offen sc1
  s_add_u32 s41, s41, 4096
  buffer_store_dwordx4 v[100:103], v2, s[8:11], s41 offen sc1
  s_mov_b32 s40, 268435456
  s_mov_b32 s41, 268435456
  s_mov_b32 s42, 268435456
  s_waitcnt vmcnt(0)
  s_barrier
  s_mov_b64 exec, 1
  v_cmp_eq_u32 vcc, 0, v11
  s_cbranch_vccz A_jn_21
  s_lshl_b32 s3, s32, 2
W_spin_22:
  buffer_load_dword v11, off, s[52:55], s3 sc1
W_spin_22h:
  s_add_u32 s44, s44, 1
  s_cmp_gt_u32 s44, 400000
  s_cbranch_scc1 W_spin_22x
  s_waitcnt vmcnt(0)
  v_cmp_eq_u32 vcc, 0, v11
  s_cbranch_vccz W_spin_22x
  s_sleep 8
  s_branch W_spin_22
W_spin_22x:
  s_waitcnt vmcnt(0)
A_jn_21:
  s_mov_b64 exec, -1
  s_cmp_lg_u32 s29, 0
  s_cbranch_scc1 W_pub_23
  v_mov_b32 v4, s35
  s_mov_b64 exec, 1
  buffer_store_dword v4, off, s[8:11], s43 sc1
  s_mov_b64 exec, -1
W_pub_23:
A_cont_18:
  s_cmp_lt_u32 s34, 64
  s_cbranch_scc1 A_top_17
  buffer_store_dwordx4 v[80:83], v2, s[8:11], s40 offen sc1
  s_add_u32 s40, s40, 4096
  buffer_store_dwordx4 v[84:87], v2, s[8:11], s40 offen sc1
  s_add_u32 s40, s40, 4096
  buffer_store_dwordx4 v[88:91], v3, s[8:11], s40 offen sc1
  buffer_store_dwordx4 v[92:95], v3, s[8:11], s40 offen offset:1024 sc1
  buffer_store_dwordx4 v[104:107], v2, s[8:11], s42 offen sc1
  buffer_store_dwordx4 v[96:99], v2, s[8:11], s41 offen sc1
  s_add_u32 s41, s41, 4096
  buffer_store_dwordx4 v[100:103], v2, s[8:11], s41 offen sc1
  s_cmp_lg_u32 s29, 0
  s_cbranch_scc1 W_arr_24
  v_lshlrev_b32 v4, 7, v0
  s_mul_i32 s3, s28, 1536
  s_lshl_b32 s6, s30, 2
  s_add_u32 s3, s3, s6
  s_add_u32 s3, s3, 606208
  v_add_u32 v4, s3, v4
  s_lshl_b32 s6, s31, 2
  s_add_u32 s6, s6, 598016
  v_writelane_b32 v4, s6, 12
  s_add_u32 s6, s6, 4096
  v_writelane_b32 v4, s6, 13
  v_mov_b32 v5, 0
  s_getreg_b32 s3, hwreg(HW_REG_XCC_ID, 0, 4)
  v_writelane_b32 v5, s3, 13
  s_mov_b64 exec, 0x3fff
  buffer_store_dword v5, v4, s[8:11], 0 offen sc1
  s_lshl_b32 s3, s28, 2
  s_add_u32 s3, s3, 132
  s_mov_b64 exec, 1
  s_waitcnt vmcnt(0)
  v_mov_b32 v5, 1
  buffer_atomic_add v5, off, s[52:55], s3 sc1
  s_mov_b64 exec, -1
W_arr_24:
  s_waitcnt vmcnt(0)
  s_barrier
  s_cmp_lg_u32 s29, 0
  s_cbranch_scc1 W_pub_25
  v_mov_b32 v4, s35
  s_mov_b64 exec, 1
  buffer_store_dword v4, off, s[8:11], s43 sc1
  s_mov_b64 exec, -1
W_pub_25:
  s_and_b32 s38, s30, 7
  s_lshr_b32 s39, s31, 3
  s_load_dwordx2 s[12:13], s[0:1], 64
  s_mov_b32 s14, 7340032
  s_mov_b32 s15, 0x20000
  s_load_dwordx2 s[16:17], s[0:1], 72
  s_mov_b32 s18, 3584
  s_mov_b32 s19, 0x20000
  v_lshrrev_b32 v4, 4, v0
  v_lshlrev_b32 v4, 1, v4
  v_and_b32 v5, 7, v0
  v_xor_b32 v5, v5, v4
  v_lshlrev_b32 v5, 4, v5
  v_lshrrev_b32 v4, 3, v0
  v_lshl_add_u32 v6, v4, 10, v5
  v_mul_u32_u24 v4, 3584, v4
  v_add_u32 v7, v4, v5
  s_mul_i32 s36, s29, 40960
  v_bfe_u32 v4, v0, 0, 1
  v_lshlrev_b32 v5, 3, v4
  v_bfe_u32 v4, v0, 1, 1
  v_lshl_add_u32 v5, v4, 4, v5
  v_bfe_u32 v4, v0, 2, 1
  v_lshl_add_u32 v5, v4, 7, v5
  v_bfe_u32 v4, v0, 3, 1
  v_lshl_add_u32 v5, v4, 8, v5
  v_bfe_u32 v4, v0, 4, 1
  v_lshl_add_u32 v5, v4, 9, v5
  v_bfe_u32 v4, v0, 5, 1
  v_lshl_add_u32 v5, v4, 10, v5
  v_add_u32 v5, s36, v5
  v_bfe_u32 v4, v0, 3, 2
  v_xor_b32 v80, 0, v4
  v_lshl_add_u32 v80, v80, 5, v5
  v_xor_b32 v81, 1, v4
  v_lshl_add_u32 v81, v81, 5, v5
  v_xor_b32 v82, 2, v4
  v_lshl_add_u32 v82, v82, 5, v5
  v_xor_b32 v83, 3, v4
  v_lshl_add_u32 v83, v83, 5, v5
  s_mul_i32 s40, s29, 524288
  s_lshl_b32 s3, s38, 7
  s_add_u32 s40, s40, s3
  s_add_u32 s40, s40, 1048576
  s_mul_i32 s41, s29, 1835008
  s_lshl_b32 s3, s39, 7
  s_add_u32 s41, s41, s3
  s_lshl_b32 s6, s29, 5
  s_add_u32 s3, s3, s6
  v_lshrrev_b32 v4, 3, v0
  v_lshlrev_b32 v4, 1, v4
  s_waitcnt lgkmcnt(0)
  buffer_load_ushort v14, v4, s[16:19], s3 offen
  buffer_load_ushort v15, v4, s[16:19], s3 offen offset:16
  s_mul_i32 s34, s38, 0
  s_lshr_b32 s34, s34, 3
  s_mul_i32 s37, s34, 114688
  s_add_u32 s37, s37, s41
  s_add_u32 s34, s34, 1
  s_cmp_eq_u32 s34, 16
  s_cselect_b32 s34, 0, s34
  s_add_u32 m0, s36, 0
  s_add_u32 s3, s37, 0
  buffer_load_dwordx4 v7, s[12:15], s3 offen nt lds
  s_add_u32 m0, s36, 1024
  s_add_u32 s3, s37, 28672
  buffer_load_dwordx4 v7, s[12:15], s3 offen nt lds
  s_add_u32 m0, s36, 2048
  s_add_u32 s3, s37, 57344
  buffer_load_dwordx4 v7, s[12:15], s3 offen nt lds
  s_add_u32 m0, s36, 3072
  s_add_u32 s3, s37, 86016
  buffer_load_dwordx4 v7, s[12:15], s3 offen nt lds
  s_mul_i32 s37, s34, 114688
  s_add_u32 s37, s37, s41
  s_add_u32 s34, s34, 1
  s_cmp_eq_u32 s34, 16
  s_cselect_b32 s34, 0, s34
  s_add_u32 m0, s36, 4096
  s_add_u32 s3, s37, 0
  buffer_load_dwordx4 v7, s[12:15], s3 offen nt lds
  s_add_u32 m0, s36, 5120
  s_add_u32 s3, s37, 28672
  buffer_load_dwordx4 v7, s[12:15], s3 offen nt lds
  s_add_u32 m0, s36, 6144
  s_add_u32 s3, s37, 57344
  buffer_load_dwordx4 v7, s[12:15], s3 offen nt lds
  s_add_u32 m0, s36, 7168
  s_add_u32 s3, s37, 86016
  buffer_load_dwordx4 v7, s[12:15], s3 offen nt lds
  s_mul_i32 s37, s34, 114688
  s_add_u32 s37, s37, s41
  s_add_u32 s34, s34, 1
  s_cmp_eq_u32 s34, 16
  s_cselect_b32 s34, 0, s34
  s_add_u32 m0, s36, 8192
  s_add_u32 s3, s37, 0
  buffer_load_dwordx4 v7, s[12:15], s3 offen nt lds
  s_add_u32 m0, s36, 9216
  s_add_u32 s3, s37, 28672
  buffer_load_dwordx4 v7, s[12:15], s3 offen nt lds
  s_add_u32 m0, s36, 10240
  s_add_u32 s3, s37, 57344
  buffer_load_dwordx4 v7, s[12:15], s3 offen nt lds
  s_add_u32 m0, s36, 11264
  s_add_u32 s3, s37, 86016
  buffer_load_dwordx4 v7, s[12:15], s3 offen nt lds
  s_mul_i32 s37, s34, 114688
  s_add_u32 s37, s37, s41
  s_add_u32 s34, s34, 1
  s_cmp_eq_u32 s34, 16
  s_cselect_b32 s34, 0, s34
  s_add_u32 m0, s36, 12288
  s_add_u32 s3, s37, 0
  buffer_load_dwordx4 v7, s[12:15], s3 offen nt lds
  s_add_u32 m0, s36, 13312
  s_add_u32 s3, s37, 28672
  buffer_load_dwordx4 v7, s[12:15], s3 offen nt lds
  s_add_u32 m0, s36, 14336
  s_add_u32 s3, s37, 57344
  buffer_load_dwordx4 v7, s[12:15], s3 offen nt lds
  s_add_u32 m0, s36, 15360
  s_add_u32 s3, s37, 86016
  buffer_load_dwordx4 v7, s[12:15], s3 offen nt lds
  s_mul_i32 s37, s34, 114688
  s_add_u32 s37, s37, s41
  s_add_u32 s34, s34, 1
  s_cmp_eq_u32 s34, 16
  s_cselect_b32 s34, 0, s34
  s_add_u32 m0, s36, 16384
  s_add_u32 s3, s37, 0
  buffer_load_dwordx4 v7, s[12:15], s3 offen nt lds
  s_add_u32 m0, s36, 17408
  s_add_u32 s3, s37, 28672
  buffer_load_dwordx4 v7, s[12:15], s3 offen nt lds
  s_add_u32 m0, s36, 18432
  s_add_u32 s3, s37, 57344
  buffer_load_dwordx4 v7, s[12:15], s3 offen nt lds
  s_add_u32 m0, s36, 19456
  s_add_u32 s3, s37, 86016
  buffer_load_dwordx4 v7, s[12:15], s3 offen nt lds
  s_mul_i32 s37, s34, 114688
  s_add_u32 s37, s37, s41
  s_add_u32 s34, s34, 1
  s_cmp_eq_u32 s34, 16
  s_cselect_b32 s34, 0, s34
  s_add_u32 m0, s36, 20480
  s_add_u32 s3, s37, 0
  buffer_load_dwordx4 v7, s[12:15], s3 offen nt lds
  s_add_u32 m0, s36, 21504
  s_add_u32 s3, s37, 28672
  buffer_load_dwordx4 v7, s[12:15], s3 offen nt lds
  s_add_u32 m0, s36, 22528
  s_add_u32 s3, s37, 57344
  buffer_load_dwordx4 v7, s[12:15], s3 offen nt lds
  s_add_u32 m0, s36, 23552
  s_add_u32 s3, s37, 86016
  buffer_load_dwordx4 v7, s[12:15], s3 offen nt lds
  s_mul_i32 s37, s34, 114688
  s_add_u32 s37, s37, s41
  s_add_u32 s34, s34, 1
  s_cmp_eq_u32 s34, 16
  s_cselect_b32 s34, 0, s34
  s_add_u32 m0, s36, 24576
  s_add_u32 s3, s37, 0
  buffer_load_dwordx4 v7, s[12:15], s3 offen nt lds
  s_add_u32 m0, s36, 25600
  s_add_u32 s3, s37, 28672
  buffer_load_dwordx4 v7, s[12:15], s3 offen nt lds
  s_add_u32 m0, s36, 26624
  s_add_u32 s3, s37, 57344
  buffer_load_dwordx4 v7, s[12:15], s3 offen nt lds
  s_add_u32 m0, s36, 27648
  s_add_u32 s3, s37, 86016
  buffer_load_dwordx4 v7, s[12:15], s3 offen nt lds
  s_mul_i32 s37, s34, 114688
  s_add_u32 s37, s37, s41
  s_add_u32 s34, s34, 1
  s_cmp_eq_u32 s34, 16
  s_cselect_b32 s34, 0, s34
  s_add_u32 m0, s36, 28672
  s_add_u32 s3, s37, 0
  buffer_load_dwordx4 v7, s[12:15], s3 offen nt lds
  s_add_u32 m0, s36, 29696
  s_add_u32 s3, s37, 28672
  buffer_load_dwordx4 v7, s[12:15], s3 offen nt lds
  s_add_u32 m0, s36, 30720
  s_add_u32 s3, s37, 57344
  buffer_load_dwordx4 v7, s[12:15], s3 offen nt lds
  s_add_u32 m0, s36, 31744
  s_add_u32 s3, s37, 86016
  buffer_load_dwordx4 v7, s[12:15], s3 offen nt lds
  s_waitcnt vmcnt(28) lgkmcnt(7)
  ds_read_b64_tr_b16 a[0:1], v80 offset:0
  ds_read_b64_tr_b16 a[2:3], v80 offset:2048
  s_mul_i32 s37, s34, 114688
  s_add_u32 s37, s37, s41
  s_add_u32 s34, s34, 1
  s_cmp_eq_u32 s34, 16
  s_cselect_b32 s34, 0, s34
  s_add_u32 m0, s36, 32768
  s_add_u32 s3, s37, 0
  buffer_load_dwordx4 v7, s[12:15], s3 offen nt lds
  ds_read_b64_tr_b16 a[4:5], v81 offset:0
  ds_read_b64_tr_b16 a[6:7], v81 offset:2048
  s_add_u32 m0, s36, 33792
  s_add_u32 s3, s37, 28672
  buffer_load_dwordx4 v7, s[12:15], s3 offen nt lds
  ds_read_b64_tr_b16 a[8:9], v82 offset:0
  ds_read_b64_tr_b16 a[10:11], v82 offset:2048
  s_add_u32 m0, s36, 34816
  s_add_u32 s3, s37, 57344
  buffer_load_dwordx4 v7, s[12:15], s3 offen nt lds
  ds_read_b64_tr_b16 a[12:13], v83 offset:0
  ds_read_b64_tr_b16 a[14:15], v83 offset:2048
  s_add_u32 m0, s36, 35840
  s_add_u32 s3, s37, 86016
  buffer_load_dwordx4 v7, s[12:15], s3 offen nt lds
  s_waitcnt vmcnt(28) lgkmcnt(7)
  ds_read_b64_tr_b16 a[16:17], v80 offset:4096
  ds_read_b64_tr_b16 a[18:19], v80 offset:6144
  s_mul_i32 s37, s34, 114688
  s_add_u32 s37, s37, s41
  s_add_u32 s34, s34, 1
  s_cmp_eq_u32 s34, 16
  s_cselect_b32 s34, 0, s34
  s_add_u32 m0, s36, 36864
  s_add_u32 s3, s37, 0
  buffer_load_dwordx4 v7, s[12:15], s3 offen nt lds
  ds_read_b64_tr_b16 a[20:21], v81 offset:4096
  ds_read_b64_tr_b16 a[22:23], v81 offset:6144
  s_add_u32 m0, s36, 37888
  s_add_u32 s3, s37, 28672
  buffer_load_dwordx4 v7, s[12:15], s3 offen nt lds
  ds_read_b64_tr_b16 a[24:25], v82 offset:4096
  ds_read_b64_tr_b16 a[26:27], v82 offset:6144
  s_add_u32 m0, s36, 38912
  s_add_u32 s3, s37, 57344
  buffer_load_dwordx4 v7, s[12:15], s3 offen nt lds
  ds_read_b64_tr_b16 a[28:29], v83 offset:4096
  ds_read_b64_tr_b16 a[30:31], v83 offset:6144
  s_add_u32 m0, s36, 39936
  s_add_u32 s3, s37, 86016
  buffer_load_dwordx4 v7, s[12:15], s3 offen nt lds
  s_waitcnt vmcnt(28) lgkmcnt(7)
  ds_read_b64_tr_b16 a[32:33], v80 offset:8192
  ds_read_b64_tr_b16 a[34:35], v80 offset:10240
  s_mul_i32 s37, s34, 114688
  s_add_u32 s37, s37, s41
  s_add_u32 s34, s34, 1
  s_cmp_eq_u32 s34, 16
  s_cselect_b32 s34, 0, s34
  s_add_u32 m0, s36, 0
  s_add_u32 s3, s37, 0
  buffer_load_dwordx4 v7, s[12:15], s3 offen nt lds
  ds_read_b64_tr_b16 a[36:37], v81 offset:8192
  ds_read_b64_tr_b16 a[38:39], v81 offset:10240
  s_add_u32 m0, s36, 1024
  s_add_u32 s3, s37, 28672
  buffer_load_dwordx4 v7, s[12:15], s3 offen nt lds
  ds_read_b64_tr_b16 a[40:41], v82 offset:8192
  ds_read_b64_tr_b16 a[42:43], v82 offset:10240
  s_add_u32 m0, s36, 2048
  s_add_u32 s3, s37, 57344
  buffer_load_dwordx4 v7, s[12:15], s3 offen nt lds
  ds_read_b64_tr_b16 a[44:45], v83 offset:8192
  ds_read_b64_tr_b16 a[46:47], v83 offset:10240
  s_add_u32 m0, s36, 3072
  s_add_u32 s3, s37, 86016
  buffer_load_dwordx4 v7, s[12:15], s3 offen nt lds
  s_waitcnt vmcnt(28) lgkmcnt(7)
  ds_read_b64_tr_b16 a[48:49], v80 offset:12288
  ds_read_b64_tr_b16 a[50:51], v80 offset:14336
  s_mul_i32 s37, s34, 114688
  s_add_u32 s37, s37, s41
  s_add_u32 s34, s34, 1
  s_cmp_eq_u32 s34, 16
  s_cselect_b32 s34, 0, s34
  s_add_u32 m0, s36, 4096
  s_add_u32 s3, s37, 0
  buffer_load_dwordx4 v7, s[12:15], s3 offen nt lds
  ds_read_b64_tr_b16 a[52:53], v81 offset:12288
  ds_read_b64_tr_b16 a[54:55], v81 offset:14336
  s_add_u32 m0, s36, 5120
  s_add_u32 s3, s37, 28672
  buffer_load_dwordx4 v7, s[12:15], s3 offen nt lds
  ds_read_b64_tr_b16 a[56:57], v82 offset:12288
  ds_read_b64_tr_b16 a[58:59], v82 offset:14336
  s_add_u32 m0, s36, 6144
  s_add_u32 s3, s37, 57344
  buffer_load_dwordx4 v7, s[12:15], s3 offen nt lds
  ds_read_b64_tr_b16 a[60:61], v83 offset:12288
  ds_read_b64_tr_b16 a[62:63], v83 offset:14336
  s_add_u32 m0, s36, 7168
  s_add_u32 s3, s37, 86016
  buffer_load_dwordx4 v7, s[12:15], s3 offen nt lds
  s_waitcnt vmcnt(28) lgkmcnt(7)
  ds_read_b64_tr_b16 a[64:65], v80 offset:16384
  ds_read_b64_tr_b16 a[66:67], v80 offset:18432
  s_mul_i32 s37, s34, 114688
  s_add_u32 s37, s37, s41
  s_add_u32 s34, s34, 1
  s_cmp_eq_u32 s34, 16
  s_cselect_b32 s34, 0, s34
  s_add_u32 m0, s36, 8192
  s_add_u32 s3, s37, 0
  buffer_load_dwordx4 v7, s[12:15], s3 offen nt lds
  ds_read_b64_tr_b16 a[68:69], v81 offset:16384
  ds_read_b64_tr_b16 a[70:71], v81 offset:18432
  s_add_u32 m0, s36, 9216
  s_add_u32 s3, s37, 28672
  buffer_load_dwordx4 v7, s[12:15], s3 offen nt lds
  ds_read_b64_tr_b16 a[72:73], v82 offset:16384
  ds_read_b64_tr_b16 a[74:75], v82 offset:18432
  s_add_u32 m0, s36, 10240
  s_add_u32 s3, s37, 57344
  buffer_load_dwordx4 v7, s[12:15], s3 offen nt lds
  ds_read_b64_tr_b16 a[76:77], v83 offset:16384
  ds_read_b64_tr_b16 a[78:79], v83 offset:18432
  s_add_u32 m0, s36, 11264
  s_add_u32 s3, s37, 86016
  buffer_load_dwordx4 v7, s[12:15], s3 offen nt lds
  s_waitcnt vmcnt(28) lgkmcnt(7)
  ds_read_b64_tr_b16 a[80:81], v80 offset:20480
  ds_read_b64_tr_b16 a[82:83], v80 offset:22528
  s_mul_i32 s37, s34, 114688
  s_add_u32 s37, s37, s41
  s_add_u32 s34, s34, 1
  s_cmp_eq_u32 s34, 16
  s_cselect_b32 s34, 0, s34
  s_add_u32 m0, s36, 12288
  s_add_u32 s3, s37, 0
  buffer_load_dwordx4 v7, s[12:15], s3 offen nt lds
  ds_read_b64_tr_b16 a[84:85], v81 offset:20480
  ds_read_b64_tr_b16 a[86:87], v81 offset:22528
  s_add_u32 m0, s36, 13312
  s_add_u32 s3, s37, 28672
  buffer_load_dwordx4 v7, s[12:15], s3 offen nt lds
  ds_read_b64_tr_b16 a[88:89], v82 offset:20480
  ds_read_b64_tr_b16 a[90:91], v82 offset:22528
  s_add_u32 m0, s36, 14336
  s_add_u32 s3, s37, 57344
  buffer_load_dwordx4 v7, s[12:15], s3 offen nt lds
  ds_read_b64_tr_b16 a[92:93], v83 offset:20480
  ds_read_b64_tr_b16 a[94:95], v83 offset:22528
  s_add_u32 m0, s36, 15360
  s_add_u32 s3, s37, 86016
  buffer_load_dwordx4 v7, s[12:15], s3 offen nt lds
  s_waitcnt vmcnt(28) lgkmcnt(7)
  ds_read_b64_tr_b16 a[96:97], v80 offset:24576
  ds_read_b64_tr_b16 a[98:99], v80 offset:26624
  s_mul_i32 s37, s34, 114688
  s_add_u32 s37, s37, s41
  s_add_u32 s34, s34, 1
  s_cmp_eq_u32 s34, 16
  s_cselect_b32 s34, 0, s34
  s_add_u32 m0, s36, 16384
  s_add_u32 s3, s37, 0
  buffer_load_dwordx4 v7, s[12:15], s3 offen nt lds
  ds_read_b64_tr_b16 a[100:101], v81 offset:24576
  ds_read_b64_tr_b16 a[102:103], v81 offset:26624
  s_add_u32 m0, s36, 17408
  s_add_u32 s3, s37, 28672
  buffer_load_dwordx4 v7, s[12:15], s3 offen nt lds
  ds_read_b64_tr_b16 a[104:105], v82 offset:24576
  ds_read_b64_tr_b16 a[106:107], v82 offset:26624
  s_add_u32 m0, s36, 18432
  s_add_u32 s3, s37, 57344
  buffer_load_dwordx4 v7, s[12:15], s3 offen nt lds
  ds_read_b64_tr_b16 a[108:109], v83 offset:24576
  ds_read_b64_tr_b16 a[110:111], v83 offset:26624
  s_add_u32 m0, s36, 19456
  s_add_u32 s3, s37, 86016
  buffer_load_dwordx4 v7, s[12:15], s3 offen nt lds
  s_waitcnt vmcnt(28) lgkmcnt(7)
  ds_read_b64_tr_b16 a[112:113], v80 offset:28672
  ds_read_b64_tr_b16 a[114:115], v80 offset:30720
  s_mul_i32 s37, s34, 114688
  s_add_u32 s37, s37, s41
  s_add_u32 s34, s34, 1
  s_cmp_eq_u32 s34, 16
  s_cselect_b32 s34, 0, s34
  s_add_u32 m0, s36, 20480
  s_add_u32 s3, s37, 0
  buffer_load_dwordx4 v7, s[12:15], s3 offen nt lds
  ds_read_b64_tr_b16 a[116:117], v81 offset:28672
  ds_read_b64_tr_b16 a[118:119], v81 offset:30720
  s_add_u32 m0, s36, 21504
  s_add_u32 s3, s37, 28672
  buffer_load_dwordx4 v7, s[12:15], s3 offen nt lds
  ds_read_b64_tr_b16 a[120:121], v82 offset:28672
  ds_read_b64_tr_b16 a[122:123], v82 offset:30720
  s_add_u32 m0, s36, 22528
  s_add_u32 s3, s37, 57344
  buffer_load_dwordx4 v7, s[12:15], s3 offen nt lds
  ds_read_b64_tr_b16 a[124:125], v83 offset:28672
  ds_read_b64_tr_b16 a[126:127], v83 offset:30720
  s_add_u32 m0, s36, 23552
  s_add_u32 s3, s37, 86016
  buffer_load_dwordx4 v7, s[12:15], s3 offen nt lds
  s_waitcnt vmcnt(28) lgkmcnt(7)
  ds_read_b64_tr_b16 a[128:129], v80 offset:32768
  ds_read_b64_tr_b16 a[130:131], v80 offset:34816
  ds_read_b64_tr_b16 a[132:133], v81 offset:32768
  ds_read_b64_tr_b16 a[134:135], v81 offset:34816
  ds_read_b64_tr_b16 a[136:137], v82 offset:32768
  ds_read_b64_tr_b16 a[138:139], v82 offset:34816
  ds_read_b64_tr_b16 a[140:141], v83 offset:32768
  ds_read_b64_tr_b16 a[142:143], v83 offset:34816
  s_waitcnt vmcnt(24) lgkmcnt(7)
  ds_read_b64_tr_b16 a[144:145], v80 offset:36864
  ds_read_b64_tr_b16 a[146:147], v80 offset:38912
  ds_read_b64_tr_b16 a[148:149], v81 offset:36864
  ds_read_b64_tr_b16 a[150:151], v81 offset:38912
  ds_read_b64_tr_b16 a[152:153], v82 offset:36864
  ds_read_b64_tr_b16 a[154:155], v82 offset:38912
  ds_read_b64_tr_b16 a[156:157], v83 offset:36864
  ds_read_b64_tr_b16 a[158:159], v83 offset:38912
  s_waitcnt vmcnt(20) lgkmcnt(7)
  ds_read_b64_tr_b16 a[160:161], v80 offset:0
  ds_read_b64_tr_b16 a[162:163], v80 offset:2048
  ds_read_b64_tr_b16 a[164:165], v81 offset:0
  ds_read_b64_tr_b16 a[166:167], v81 offset:2048
  ds_read_b64_tr_b16 a[168:169], v82 offset:0
  ds_read_b64_tr_b16 a[170:171], v82 offset:2048
  ds_read_b64_tr_b16 a[172:173], v83 offset:0
  ds_read_b64_tr_b16 a[174:175], v83 offset:2048
  s_waitcnt vmcnt(16) lgkmcnt(7)
  ds_read_b64_tr_b16 a[176:177], v80 offset:4096
  ds_read_b64_tr_b16 a[178:179], v80 offset:6144
  ds_read_b64_tr_b16 a[180:181], v81 offset:4096
  ds_read_b64_tr_b16 a[182:183], v81 offset:6144
  ds_read_b64_tr_b16 a[184:185], v82 offset:4096
  ds_read_b64_tr_b16 a[186:187], v82 offset:6144
  ds_read_b64_tr_b16 a[188:189], v83 offset:4096
  ds_read_b64_tr_b16 a[190:191], v83 offset:6144
  s_waitcnt vmcnt(12) lgkmcnt(7)
  ds_read_b64_tr_b16 a[192:193], v80 offset:8192
  ds_read_b64_tr_b16 a[194:195], v80 offset:10240
  ds_read_b64_tr_b16 a[196:197], v81 offset:8192
  ds_read_b64_tr_b16 a[198:199], v81 offset:10240
  ds_read_b64_tr_b16 a[200:201], v82 offset:8192
  ds_read_b64_tr_b16 a[202:203], v82 offset:10240
  ds_read_b64_tr_b16 a[204:205], v83 offset:8192
  ds_read_b64_tr_b16 a[206:207], v83 offset:10240
  s_waitcnt vmcnt(8) lgkmcnt(7)
  ds_read_b64_tr_b16 a[208:209], v80 offset:12288
  ds_read_b64_tr_b16 a[210:211], v80 offset:14336
  ds_read_b64_tr_b16 a[212:213], v81 offset:12288
  ds_read_b64_tr_b16 a[214:215], v81 offset:14336
  ds_read_b64_tr_b16 a[216:217], v82 offset:12288
  ds_read_b64_tr_b16 a[218:219], v82 offset:14336
  ds_read_b64_tr_b16 a[220:221], v83 offset:12288
  ds_read_b64_tr_b16 a[222:223], v83 offset:14336
  s_waitcnt vmcnt(4) lgkmcnt(7)
  ds_read_b64_tr_b16 a[224:225], v80 offset:16384
  ds_read_b64_tr_b16 a[226:227], v80 offset:18432
  ds_read_b64_tr_b16 a[228:229], v81 offset:16384
  ds_read_b64_tr_b16 a[230:231], v81 offset:18432
  ds_read_b64_tr_b16 a[232:233], v82 offset:16384
  ds_read_b64_tr_b16 a[234:235], v82 offset:18432
  ds_read_b64_tr_b16 a[236:237], v83 offset:16384
  ds_read_b64_tr_b16 a[238:239], v83 offset:18432
  s_waitcnt vmcnt(0) lgkmcnt(7)
  ds_read_b64_tr_b16 a[240:241], v80 offset:20480
  ds_read_b64_tr_b16 a[242:243], v80 offset:22528
  ds_read_b64_tr_b16 a[244:245], v81 offset:20480
  ds_read_b64_tr_b16 a[246:247], v81 offset:22528
  ds_read_b64_tr_b16 a[248:249], v82 offset:20480
  ds_read_b64_tr_b16 a[250:251], v82 offset:22528
  ds_read_b64_tr_b16 a[252:253], v83 offset:20480
  ds_read_b64_tr_b16 a[254:255], v83 offset:22528
  s_waitcnt lgkmcnt(0)
  v_mov_b32 v4, 6
  v_lshlrev_b32 v4, 2, v4
init_26:
  buffer_load_dword v5, v4, s[52:55], 0 offen offset:132 sc1
  s_add_u32 s44, s44, 1
  s_cmp_gt_u32 s44, 400000
  s_cbranch_scc1 init_26x
  s_waitcnt vmcnt(0)
  v_cmp_gt_u32 vcc, 32, v5
  s_cbranch_vccz init_26x
  s_sleep 8
  s_branch init_26
init_26x:
  s_waitcnt vmcnt(0)
  v_min_u32 v5, 55, v0
  v_lshlrev_b32 v5, 4, v5
  v_add_u32 v5, 598016, v5
  v_cmp_le_u32 vcc, 32, v0
  s_nop 1
  v_cndmask_b32 v12, 0, 0, vcc
  v_cmp_le_u32 vcc, 48, v0
  s_nop 1
  v_cndmask_b32 v12, v12, 1, vcc
W_spin_27:
  buffer_load_dwordx4 v[8:11], v5, s[8:11], 0 offen sc1
W_spin_27h:
  s_add_u32 s44, s44, 1
  s_cmp_gt_u32 s44, 400000
  s_cbranch_scc1 W_spin_27x
  s_waitcnt vmcnt(0)
  v_min3_u32 v8, v8, v9, v10
  v_min_u32 v8, v8, v11
  v_cmp_gt_u32 vcc, v12, v8
  s_cbranch_vccz W_spin_27x
  s_sleep 8
  s_branch W_spin_27
W_spin_27x:
  s_waitcnt vmcnt(0)
  s_mul_i32 s34, s38, 0
  s_lshr_b32 s34, s34, 3
  s_mul_i32 s37, s34, 32768
  s_add_u32 s37, s37, s40
  s_add_u32 s34, s34, 1
  s_cmp_eq_u32 s34, 16
  s_cselect_b32 s34, 0, s34
  s_add_u32 m0, s36, 0
  s_add_u32 s3, s37, 0
  buffer_load_dwordx4 v6, s[8:11], s3 offen sc1 lds
  s_add_u32 m0, s36, 1024
  s_add_u32 s3, s37, 8192
  buffer_load_dwordx4 v6, s[8:11], s3 offen sc1 lds
  s_add_u32 m0, s36, 2048
  s_add_u32 s3, s37, 16384
  buffer_load_dwordx4 v6, s[8:11], s3 offen sc1 lds
  s_add_u32 m0, s36, 3072
  s_add_u32 s3, s37, 24576
  buffer_load_dwordx4 v6, s[8:11], s3 offen sc1 lds
  s_mul_i32 s37, s34, 32768
  s_add_u32 s37, s37, s40
  s_add_u32 s34, s34, 1
  s_cmp_eq_u32 s34, 16
  s_cselect_b32 s34, 0, s34
  s_add_u32 m0, s36, 4096
  s_add_u32 s3, s37, 0
  buffer_load_dwordx4 v6, s[8:11], s3 offen sc1 lds
  s_add_u32 m0, s36, 5120
  s_add_u32 s3, s37, 8192
  buffer_load_dwordx4 v6, s[8:11], s3 offen sc1 lds
  s_add_u32 m0, s36, 6144
  s_add_u32 s3, s37, 16384
  buffer_load_dwordx4 v6, s[8:11], s3 offen sc1 lds
  s_add_u32 m0, s36, 7168
  s_add_u32 s3, s37, 24576
  buffer_load_dwordx4 v6, s[8:11], s3 offen sc1 lds
  s_mul_i32 s37, s34, 32768
  s_add_u32 s37, s37, s40
  s_add_u32 s34, s34, 1
  s_cmp_eq_u32 s34, 16
  s_cselect_b32 s34, 0, s34
  s_add_u32 m0, s36, 8192
  s_add_u32 s3, s37, 0
  buffer_load_dwordx4 v6, s[8:11], s3 offen sc1 lds
  s_add_u32 m0, s36, 9216
  s_add_u32 s3, s37, 8192
  buffer_load_dwordx4 v6, s[8:11], s3 offen sc1 lds
  s_add_u32 m0, s36, 10240
  s_add_u32 s3, s37, 16384
  buffer_load_dwordx4 v6, s[8:11], s3 offen sc1 lds
  s_add_u32 m0, s36, 11264
  s_add_u32 s3, s37, 24576
  buffer_load_dwordx4 v6, s[8:11], s3 offen sc1 lds
  s_mul_i32 s37, s34, 32768
  s_add_u32 s37, s37, s40
  s_add_u32 s34, s34, 1
  s_cmp_eq_u32 s34, 16
  s_cselect_b32 s34, 0, s34
  s_add_u32 m0, s36, 12288
  s_add_u32 s3, s37, 0
  buffer_load_dwordx4 v6, s[8:11], s3 offen sc1 lds
  s_add_u32 m0, s36, 13312
  s_add_u32 s3, s37, 8192
  buffer_load_dwordx4 v6, s[8:11], s3 offen sc1 lds
  s_add_u32 m0, s36, 14336
  s_add_u32 s3, s37, 16384
  buffer_load_dwordx4 v6, s[8:11], s3 offen sc1 lds
  s_add_u32 m0, s36, 15360
  s_add_u32 s3, s37, 24576
  buffer_load_dwordx4 v6, s[8:11], s3 offen sc1 lds
  s_mul_i32 s37, s34, 32768
  s_add_u32 s37, s37, s40
  s_add_u32 s34, s34, 1
  s_cmp_eq_u32 s34, 16
  s_cselect_b32 s34, 0, s34
  s_add_u32 m0, s36, 16384
  s_add_u32 s3, s37, 0
  buffer_load_dwordx4 v6, s[8:11], s3 offen sc1 lds
  s_add_u32 m0, s36, 17408
  s_add_u32 s3, s37, 8192
  buffer_load_dwordx4 v6, s[8:11], s3 offen sc1 lds
  s_add_u32 m0, s36, 18432
  s_add_u32 s3, s37, 16384
  buffer_load_dwordx4 v6, s[8:11], s3 offen sc1 lds
  s_add_u32 m0, s36, 19456
  s_add_u32 s3, s37, 24576
  buffer_load_dwordx4 v6, s[8:11], s3 offen sc1 lds
  s_mul_i32 s37, s34, 32768
  s_add_u32 s37, s37, s40
  s_add_u32 s34, s34, 1
  s_cmp_eq_u32 s34, 16
  s_cselect_b32 s34, 0, s34
  s_add_u32 m0, s36, 20480
  s_add_u32 s3, s37, 0
  buffer_load_dwordx4 v6, s[8:11], s3 offen sc1 lds
  s_add_u32 m0, s36, 21504
  s_add_u32 s3, s37, 8192
  buffer_load_dwordx4 v6, s[8:11], s3 offen sc1 lds
  s_add_u32 m0, s36, 22528
  s_add_u32 s3, s37, 16384
  buffer_load_dwordx4 v6, s[8:11], s3 offen sc1 lds
  s_add_u32 m0, s36, 23552
  s_add_u32 s3, s37, 24576
  buffer_load_dwordx4 v6, s[8:11], s3 offen sc1 lds
  s_mul_i32 s37, s34, 32768
  s_add_u32 s37, s37, s40
  s_add_u32 s34, s34, 1
  s_cmp_eq_u32 s34, 16
  s_cselect_b32 s34, 0, s34
  s_add_u32 m0, s36, 24576
  s_add_u32 s3, s37, 0
  buffer_load_dwordx4 v6, s[8:11], s3 offen sc1 lds
  s_add_u32 m0, s36, 25600
  s_add_u32 s3, s37, 8192
  buffer_load_dwordx4 v6, s[8:11], s3 offen sc1 lds
  s_add_u32 m0, s36, 26624
  s_add_u32 s3, s37, 16384
  buffer_load_dwordx4 v6, s[8:11], s3 offen sc1 lds
  s_add_u32 m0, s36, 27648
  s_add_u32 s3, s37, 24576
  buffer_load_dwordx4 v6, s[8:11], s3 offen sc1 lds
  s_mul_i32 s37, s34, 32768
  s_add_u32 s37, s37, s40
  s_add_u32 s34, s34, 1
  s_cmp_eq_u32 s34, 16
  s_cselect_b32 s34, 0, s34
  s_add_u32 m0, s36, 28672
  s_add_u32 s3, s37, 0
  buffer_load_dwordx4 v6, s[8:11], s3 offen sc1 lds
  s_add_u32 m0, s36, 29696
  s_add_u32 s3, s37, 8192
  buffer_load_dwordx4 v6, s[8:11], s3 offen sc1 lds
  s_add_u32 m0, s36, 30720
  s_add_u32 s3, s37, 16384
  buffer_load_dwordx4 v6, s[8:11], s3 offen sc1 lds
  s_add_u32 m0, s36, 31744
  s_add_u32 s3, s37, 24576
  buffer_load_dwordx4 v6, s[8:11], s3 offen sc1 lds
  s_waitcnt vmcnt(28)
  ds_read_b64_tr_b16 v[16:17], v80 offset:0
  ds_read_b64_tr_b16 v[18:19], v80 offset:2048
  ds_read_b64_tr_b16 v[20:21], v81 offset:0
  ds_read_b64_tr_b16 v[22:23], v81 offset:2048
  ds_read_b64_tr_b16 v[24:25], v82 offset:0
  ds_read_b64_tr_b16 v[26:27], v82 offset:2048
  ds_read_b64_tr_b16 v[28:29], v83 offset:0
  ds_read_b64_tr_b16 v[30:31], v83 offset:2048
  s_waitcnt lgkmcnt(0) vmcnt(24)
  v_mfma_f32_16x16x32_bf16 v[128:131], v[16:19], a[0:3], 0
  ds_read_b64_tr_b16 v[32:33], v80 offset:4096
  v_mfma_f32_16x16x32_bf16 v[144:147], v[16:19], a[4:7], 0
  ds_read_b64_tr_b16 v[34:35], v80 offset:6144
  v_mfma_f32_16x16x32_bf16 v[160:163], v[16:19], a[8:11], 0
  ds_read_b64_tr_b16 v[36:37], v81 offset:4096
  v_mfma_f32_16x16x32_bf16 v[176:179], v[16:19], a[12:15], 0
  ds_read_b64_tr_b16 v[38:39], v81 offset:6144
  v_mfma_f32_16x16x32_bf16 v[132:135], v[20:23], a[0:3], 0
  ds_read_b64_tr_b16 v[40:41], v82 offset:4096
  v_mfma_f32_16x16x32_bf16 v[148:151], v[20:23], a[4:7], 0
  ds_read_b64_tr_b16 v[42:43], v82 offset:6144
  v_mfma_f32_16x16x32_bf16 v[164:167], v[20:23], a[8:11], 0
  ds_read_b64_tr_b16 v[44:45], v83 offset:4096
  v_mfma_f32_16x16x32_bf16 v[180:183], v[20:23], a[12:15], 0
  ds_read_b64_tr_b16 v[46:47], v83 offset:6144
  v_mfma_f32_16x16x32_bf16 v[136:139], v[24:27], a[0:3], 0
  v_mfma_f32_16x16x32_bf16 v[152:155], v[24:27], a[4:7], 0
  s_mul_i32 s37, s34, 32768
  s_add_u32 s37, s37, s40
  s_add_u32 s34, s34, 1
  s_cmp_eq_u32 s34, 16
  s_cselect_b32 s34, 0, s34
  s_add_u32 m0, s36, 32768
  s_add_u32 s3, s37, 0
  buffer_load_dwordx4 v6, s[8:11], s3 offen sc1 lds
  v_mfma_f32_16x16x32_bf16 v[168:171], v[24:27], a[8:11], 0
  v_mfma_f32_16x16x32_bf16 v[184:187], v[24:27], a[12:15], 0
  s_add_u32 m0, s36, 33792
  s_add_u32 s3, s37, 8192
  buffer_load_dwordx4 v6, s[8:11], s3 offen sc1 lds
  v_mfma_f32_16x16x32_bf16 v[140:143], v[28:31], a[0:3], 0
  v_mfma_f32_16x16x32_bf16 v[156:159], v[28:31], a[4:7], 0
  s_add_u32 m0, s36, 34816
  s_add_u32 s3, s37, 16384
  buffer_load_dwordx4 v6, s[8:11], s3 offen sc1 lds
  v_mfma_f32_16x16x32_bf16 v[172:175], v[28:31], a[8:11], 0
  v_mfma_f32_16x16x32_bf16 v[188:191], v[28:31], a[12:15], 0
  s_add_u32 m0, s36, 35840
  s_add_u32 s3, s37, 24576
  buffer_load_dwordx4 v6, s[8:11], s3 offen sc1 lds
  s_waitcnt lgkmcnt(0) vmcnt(24)
  v_mfma_f32_16x16x32_bf16 v[128:131], v[32:35], a[16:19], v[128:131]
  ds_read_b64_tr_b16 v[16:17], v80 offset:8192
  v_mfma_f32_16x16x32_bf16 v[144:147], v[32:35], a[20:23], v[144:147]
  ds_read_b64_tr_b16 v[18:19], v80 offset:10240
  v_mfma_f32_16x16x32_bf16 v[160:163], v[32:35], a[24:27], v[160:163]
  ds_read_b64_tr_b16 v[20:21], v81 offset:8192
  v_mfma_f32_16x16x32_bf16 v[176:179], v[32:35], a[28:31], v[176:179]
  ds_read_b64_tr_b16 v[22:23], v81 offset:10240
  v_mfma_f32_16x16x32_bf16 v[132:135], v[36:39], a[16:19], v[132:135]
  ds_read_b64_tr_b16 v[24:25], v82 offset:8192
  v_mfma_f32_16x16x32_bf16 v[148:151], v[36:39], a[20:23], v[148:151]
  ds_read_b64_tr_b16 v[26:27], v82 offset:10240
  v_mfma_f32_16x16x32_bf16 v[164:167], v[36:39], a[24:27], v[164:167]
  ds_read_b64_tr_b16 v[28:29], v83 offset:8192
  v_mfma_f32_16x16x32_bf16 v[180:183], v[36:39], a[28:31], v[180:183]
  ds_read_b64_tr_b16 v[30:31], v83 offset:10240
  v_mfma_f32_16x16x32_bf16 v[136:139], v[40:43], a[16:19], v[136:139]
  v_mfma_f32_16x16x32_bf16 v[152:155], v[40:43], a[20:23], v[152:155]
  s_mul_i32 s37, s34, 32768
  s_add_u32 s37, s37, s40
  s_add_u32 s34, s34, 1
  s_cmp_eq_u32 s34, 16
  s_cselect_b32 s34, 0, s34
  s_add_u32 m0, s36, 36864
  s_add_u32 s3, s37, 0
  buffer_load_dwordx4 v6, s[8:11], s3 offen sc1 lds
  v_mfma_f32_16x16x32_bf16 v[168:171], v[40:43], a[24:27], v[168:171]
  v_mfma_f32_16x16x32_bf16 v[184:187], v[40:43], a[28:31], v[184:187]
  s_add_u32 m0, s36, 37888
  s_add_u32 s3, s37, 8192
  buffer_load_dwordx4 v6, s[8:11], s3 offen sc1 lds
  v_mfma_f32_16x16x32_bf16 v[140:143], v[44:47], a[16:19], v[140:143]
  v_mfma_f32_16x16x32_bf16 v[156:159], v[44:47], a[20:23], v[156:159]
  s_add_u32 m0, s36, 38912
  s_add_u32 s3, s37, 16384
  buffer_load_dwordx4 v6, s[8:11], s3 offen sc1 lds
  v_mfma_f32_16x16x32_bf16 v[172:175], v[44:47], a[24:27], v[172:175]
  v_mfma_f32_16x16x32_bf16 v[188:191], v[44:47], a[28:31], v[188:191]
  s_add_u32 m0, s36, 39936
  s_add_u32 s3, s37, 24576
  buffer_load_dwordx4 v6, s[8:11], s3 offen sc1 lds
  s_waitcnt lgkmcnt(0) vmcnt(24)
  v_mfma_f32_16x16x32_bf16 v[128:131], v[16:19], a[32:35], v[128:131]
  ds_read_b64_tr_b16 v[32:33], v80 offset:12288
  v_mfma_f32_16x16x32_bf16 v[144:147], v[16:19], a[36:39], v[144:147]
  ds_read_b64_tr_b16 v[34:35], v80 offset:14336
  v_mfma_f32_16x16x32_bf16 v[160:163], v[16:19], a[40:43], v[160:163]
  ds_read_b64_tr_b16 v[36:37], v81 offset:12288
  v_mfma_f32_16x16x32_bf16 v[176:179], v[16:19], a[44:47], v[176:179]
  ds_read_b64_tr_b16 v[38:39], v81 offset:14336
  v_mfma_f32_16x16x32_bf16 v[132:135], v[20:23], a[32:35], v[132:135]
  ds_read_b64_tr_b16 v[40:41], v82 offset:12288
  v_mfma_f32_16x16x32_bf16 v[148:151], v[20:23], a[36:39], v[148:151]
  ds_read_b64_tr_b16 v[42:43], v82 offset:14336
  v_mfma_f32_16x16x32_bf16 v[164:167], v[20:23], a[40:43], v[164:167]
  ds_read_b64_tr_b16 v[44:45], v83 offset:12288
  v_mfma_f32_16x16x32_bf16 v[180:183], v[20:23], a[44:47], v[180:183]
  ds_read_b64_tr_b16 v[46:47], v83 offset:14336
  v_mfma_f32_16x16x32_bf16 v[136:139], v[24:27], a[32:35], v[136:139]
  v_mfma_f32_16x16x32_bf16 v[152:155], v[24:27], a[36:39], v[152:155]
  s_mul_i32 s37, s34, 32768
  s_add_u32 s37, s37, s40
  s_add_u32 s34, s34, 1
  s_cmp_eq_u32 s34, 16
  s_cselect_b32 s34, 0, s34
  s_add_u32 m0, s36, 0
  s_add_u32 s3, s37, 0
  buffer_load_dwordx4 v6, s[8:11], s3 offen sc1 lds
  v_mfma_f32_16x16x32_bf16 v[168:171], v[24:27], a[40:43], v[168:171]
  v_mfma_f32_16x16x32_bf16 v[184:187], v[24:27], a[44:47], v[184:187]
  s_add_u32 m0, s36, 1024
  s_add_u32 s3, s37, 8192
  buffer_load_dwordx4 v6, s[8:11], s3 offen sc1 lds
  v_mfma_f32_16x16x32_bf16 v[140:143], v[28:31], a[32:35], v[140:143]
  v_mfma_f32_16x16x32_bf16 v[156:159], v[28:31], a[36:39], v[156:159]
  s_add_u32 m0, s36, 2048
  s_add_u32 s3, s37, 16384
  buffer_load_dwordx4 v6, s[8:11], s3 offen sc1 lds
  v_mfma_f32_16x16x32_bf16 v[172:175], v[28:31], a[40:43], v[172:175]
  v_mfma_f32_16x16x32_bf16 v[188:191], v[28:31], a[44:47], v[188:191]
  s_add_u32 m0, s36, 3072
  s_add_u32 s3, s37, 24576
  buffer_load_dwordx4 v6, s[8:11], s3 offen sc1 lds
  s_waitcnt lgkmcnt(0) vmcnt(24)
  v_mfma_f32_16x16x32_bf16 v[128:131], v[32:35], a[48:51], v[128:131]
  ds_read_b64_tr_b16 v[16:17], v80 offset:16384
  v_mfma_f32_16x16x32_bf16 v[144:147], v[32:35], a[52:55], v[144:147]
  ds_read_b64_tr_b16 v[18:19], v80 offset:18432
  v_mfma_f32_16x16x32_bf16 v[160:163], v[32:35], a[56:59], v[160:163]
  ds_read_b64_tr_b16 v[20:21], v81 offset:16384
  v_mfma_f32_16x16x32_bf16 v[176:179], v[32:35], a[60:63], v[176:179]
  ds_read_b64_tr_b16 v[22:23], v81 offset:18432
  v_mfma_f32_16x16x32_bf16 v[132:135], v[36:39], a[48:51], v[132:135]
  ds_read_b64_tr_b16 v[24:25], v82 offset:16384
  v_mfma_f32_16x16x32_bf16 v[148:151], v[36:39], a[52:55], v[148:151]
  ds_read_b64_tr_b16 v[26:27], v82 offset:18432
  v_mfma_f32_16x16x32_bf16 v[164:167], v[36:39], a[56:59], v[164:167]
  ds_read_b64_tr_b16 v[28:29], v83 offset:16384
  v_mfma_f32_16x16x32_bf16 v[180:183], v[36:39], a[60:63], v[180:183]
  ds_read_b64_tr_b16 v[30:31], v83 offset:18432
  v_mfma_f32_16x16x32_bf16 v[136:139], v[40:43], a[48:51], v[136:139]
  v_mfma_f32_16x16x32_bf16 v[152:155], v[40:43], a[52:55], v[152:155]
  s_mul_i32 s37, s34, 32768
  s_add_u32 s37, s37, s40
  s_add_u32 s34, s34, 1
  s_cmp_eq_u32 s34, 16
  s_cselect_b32 s34, 0, s34
  s_add_u32 m0, s36, 4096
  s_add_u32 s3, s37, 0
  buffer_load_dwordx4 v6, s[8:11], s3 offen sc1 lds
  v_mfma_f32_16x16x32_bf16 v[168:171], v[40:43], a[56:59], v[168:171]
  v_mfma_f32_16x16x32_bf16 v[184:187], v[40:43], a[60:63], v[184:187]
  s_add_u32 m0, s36, 5120
  s_add_u32 s3, s37, 8192
  buffer_load_dwordx4 v6, s[8:11], s3 offen sc1 lds
  v_mfma_f32_16x16x32_bf16 v[140:143], v[44:47], a[48:51], v[140:143]
  v_mfma_f32_16x16x32_bf16 v[156:159], v[44:47], a[52:55], v[156:159]
  s_add_u32 m0, s36, 6144
  s_add_u32 s3, s37, 16384
  buffer_load_dwordx4 v6, s[8:11], s3 offen sc1 lds
  v_mfma_f32_16x16x32_bf16 v[172:175], v[44:47], a[56:59], v[172:175]
  v_mfma_f32_16x16x32_bf16 v[188:191], v[44:47], a[60:63], v[188:191]
  s_add_u32 m0, s36, 7168
  s_add_u32 s3, s37, 24576
  buffer_load_dwordx4 v6, s[8:11], s3 offen sc1 lds
  s_waitcnt lgkmcnt(0) vmcnt(24)
  v_mfma_f32_16x16x32_bf16 v[128:131], v[16:19], a[64:67], v[128:131]
  ds_read_b64_tr_b16 v[32:33], v80 offset:20480
  v_mfma_f32_16x16x32_bf16 v[144:147], v[16:19], a[68:71], v[144:147]
  ds_read_b64_tr_b16 v[34:35], v80 offset:22528
  v_mfma_f32_16x16x32_bf16 v[160:163], v[16:19], a[72:75], v[160:163]
  ds_read_b64_tr_b16 v[36:37], v81 offset:20480
  v_mfma_f32_16x16x32_bf16 v[176:179], v[16:19], a[76:79], v[176:179]
  ds_read_b64_tr_b16 v[38:39], v81 offset:22528
  v_mfma_f32_16x16x32_bf16 v[132:135], v[20:23], a[64:67], v[132:135]
  ds_read_b64_tr_b16 v[40:41], v82 offset:20480
  v_mfma_f32_16x16x32_bf16 v[148:151], v[20:23], a[68:71], v[148:151]
  ds_read_b64_tr_b16 v[42:43], v82 offset:22528
  v_mfma_f32_16x16x32_bf16 v[164:167], v[20:23], a[72:75], v[164:167]
  ds_read_b64_tr_b16 v[44:45], v83 offset:20480
  v_mfma_f32_16x16x32_bf16 v[180:183], v[20:23], a[76:79], v[180:183]
  ds_read_b64_tr_b16 v[46:47], v83 offset:22528
  v_mfma_f32_16x16x32_bf16 v[136:139], v[24:27], a[64:67], v[136:139]
  v_mfma_f32_16x16x32_bf16 v[152:155], v[24:27], a[68:71], v[152:155]
  s_mul_i32 s37, s34, 32768
  s_add_u32 s37, s37, s40
  s_add_u32 s34, s34, 1
  s_cmp_eq_u32 s34, 16
  s_cselect_b32 s34, 0, s34
  s_add_u32 m0, s36, 8192
  s_add_u32 s3, s37, 0
  buffer_load_dwordx4 v6, s[8:11], s3 offen sc1 lds
  v_mfma_f32_16x16x32_bf16 v[168:171], v[24:27], a[72:75], v[168:171]
  v_mfma_f32_16x16x32_bf16 v[184:187], v[24:27], a[76:79], v[184:187]
  s_add_u32 m0, s36, 9216
  s_add_u32 s3, s37, 8192
  buffer_load_dwordx4 v6, s[8:11], s3 offen sc1 lds
  v_mfma_f32_16x16x32_bf16 v[140:143], v[28:31], a[64:67], v[140:143]
  v_mfma_f32_16x16x32_bf16 v[156:159], v[28:31], a[68:71], v[156:159]
  s_add_u32 m0, s36, 10240
  s_add_u32 s3, s37, 16384
  buffer_load_dwordx4 v6, s[8:11], s3 offen sc1 lds
  v_mfma_f32_16x16x32_bf16 v[172:175], v[28:31], a[72:75], v[172:175]
  v_mfma_f32_16x16x32_bf16 v[188:191], v[28:31], a[76:79], v[188:191]
  s_add_u32 m0, s36, 11264
  s_add_u32 s3, s37, 24576
  buffer_load_dwordx4 v6, s[8:11], s3 offen sc1 lds
  s_waitcnt lgkmcnt(0) vmcnt(24)
  v_mfma_f32_16x16x32_bf16 v[128:131], v[32:35], a[80:83], v[128:131]
  ds_read_b64_tr_b16 v[16:17], v80 offset:24576
  v_mfma_f32_16x16x32_bf16 v[144:147], v[32:35], a[84:87], v[144:147]
  ds_read_b64_tr_b16 v[18:19], v80 offset:26624
  v_mfma_f32_16x16x32_bf16 v[160:163], v[32:35], a[88:91], v[160:163]
  ds_read_b64_tr_b16 v[20:21], v81 offset:24576
  v_mfma_f32_16x16x32_bf16 v[176:179], v[32:35], a[92:95], v[176:179]
  ds_read_b64_tr_b16 v[22:23], v81 offset:26624
  v_mfma_f32_16x16x32_bf16 v[132:135], v[36:39], a[80:83], v[132:135]
  ds_read_b64_tr_b16 v[24:25], v82 offset:24576
  v_mfma_f32_16x16x32_bf16 v[148:151], v[36:39], a[84:87], v[148:151]
  ds_read_b64_tr_b16 v[26:27], v82 offset:26624
  v_mfma_f32_16x16x32_bf16 v[164:167], v[36:39], a[88:91], v[164:167]
  ds_read_b64_tr_b16 v[28:29], v83 offset:24576
  v_mfma_f32_16x16x32_bf16 v[180:183], v[36:39], a[92:95], v[180:183]
  ds_read_b64_tr_b16 v[30:31], v83 offset:26624
  v_mfma_f32_16x16x32_bf16 v[136:139], v[40:43], a[80:83], v[136:139]
  v_mfma_f32_16x16x32_bf16 v[152:155], v[40:43], a[84:87], v[152:155]
  s_mul_i32 s37, s34, 32768
  s_add_u32 s37, s37, s40
  s_add_u32 s34, s34, 1
  s_cmp_eq_u32 s34, 16
  s_cselect_b32 s34, 0, s34
  s_add_u32 m0, s36, 12288
  s_add_u32 s3, s37, 0
  buffer_load_dwordx4 v6, s[8:11], s3 offen sc1 lds
  v_mfma_f32_16x16x32_bf16 v[168:171], v[40:43], a[88:91], v[168:171]
  v_mfma_f32_16x16x32_bf16 v[184:187], v[40:43], a[92:95], v[184:187]
  s_add_u32 m0, s36, 13312
  s_add_u32 s3, s37, 8192
  buffer_load_dwordx4 v6, s[8:11], s3 offen sc1 lds
  v_mfma_f32_16x16x32_bf16 v[140:143], v[44:47], a[80:83], v[140:143]
  v_mfma_f32_16x16x32_bf16 v[156:159], v[44:47], a[84:87], v[156:159]
  s_add_u32 m0, s36, 14336
  s_add_u32 s3, s37, 16384
  buffer_load_dwordx4 v6, s[8:11], s3 offen sc1 lds
  v_mfma_f32_16x16x32_bf16 v[172:175], v[44:47], a[88:91], v[172:175]
  v_mfma_f32_16x16x32_bf16 v[188:191], v[44:47], a[92:95], v[188:191]
  s_add_u32 m0, s36, 15360
  s_add_u32 s3, s37, 24576
  buffer_load_dwordx4 v6, s[8:11], s3 offen sc1 lds
  s_waitcnt lgkmcnt(0) vmcnt(24)
  v_mfma_f32_16x16x32_bf16 v[128:131], v[16:19], a[96:99], v[128:131]
  ds_read_b64_tr_b16 v[32:33], v80 offset:28672
  v_mfma_f32_16x16x32_bf16 v[144:147], v[16:19], a[100:103], v[144:147]
  ds_read_b64_tr_b16 v[34:35], v80 offset:30720
  v_mfma_f32_16x16x32_bf16 v[160:163], v[16:19], a[104:107], v[160:163]
  ds_read_b64_tr_b16 v[36:37], v81 offset:28672
  v_mfma_f32_16x16x32_bf16 v[176:179], v[16:19], a[108:111], v[176:179]
  ds_read_b64_tr_b16 v[38:39], v81 offset:30720
  v_mfma_f32_16x16x32_bf16 v[132:135], v[20:23], a[96:99], v[132:135]
  ds_read_b64_tr_b16 v[40:41], v82 offset:28672
  v_mfma_f32_16x16x32_bf16 v[148:151], v[20:23], a[100:103], v[148:151]
  ds_read_b64_tr_b16 v[42:43], v82 offset:30720
  v_mfma_f32_16x16x32_bf16 v[164:167], v[20:23], a[104:107], v[164:167]
  ds_read_b64_tr_b16 v[44:45], v83 offset:28672
  v_mfma_f32_16x16x32_bf16 v[180:183], v[20:23], a[108:111], v[180:183]
  ds_read_b64_tr_b16 v[46:47], v83 offset:30720
  v_mfma_f32_16x16x32_bf16 v[136:139], v[24:27], a[96:99], v[136:139]
  v_mfma_f32_16x16x32_bf16 v[152:155], v[24:27], a[100:103], v[152:155]
  s_mul_i32 s37, s34, 32768
  s_add_u32 s37, s37, s40
  s_add_u32 s34, s34, 1
  s_cmp_eq_u32 s34, 16
  s_cselect_b32 s34, 0, s34
  s_add_u32 m0, s36, 16384
  s_add_u32 s3, s37, 0
  buffer_load_dwordx4 v6, s[8:11], s3 offen sc1 lds
  v_mfma_f32_16x16x32_bf16 v[168:171], v[24:27], a[104:107], v[168:171]
  v_mfma_f32_16x16x32_bf16 v[184:187], v[24:27], a[108:111], v[184:187]
  s_add_u32 m0, s36, 17408
  s_add_u32 s3, s37, 8192
  buffer_load_dwordx4 v6, s[8:11], s3 offen sc1 lds
  v_mfma_f32_16x16x32_bf16 v[140:143], v[28:31], a[96:99], v[140:143]
  v_mfma_f32_16x16x32_bf16 v[156:159], v[28:31], a[100:103], v[156:159]
  s_add_u32 m0, s36, 18432
  s_add_u32 s3, s37, 16384
  buffer_load_dwordx4 v6, s[8:11], s3 offen sc1 lds
  v_mfma_f32_16x16x32_bf16 v[172:175], v[28:31], a[104:107], v[172:175]
  v_mfma_f32_16x16x32_bf16 v[188:191], v[28:31], a[108:111], v[188:191]
  s_add_u32 m0, s36, 19456
  s_add_u32 s3, s37, 24576
  buffer_load_dwordx4 v6, s[8:11], s3 offen sc1 lds
  s_waitcnt lgkmcnt(0) vmcnt(24)
  v_mfma_f32_16x16x32_bf16 v[128:131], v[32:35], a[112:115], v[128:131]
  ds_read_b64_tr_b16 v[16:17], v80 offset:32768
  v_mfma_f32_16x16x32_bf16 v[144:147], v[32:35], a[116:119], v[144:147]
  ds_read_b64_tr_b16 v[18:19], v80 offset:34816
  v_mfma_f32_16x16x32_bf16 v[160:163], v[32:35], a[120:123], v[160:163]
  ds_read_b64_tr_b16 v[20:21], v81 offset:32768
  v_mfma_f32_16x16x32_bf16 v[176:179], v[32:35], a[124:127], v[176:179]
  ds_read_b64_tr_b16 v[22:23], v81 offset:34816
  v_mfma_f32_16x16x32_bf16 v[132:135], v[36:39], a[112:115], v[132:135]
  ds_read_b64_tr_b16 v[24:25], v82 offset:32768
  v_mfma_f32_16x16x32_bf16 v[148:151], v[36:39], a[116:119], v[148:151]
  ds_read_b64_tr_b16 v[26:27], v82 offset:34816
  v_mfma_f32_16x16x32_bf16 v[164:167], v[36:39], a[120:123], v[164:167]
  ds_read_b64_tr_b16 v[28:29], v83 offset:32768
  v_mfma_f32_16x16x32_bf16 v[180:183], v[36:39], a[124:127], v[180:183]
  ds_read_b64_tr_b16 v[30:31], v83 offset:34816
  v_mfma_f32_16x16x32_bf16 v[136:139], v[40:43], a[112:115], v[136:139]
  v_mfma_f32_16x16x32_bf16 v[152:155], v[40:43], a[116:119], v[152:155]
  s_mul_i32 s37, s34, 32768
  s_add_u32 s37, s37, s40
  s_add_u32 s34, s34, 1
  s_cmp_eq_u32 s34, 16
  s_cselect_b32 s34, 0, s34
  s_add_u32 m0, s36, 20480
  s_add_u32 s3, s37, 0
  buffer_load_dwordx4 v6, s[8:11], s3 offen sc1 lds
  v_mfma_f32_16x16x32_bf16 v[168:171], v[40:43], a[120:123], v[168:171]
  v_mfma_f32_16x16x32_bf16 v[184:187], v[40:43], a[124:127], v[184:187]
  s_add_u32 m0, s36, 21504
  s_add_u32 s3, s37, 8192
  buffer_load_dwordx4 v6, s[8:11], s3 offen sc1 lds
  v_mfma_f32_16x16x32_bf16 v[140:143], v[44:47], a[112:115], v[140:143]
  v_mfma_f32_16x16x32_bf16 v[156:159], v[44:47], a[116:119], v[156:159]
  s_add_u32 m0, s36, 22528
  s_add_u32 s3, s37, 16384
  buffer_load_dwordx4 v6, s[8:11], s3 offen sc1 lds
  v_mfma_f32_16x16x32_bf16 v[172:175], v[44:47], a[120:123], v[172:175]
  v_mfma_f32_16x16x32_bf16 v[188:191], v[44:47], a[124:127], v[188:191]
  s_add_u32 m0, s36, 23552
  s_add_u32 s3, s37, 24576
  buffer_load_dwordx4 v6, s[8:11], s3 offen sc1 lds
  s_waitcnt lgkmcnt(0) vmcnt(24)
  v_mfma_f32_16x16x32_bf16 v[128:131], v[16:19], a[128:131], v[128:131]
  ds_read_b64_tr_b16 v[32:33], v80 offset:36864
  v_mfma_f32_16x16x32_bf16 v[144:147], v[16:19], a[132:135], v[144:147]
  ds_read_b64_tr_b16 v[34:35], v80 offset:38912
  v_mfma_f32_16x16x32_bf16 v[160:163], v[16:19], a[136:139], v[160:163]
  ds_read_b64_tr_b16 v[36:37], v81 offset:36864
  v_mfma_f32_16x16x32_bf16 v[176:179], v[16:19], a[140:143], v[176:179]
  ds_read_b64_tr_b16 v[38:39], v81 offset:38912
  v_mfma_f32_16x16x32_bf16 v[132:135], v[20:23], a[128:131], v[132:135]
  ds_read_b64_tr_b16 v[40:41], v82 offset:36864
  v_mfma_f32_16x16x32_bf16 v[148:151], v[20:23], a[132:135], v[148:151]
  ds_read_b64_tr_b16 v[42:43], v82 offset:38912
  v_mfma_f32_16x16x32_bf16 v[164:167], v[20:23], a[136:139], v[164:167]
  ds_read_b64_tr_b16 v[44:45], v83 offset:36864
  v_mfma_f32_16x16x32_bf16 v[180:183], v[20:23], a[140:143], v[180:183]
  ds_read_b64_tr_b16 v[46:47], v83 offset:38912
  v_mfma_f32_16x16x32_bf16 v[136:139], v[24:27], a[128:131], v[136:139]
  v_mfma_f32_16x16x32_bf16 v[152:155], v[24:27], a[132:135], v[152:155]
  v_mfma_f32_16x16x32_bf16 v[168:171], v[24:27], a[136:139], v[168:171]
  v_mfma_f32_16x16x32_bf16 v[184:187], v[24:27], a[140:143], v[184:187]
  v_mfma_f32_16x16x32_bf16 v[140:143], v[28:31], a[128:131], v[140:143]
  v_mfma_f32_16x16x32_bf16 v[156:159], v[28:31], a[132:135], v[156:159]
  v_mfma_f32_16x16x32_bf16 v[172:175], v[28:31], a[136:139], v[172:175]
  v_mfma_f32_16x16x32_bf16 v[188:191], v[28:31], a[140:143], v[188:191]
  s_waitcnt lgkmcnt(0) vmcnt(20)
  v_mfma_f32_16x16x32_bf16 v[128:131], v[32:35], a[144:147], v[128:131]
  ds_read_b64_tr_b16 v[16:17], v80 offset:0
  v_mfma_f32_16x16x32_bf16 v[144:147], v[32:35], a[148:151], v[144:147]
  ds_read_b64_tr_b16 v[18:19], v80 offset:2048
  v_mfma_f32_16x16x32_bf16 v[160:163], v[32:35], a[152:155], v[160:163]
  ds_read_b64_tr_b16 v[20:21], v81 offset:0
  v_mfma_f32_16x16x32_bf16 v[176:179], v[32:35], a[156:159], v[176:179]
  ds_read_b64_tr_b16 v[22:23], v81 offset:2048
  v_mfma_f32_16x16x32_bf16 v[132:135], v[36:39], a[144:147], v[132:135]
  ds_read_b64_tr_b16 v[24:25], v82 offset:0
  v_mfma_f32_16x16x32_bf16 v[148:151], v[36:39], a[148:151], v[148:151]
  ds_read_b64_tr_b16 v[26:27], v82 offset:2048
  v_mfma_f32_16x16x32_bf16 v[164:167], v[36:39], a[152:155], v[164:167]
  ds_read_b64_tr_b16 v[28:29], v83 offset:0
  v_mfma_f32_16x16x32_bf16 v[180:183], v[36:39], a[156:159], v[180:183]
  ds_read_b64_tr_b16 v[30:31], v83 offset:2048
  v_mfma_f32_16x16x32_bf16 v[136:139], v[40:43], a[144:147], v[136:139]
  v_mfma_f32_16x16x32_bf16 v[152:155], v[40:43], a[148:151], v[152:155]
  v_mfma_f32_16x16x32_bf16 v[168:171], v[40:43], a[152:155], v[168:171]
  v_mfma_f32_16x16x32_bf16 v[184:187], v[40:43], a[156:159], v[184:187]
  v_mfma_f32_16x16x32_bf16 v[140:143], v[44:47], a[144:147], v[140:143]
  v_mfma_f32_16x16x32_bf16 v[156:159], v[44:47], a[148:151], v[156:159]
  v_mfma_f32_16x16x32_bf16 v[172:175], v[44:47], a[152:155], v[172:175]
  v_mfma_f32_16x16x32_bf16 v[188:191], v[44:47], a[156:159], v[188:191]
  s_waitcnt lgkmcnt(0) vmcnt(16)
  v_mfma_f32_16x16x32_bf16 v[128:131], v[16:19], a[160:163], v[128:131]
  ds_read_b64_tr_b16 v[32:33], v80 offset:4096
  v_mfma_f32_16x16x32_bf16 v[144:147], v[16:19], a[164:167], v[144:147]
  ds_read_b64_tr_b16 v[34:35], v80 offset:6144
  v_mfma_f32_16x16x32_bf16 v[160:163], v[16:19], a[168:171], v[160:163]
  ds_read_b64_tr_b16 v[36:37], v81 offset:4096
  v_mfma_f32_16x16x32_bf16 v[176:179], v[16:19], a[172:175], v[176:179]
  ds_read_b64_tr_b16 v[38:39], v81 offset:6144
  v_mfma_f32_16x16x32_bf16 v[132:135], v[20:23], a[160:163], v[132:135]
  ds_read_b64_tr_b16 v[40:41], v82 offset:4096
  v_mfma_f32_16x16x32_bf16 v[148:151], v[20:23], a[164:167], v[148:151]
  ds_read_b64_tr_b16 v[42:43], v82 offset:6144
  v_mfma_f32_16x16x32_bf16 v[164:167], v[20:23], a[168:171], v[164:167]
  ds_read_b64_tr_b16 v[44:45], v83 offset:4096
  v_mfma_f32_16x16x32_bf16 v[180:183], v[20:23], a[172:175], v[180:183]
  ds_read_b64_tr_b16 v[46:47], v83 offset:6144
  v_mfma_f32_16x16x32_bf16 v[136:139], v[24:27], a[160:163], v[136:139]
  v_mfma_f32_16x16x32_bf16 v[152:155], v[24:27], a[164:167], v[152:155]
  v_mfma_f32_16x16x32_bf16 v[168:171], v[24:27], a[168:171], v[168:171]
  v_mfma_f32_16x16x32_bf16 v[184:187], v[24:27], a[172:175], v[184:187]
  v_mfma_f32_16x16x32_bf16 v[140:143], v[28:31], a[160:163], v[140:143]
  v_mfma_f32_16x16x32_bf16 v[156:159], v[28:31], a[164:167], v[156:159]
  v_mfma_f32_16x16x32_bf16 v[172:175], v[28:31], a[168:171], v[172:175]
  v_mfma_f32_16x16x32_bf16 v[188:191], v[28:31], a[172:175], v[188:191]
  s_waitcnt lgkmcnt(0) vmcnt(12)
  v_mfma_f32_16x16x32_bf16 v[128:131], v[32:35], a[176:179], v[128:131]
  ds_read_b64_tr_b16 v[16:17], v80 offset:8192
  v_mfma_f32_16x16x32_bf16 v[144:147], v[32:35], a[180:183], v[144:147]
  ds_read_b64_tr_b16 v[18:19], v80 offset:10240
  v_mfma_f32_16x16x32_bf16 v[160:163], v[32:35], a[184:187], v[160:163]
  ds_read_b64_tr_b16 v[20:21], v81 offset:8192
  v_mfma_f32_16x16x32_bf16 v[176:179], v[32:35], a[188:191], v[176:179]
  ds_read_b64_tr_b16 v[22:23], v81 offset:10240
  v_mfma_f32_16x16x32_bf16 v[132:135], v[36:39], a[176:179], v[132:135]
  ds_read_b64_tr_b16 v[24:25], v82 offset:8192
  v_mfma_f32_16x16x32_bf16 v[148:151], v[36:39], a[180:183], v[148:151]
  ds_read_b64_tr_b16 v[26:27], v82 offset:10240
  v_mfma_f32_16x16x32_bf16 v[164:167], v[36:39], a[184:187], v[164:167]
  ds_read_b64_tr_b16 v[28:29], v83 offset:8192
  v_mfma_f32_16x16x32_bf16 v[180:183], v[36:39], a[188:191], v[180:183]
  ds_read_b64_tr_b16 v[30:31], v83 offset:10240
  v_mfma_f32_16x16x32_bf16 v[136:139], v[40:43], a[176:179], v[136:139]
  v_mfma_f32_16x16x32_bf16 v[152:155], v[40:43], a[180:183], v[152:155]
  v_mfma_f32_16x16x32_bf16 v[168:171], v[40:43], a[184:187], v[168:171]
  v_mfma_f32_16x16x32_bf16 v[184:187], v[40:43], a[188:191], v[184:187]
  v_mfma_f32_16x16x32_bf16 v[140:143], v[44:47], a[176:179], v[140:143]
  v_mfma_f32_16x16x32_bf16 v[156:159], v[44:47], a[180:183], v[156:159]
  v_mfma_f32_16x16x32_bf16 v[172:175], v[44:47], a[184:187], v[172:175]
  v_mfma_f32_16x16x32_bf16 v[188:191], v[44:47], a[188:191], v[188:191]
  s_waitcnt lgkmcnt(0) vmcnt(8)
  v_mfma_f32_16x16x32_bf16 v[128:131], v[16:19], a[192:195], v[128:131]
  ds_read_b64_tr_b16 v[32:33], v80 offset:12288
  v_mfma_f32_16x16x32_bf16 v[144:147], v[16:19], a[196:199], v[144:147]
  ds_read_b64_tr_b16 v[34:35], v80 offset:14336
  v_mfma_f32_16x16x32_bf16 v[160:163], v[16:19], a[200:203], v[160:163]
  ds_read_b64_tr_b16 v[36:37], v81 offset:12288
  v_mfma_f32_16x16x32_bf16 v[176:179], v[16:19], a[204:207], v[176:179]
  ds_read_b64_tr_b16 v[38:39], v81 offset:14336
  v_mfma_f32_16x16x32_bf16 v[132:135], v[20:23], a[192:195], v[132:135]
  ds_read_b64_tr_b16 v[40:41], v82 offset:12288
  v_mfma_f32_16x16x32_bf16 v[148:151], v[20:23], a[196:199], v[148:151]
  ds_read_b64_tr_b16 v[42:43], v82 offset:14336
  v_mfma_f32_16x16x32_bf16 v[164:167], v[20:23], a[200:203], v[164:167]
  ds_read_b64_tr_b16 v[44:45], v83 offset:12288
  v_mfma_f32_16x16x32_bf16 v[180:183], v[20:23], a[204:207], v[180:183]
  ds_read_b64_tr_b16 v[46:47], v83 offset:14336
  v_mfma_f32_16x16x32_bf16 v[136:139], v[24:27], a[192:195], v[136:139]
  v_mfma_f32_16x16x32_bf16 v[152:155], v[24:27], a[196:199], v[152:155]
  v_mfma_f32_16x16x32_bf16 v[168:171], v[24:27], a[200:203], v[168:171]
  v_mfma_f32_16x16x32_bf16 v[184:187], v[24:27], a[204:207], v[184:187]
  v_mfma_f32_16x16x32_bf16 v[140:143], v[28:31], a[192:195], v[140:143]
  v_mfma_f32_16x16x32_bf16 v[156:159], v[28:31], a[196:199], v[156:159]
  v_mfma_f32_16x16x32_bf16 v[172:175], v[28:31], a[200:203], v[172:175]
  v_mfma_f32_16x16x32_bf16 v[188:191], v[28:31], a[204:207], v[188:191]
  s_waitcnt lgkmcnt(0) vmcnt(4)
  v_mfma_f32_16x16x32_bf16 v[128:131], v[32:35], a[208:211], v[128:131]
  ds_read_b64_tr_b16 v[16:17], v80 offset:16384
  v_mfma_f32_16x16x32_bf16 v[144:147], v[32:35], a[212:215], v[144:147]
  ds_read_b64_tr_b16 v[18:19], v80 offset:18432
  v_mfma_f32_16x16x32_bf16 v[160:163], v[32:35], a[216:219], v[160:163]
  ds_read_b64_tr_b16 v[20:21], v81 offset:16384
  v_mfma_f32_16x16x32_bf16 v[176:179], v[32:35], a[220:223], v[176:179]
  ds_read_b64_tr_b16 v[22:23], v81 offset:18432
  v_mfma_f32_16x16x32_bf16 v[132:135], v[36:39], a[208:211], v[132:135]
  ds_read_b64_tr_b16 v[24:25], v82 offset:16384
  v_mfma_f32_16x16x32_bf16 v[148:151], v[36:39], a[212:215], v[148:151]
  ds_read_b64_tr_b16 v[26:27], v82 offset:18432
  v_mfma_f32_16x16x32_bf16 v[164:167], v[36:39], a[216:219], v[164:167]
  ds_read_b64_tr_b16 v[28:29], v83 offset:16384
  v_mfma_f32_16x16x32_bf16 v[180:183], v[36:39], a[220:223], v[180:183]
  ds_read_b64_tr_b16 v[30:31], v83 offset:18432
  v_mfma_f32_16x16x32_bf16 v[136:139], v[40:43], a[208:211], v[136:139]
  v_mfma_f32_16x16x32_bf16 v[152:155], v[40:43], a[212:215], v[152:155]
  v_mfma_f32_16x16x32_bf16 v[168:171], v[40:43], a[216:219], v[168:171]
  v_mfma_f32_16x16x32_bf16 v[184:187], v[40:43], a[220:223], v[184:187]
  v_mfma_f32_16x16x32_bf16 v[140:143], v[44:47], a[208:211], v[140:143]
  v_mfma_f32_16x16x32_bf16 v[156:159], v[44:47], a[212:215], v[156:159]
  v_mfma_f32_16x16x32_bf16 v[172:175], v[44:47], a[216:219], v[172:175]
  v_mfma_f32_16x16x32_bf16 v[188:191], v[44:47], a[220:223], v[188:191]
  s_waitcnt lgkmcnt(0) vmcnt(0)
  v_mfma_f32_16x16x32_bf16 v[128:131], v[16:19], a[224:227], v[128:131]
  ds_read_b64_tr_b16 v[32:33], v80 offset:20480
  v_mfma_f32_16x16x32_bf16 v[144:147], v[16:19], a[228:231], v[144:147]
  ds_read_b64_tr_b16 v[34:35], v80 offset:22528
  v_mfma_f32_16x16x32_bf16 v[160:163], v[16:19], a[232:235], v[160:163]
  ds_read_b64_tr_b16 v[36:37], v81 offset:20480
  v_mfma_f32_16x16x32_bf16 v[176:179], v[16:19], a[236:239], v[176:179]
  ds_read_b64_tr_b16 v[38:39], v81 offset:22528
  v_mfma_f32_16x16x32_bf16 v[132:135], v[20:23], a[224:227], v[132:135]
  ds_read_b64_tr_b16 v[40:41], v82 offset:20480
  v_mfma_f32_16x16x32_bf16 v[148:151], v[20:23], a[228:231], v[148:151]
  ds_read_b64_tr_b16 v[42:43], v82 offset:22528
  v_mfma_f32_16x16x32_bf16 v[164:167], v[20:23], a[232:235], v[164:167]
  ds_read_b64_tr_b16 v[44:45], v83 offset:20480
  v_mfma_f32_16x16x32_bf16 v[180:183], v[20:23], a[236:239], v[180:183]
  ds_read_b64_tr_b16 v[46:47], v83 offset:22528
  v_mfma_f32_16x16x32_bf16 v[136:139], v[24:27], a[224:227], v[136:139]
  v_mfma_f32_16x16x32_bf16 v[152:155], v[24:27], a[228:231], v[152:155]
  v_mfma_f32_16x16x32_bf16 v[168:171], v[24:27], a[232:235], v[168:171]
  v_mfma_f32_16x16x32_bf16 v[184:187], v[24:27], a[236:239], v[184:187]
  v_mfma_f32_16x16x32_bf16 v[140:143], v[28:31], a[224:227], v[140:143]
  v_mfma_f32_16x16x32_bf16 v[156:159], v[28:31], a[228:231], v[156:159]
  v_mfma_f32_16x16x32_bf16 v[172:175], v[28:31], a[232:235], v[172:175]
  v_mfma_f32_16x16x32_bf16 v[188:191], v[28:31], a[236:239], v[188:191]
  s_waitcnt lgkmcnt(0)
  v_mfma_f32_16x16x32_bf16 v[128:131], v[32:35], a[240:243], v[128:131]
  v_mfma_f32_16x16x32_bf16 v[144:147], v[32:35], a[244:247], v[144:147]
  v_mfma_f32_16x16x32_bf16 v[160:163], v[32:35], a[248:251], v[160:163]
  v_mfma_f32_16x16x32_bf16 v[176:179], v[32:35], a[252:255], v[176:179]
  v_mfma_f32_16x16x32_bf16 v[132:135], v[36:39], a[240:243], v[132:135]
  v_mfma_f32_16x16x32_bf16 v[148:151], v[36:39], a[244:247], v[148:151]
  v_mfma_f32_16x16x32_bf16 v[164:167], v[36:39], a[248:251], v[164:167]
  v_mfma_f32_16x16x32_bf16 v[180:183], v[36:39], a[252:255], v[180:183]
  v_mfma_f32_16x16x32_bf16 v[136:139], v[40:43], a[240:243], v[136:139]
  v_mfma_f32_16x16x32_bf16 v[152:155], v[40:43], a[244:247], v[152:155]
  v_mfma_f32_16x16x32_bf16 v[168:171], v[40:43], a[248:251], v[168:171]
  v_mfma_f32_16x16x32_bf16 v[184:187], v[40:43], a[252:255], v[184:187]
  v_mfma_f32_16x16x32_bf16 v[140:143], v[44:47], a[240:243], v[140:143]
  v_mfma_f32_16x16x32_bf16 v[156:159], v[44:47], a[244:247], v[156:159]
  v_mfma_f32_16x16x32_bf16 v[172:175], v[44:47], a[248:251], v[172:175]
  v_mfma_f32_16x16x32_bf16 v[188:191], v[44:47], a[252:255], v[188:191]
  s_barrier
  s_lshl_b32 s3, s29, 14
  v_add_u32 v4, s3, v1
  ds_write_b128 v4, v[128:131] offset:0
  ds_write_b128 v4, v[132:135] offset:1024
  ds_write_b128 v4, v[136:139] offset:2048
  ds_write_b128 v4, v[140:143] offset:3072
  ds_write_b128 v4, v[144:147] offset:4096
  ds_write_b128 v4, v[148:151] offset:5120
  ds_write_b128 v4, v[152:155] offset:6144
  ds_write_b128 v4, v[156:159] offset:7168
  s_waitcnt lgkmcnt(0)
  ds_write_b128 v4, v[160:163] offset:8192
  ds_write_b128 v4, v[164:167] offset:9216
  ds_write_b128 v4, v[168:171] offset:10240
  ds_write_b128 v4, v[172:175] offset:11264
  ds_write_b128 v4, v[176:179] offset:12288
  ds_write_b128 v4, v[180:183] offset:13312
  ds_write_b128 v4, v[184:187] offset:14336
  ds_write_b128 v4, v[188:191] offset:15360
  s_waitcnt lgkmcnt(0)
  v_bfe_u32 v4, v0, 0, 1
  v_lshlrev_b32 v5, 9, v4
  v_bfe_u32 v4, v0, 1, 1
  v_lshl_add_u32 v5, v4, 10, v5
  v_bfe_u32 v4, v0, 2, 1
  v_lshl_add_u32 v5, v4, 11, v5
  v_bfe_u32 v4, v0, 3, 1
  v_lshl_add_u32 v5, v4, 4, v5
  v_bfe_u32 v4, v0, 4, 1
  v_lshl_add_u32 v5, v4, 5, v5
  v_bfe_u32 v4, v0, 5, 1
  v_lshl_add_u32 v5, v4, 6, v5
  s_barrier
  s_lshl_b32 s3, s29, 12
  v_add_u32 v4, s3, v5
  ds_read_b128 v[16:19], v4 offset:0
  ds_read_b128 v[20:23], v4 offset:256
  ds_read_b128 v[24:27], v4 offset:128
  ds_read_b128 v[28:31], v4 offset:384
  ds_read_b128 v[32:35], v4 offset:16384
  ds_read_b128 v[36:39], v4 offset:16640
  ds_read_b128 v[40:43], v4 offset:16512
  ds_read_b128 v[44:47], v4 offset:16768
  s_waitcnt lgkmcnt(0)
  ds_read_b128 v[48:51], v4 offset:32768
  ds_read_b128 v[52:55], v4 offset:33024
  ds_read_b128 v[56:59], v4 offset:32896
  ds_read_b128 v[60:63], v4 offset:33152
  ds_read_b128 v[64:67], v4 offset:49152
  ds_read_b128 v[68:71], v4 offset:49408
  ds_read_b128 v[72:75], v4 offset:49280
  ds_read_b128 v[76:79], v4 offset:49536
  s_waitcnt lgkmcnt(0)
  v_lshlrev_b32 v14, 16, v14
  v_lshlrev_b32 v15, 16, v15
  v_add_f32 v16, v16, v32
  v_add_f32 v48, v48, v64
  v_add_f32 v16, v16, v48
  v_add_f32 v17, v17, v33
  v_add_f32 v49, v49, v65
  v_add_f32 v17, v17, v49
  v_add_f32 v18, v18, v34
  v_add_f32 v50, v50, v66
  v_add_f32 v18, v18, v50
  v_add_f32 v19, v19, v35
  v_add_f32 v51, v51, v67
  v_add_f32 v19, v19, v51
  v_add_f32 v20, v20, v36
  v_add_f32 v52, v52, v68
  v_add_f32 v20, v20, v52
  v_add_f32 v21, v21, v37
  v_add_f32 v53, v53, v69
  v_add_f32 v21, v21, v53
  v_add_f32 v22, v22, v38
  v_add_f32 v54, v54, v70
  v_add_f32 v22, v22, v54
  v_add_f32 v23, v23, v39
  v_add_f32 v55, v55, v71
  v_add_f32 v23, v23, v55
  v_add_f32 v24, v24, v40
  v_add_f32 v56, v56, v72
  v_add_f32 v24, v24, v56
  v_add_f32 v25, v25, v41
  v_add_f32 v57, v57, v73
  v_add_f32 v25, v25, v57
  v_add_f32 v26, v26, v42
  v_add_f32 v58, v58, v74
  v_add_f32 v26, v26, v58
  v_add_f32 v27, v27, v43
  v_add_f32 v59, v59, v75
  v_add_f32 v27, v27, v59
  v_add_f32 v28, v28, v44
  v_add_f32 v60, v60, v76
  v_add_f32 v28, v28, v60
  v_add_f32 v29, v29, v45
  v_add_f32 v61, v61, v77
  v_add_f32 v29, v29, v61
  v_add_f32 v30, v30, v46
  v_add_f32 v62, v62, v78
  v_add_f32 v30, v30, v62
  v_add_f32 v31, v31, v47
  v_add_f32 v63, v63, v79
  v_add_f32 v31, v31, v63
  v_cvt_pk_bf16_f32 v32, v16, v17
  v_and_b32 v17, 0xffff0000, v32
  v_lshlrev_b32 v16, 16, v32
  v_add_f32 v16, v16, v14
  v_add_f32 v17, v17, v14
  v_cvt_pk_bf16_f32 v32, v16, v17
  v_and_b32 v17, 0xffff0000, v32
  v_lshlrev_b32 v16, 16, v32
  v_mov_b32 v6, 0xbdd2d3e8
  v_mul_f32 v4, v16, v16
  v_fmaak_f32 v4, v4, v6, 0xc0135761
  v_mul_f32 v4, v4, v16
  v_exp_f32 v4, v4
  s_nop 0
  v_add_f32 v4, 1.0, v4
  v_rcp_f32 v4, v4
  s_nop 0
  v_mul_f32 v16, v16, v4
  v_mul_f32 v5, v17, v17
  v_fmaak_f32 v5, v5, v6, 0xc0135761
  v_mul_f32 v5, v5, v17
  v_exp_f32 v5, v5
  s_nop 0
  v_add_f32 v5, 1.0, v5
  v_rcp_f32 v5, v5
  s_nop 0
  v_mul_f32 v17, v17, v5
  v_cvt_pk_bf16_f32 v32, v16, v17
  v_cvt_pk_bf16_f32 v33, v18, v19
  v_and_b32 v19, 0xffff0000, v33
  v_lshlrev_b32 v18, 16, v33
  v_add_f32 v18, v18, v14
  v_add_f32 v19, v19, v14
  v_cvt_pk_bf16_f32 v33, v18, v19
  v_and_b32 v19, 0xffff0000, v33
  v_lshlrev_b32 v18, 16, v33
  v_mul_f32 v4, v18, v18
  v_fmaak_f32 v4, v4, v6, 0xc0135761
  v_mul_f32 v4, v4, v18
  v_exp_f32 v4, v4
  s_nop 0
  v_add_f32 v4, 1.0, v4
  v_rcp_f32 v4, v4
  s_nop 0
  v_mul_f32 v18, v18, v4
  v_mul_f32 v5, v19, v19
  v_fmaak_f32 v5, v5, v6, 0xc0135761
  v_mul_f32 v5, v5, v19
  v_exp_f32 v5, v5
  s_nop 0
  v_add_f32 v5, 1.0, v5
  v_rcp_f32 v5, v5
  s_nop 0
  v_mul_f32 v19, v19, v5
  v_cvt_pk_bf16_f32 v33, v18, v19
  v_cvt_pk_bf16_f32 v34, v20, v21
  v_and_b32 v21, 0xffff0000, v34
  v_lshlrev_b32 v20, 16, v34
  v_add_f32 v20, v20, v14
  v_add_f32 v21, v21, v14
  v_cvt_pk_bf16_f32 v34, v20, v21
  v_and_b32 v21, 0xffff0000, v34
  v_lshlrev_b32 v20, 16, v34
  v_mul_f32 v4, v20, v20
  v_fmaak_f32 v4, v4, v6, 0xc0135761
  v_mul_f32 v4, v4, v20
  v_exp_f32 v4, v4
  s_nop 0
  v_add_f32 v4, 1.0, v4
  v_rcp_f32 v4, v4
  s_nop 0
  v_mul_f32 v20, v20, v4
  v_mul_f32 v5, v21, v21
  v_fmaak_f32 v5, v5, v6, 0xc0135761
  v_mul_f32 v5, v5, v21
  v_exp_f32 v5, v5
  s_nop 0
  v_add_f32 v5, 1.0, v5
  v_rcp_f32 v5, v5
  s_nop 0
  v_mul_f32 v21, v21, v5
  v_cvt_pk_bf16_f32 v34, v20, v21
  v_cvt_pk_bf16_f32 v35, v22, v23
  v_and_b32 v23, 0xffff0000, v35
  v_lshlrev_b32 v22, 16, v35
  v_add_f32 v22, v22, v14
  v_add_f32 v23, v23, v14
  v_cvt_pk_bf16_f32 v35, v22, v23
  v_and_b32 v23, 0xffff0000, v35
  v_lshlrev_b32 v22, 16, v35
  v_mul_f32 v4, v22, v22
  v_fmaak_f32 v4, v4, v6, 0xc0135761
  v_mul_f32 v4, v4, v22
  v_exp_f32 v4, v4
  s_nop 0
  v_add_f32 v4, 1.0, v4
  v_rcp_f32 v4, v4
  s_nop 0
  v_mul_f32 v22, v22, v4
  v_mul_f32 v5, v23, v23
  v_fmaak_f32 v5, v5, v6, 0xc0135761
  v_mul_f32 v5, v5, v23
  v_exp_f32 v5, v5
  s_nop 0
  v_add_f32 v5, 1.0, v5
  v_rcp_f32 v5, v5
  s_nop 0
  v_mul_f32 v23, v23, v5
  v_cvt_pk_bf16_f32 v35, v22, v23
  v_cvt_pk_bf16_f32 v36, v24, v25
  v_and_b32 v25, 0xffff0000, v36
  v_lshlrev_b32 v24, 16, v36
  v_add_f32 v24, v24, v15
  v_add_f32 v25, v25, v15
  v_cvt_pk_bf16_f32 v36, v24, v25
  v_and_b32 v25, 0xffff0000, v36
  v_lshlrev_b32 v24, 16, v36
  v_mul_f32 v4, v24, v24
  v_fmaak_f32 v4, v4, v6, 0xc0135761
  v_mul_f32 v4, v4, v24
  v_exp_f32 v4, v4
  s_nop 0
  v_add_f32 v4, 1.0, v4
  v_rcp_f32 v4, v4
  s_nop 0
  v_mul_f32 v24, v24, v4
  v_mul_f32 v5, v25, v25
  v_fmaak_f32 v5, v5, v6, 0xc0135761
  v_mul_f32 v5, v5, v25
  v_exp_f32 v5, v5
  s_nop 0
  v_add_f32 v5, 1.0, v5
  v_rcp_f32 v5, v5
  s_nop 0
  v_mul_f32 v25, v25, v5
  v_cvt_pk_bf16_f32 v36, v24, v25
  v_cvt_pk_bf16_f32 v37, v26, v27
  v_and_b32 v27, 0xffff0000, v37
  v_lshlrev_b32 v26, 16, v37
  v_add_f32 v26, v26, v15
  v_add_f32 v27, v27, v15
  v_cvt_pk_bf16_f32 v37, v26, v27
  v_and_b32 v27, 0xffff0000, v37
  v_lshlrev_b32 v26, 16, v37
  v_mul_f32 v4, v26, v26
  v_fmaak_f32 v4, v4, v6, 0xc0135761
  v_mul_f32 v4, v4, v26
  v_exp_f32 v4, v4
  s_nop 0
  v_add_f32 v4, 1.0, v4
  v_rcp_f32 v4, v4
  s_nop 0
  v_mul_f32 v26, v26, v4
  v_mul_f32 v5, v27, v27
  v_fmaak_f32 v5, v5, v6, 0xc0135761
  v_mul_f32 v5, v5, v27
  v_exp_f32 v5, v5
  s_nop 0
  v_add_f32 v5, 1.0, v5
  v_rcp_f32 v5, v5
  s_nop 0
  v_mul_f32 v27, v27, v5
  v_cvt_pk_bf16_f32 v37, v26, v27
  v_cvt_pk_bf16_f32 v38, v28, v29
  v_and_b32 v29, 0xffff0000, v38
  v_lshlrev_b32 v28, 16, v38
  v_add_f32 v28, v28, v15
  v_add_f32 v29, v29, v15
  v_cvt_pk_bf16_f32 v38, v28, v29
  v_and_b32 v29, 0xffff0000, v38
  v_lshlrev_b32 v28, 16, v38
  v_mul_f32 v4, v28, v28
  v_fmaak_f32 v4, v4, v6, 0xc0135761
  v_mul_f32 v4, v4, v28
  v_exp_f32 v4, v4
  s_nop 0
  v_add_f32 v4, 1.0, v4
  v_rcp_f32 v4, v4
  s_nop 0
  v_mul_f32 v28, v28, v4
  v_mul_f32 v5, v29, v29
  v_fmaak_f32 v5, v5, v6, 0xc0135761
  v_mul_f32 v5, v5, v29
  v_exp_f32 v5, v5
  s_nop 0
  v_add_f32 v5, 1.0, v5
  v_rcp_f32 v5, v5
  s_nop 0
  v_mul_f32 v29, v29, v5
  v_cvt_pk_bf16_f32 v38, v28, v29
  v_cvt_pk_bf16_f32 v39, v30, v31
  v_and_b32 v31, 0xffff0000, v39
  v_lshlrev_b32 v30, 16, v39
  v_add_f32 v30, v30, v15
  v_add_f32 v31, v31, v15
  v_cvt_pk_bf16_f32 v39, v30, v31
  v_and_b32 v31, 0xffff0000, v39
  v_lshlrev_b32 v30, 16, v39
  v_mul_f32 v4, v30, v30
  v_fmaak_f32 v4, v4, v6, 0xc0135761
  v_mul_f32 v4, v4, v30
  v_exp_f32 v4, v4
  s_nop 0
  v_add_f32 v4, 1.0, v4
  v_rcp_f32 v4, v4
  s_nop 0
  v_mul_f32 v30, v30, v4
  v_mul_f32 v5, v31, v31
  v_fmaak_f32 v5, v5, v6, 0xc0135761
  v_mul_f32 v5, v5, v31
  v_exp_f32 v5, v5
  s_nop 0
  v_add_f32 v5, 1.0, v5
  v_rcp_f32 v5, v5
  s_nop 0
  v_mul_f32 v31, v31, v5
  v_cvt_pk_bf16_f32 v39, v30, v31
  v_bfe_u32 v4, v0, 0, 1
  v_lshlrev_b32 v5, 4, v4
  v_bfe_u32 v4, v0, 1, 1
  v_lshl_add_u32 v5, v4, 5, v5
  v_bfe_u32 v4, v0, 2, 1
  v_lshl_add_u32 v5, v4, 6, v5
  v_bfe_u32 v4, v0, 3, 1
  v_lshl_add_u32 v5, v4, 10, v5
  v_bfe_u32 v4, v0, 4, 1
  v_lshl_add_u32 v5, v4, 11, v5
  v_bfe_u32 v4, v0, 5, 1
  v_lshl_add_u32 v5, v4, 12, v5
  s_lshl_b32 s3, s39, 16
  s_lshl_b32 s6, s29, 14
  s_add_u32 s3, s3, s6
  s_lshl_b32 s6, s38, 7
  s_add_u32 s3, s3, s6
  s_add_u32 s3, s3, 3145728
  buffer_store_dwordx4 v[32:35], v5, s[8:11], s3 offen sc1
  s_add_u32 s3, s3, 8192
  buffer_store_dwordx4 v[36:39], v5, s[8:11], s3 offen sc1
  s_waitcnt vmcnt(0)
  s_barrier
  s_lshl_b32 s3, s31, 2
  s_add_u32 s3, s3, 598016
  s_cmp_lg_u32 s29, 0
  s_cbranch_scc1 W_pub_28
  v_mov_b32 v4, 2
  s_mov_b64 exec, 1
  buffer_store_dword v4, off, s[8:11], s3 sc1
  s_mov_b64 exec, -1
W_pub_28:
  s_mov_b32 s35, 3
C_top_29:
  s_load_dwordx2 s[12:13], s[0:1], 80
  s_mov_b32 s14, 7340032
  s_mov_b32 s15, 0x20000
  s_load_dwordx2 s[16:17], s[0:1], 88
  s_mov_b32 s18, 4096
  s_mov_b32 s19, 0x20000
  v_lshrrev_b32 v4, 4, v0
  v_lshlrev_b32 v4, 1, v4
  v_and_b32 v5, 7, v0
  v_xor_b32 v5, v5, v4
  v_lshlrev_b32 v5, 4, v5
  v_lshrrev_b32 v4, 3, v0
  v_lshl_add_u32 v6, v4, 10, v5
  v_mul_u32_u24 v4, 4096, v4
  v_add_u32 v7, v4, v5
  s_mul_i32 s36, s29, 40960
  v_bfe_u32 v4, v0, 0, 1
  v_lshlrev_b32 v5, 3, v4
  v_bfe_u32 v4, v0, 1, 1
  v_lshl_add_u32 v5, v4, 4, v5
  v_bfe_u32 v4, v0, 2, 1
  v_lshl_add_u32 v5, v4, 7, v5
  v_bfe_u32 v4, v0, 3, 1
  v_lshl_add_u32 v5, v4, 8, v5
  v_bfe_u32 v4, v0, 4, 1
  v_lshl_add_u32 v5, v4, 9, v5
  v_bfe_u32 v4, v0, 5, 1
  v_lshl_add_u32 v5, v4, 10, v5
  v_add_u32 v5, s36, v5
  v_bfe_u32 v4, v0, 3, 2
  v_xor_b32 v80, 0, v4
  v_lshl_add_u32 v80, v80, 5, v5
  v_xor_b32 v81, 1, v4
  v_lshl_add_u32 v81, v81, 5, v5
  v_xor_b32 v82, 2, v4
  v_lshl_add_u32 v82, v82, 5, v5
  v_xor_b32 v83, 3, v4
  v_lshl_add_u32 v83, v83, 5, v5
  s_mul_i32 s40, s29, 458752
  s_lshl_b32 s3, s38, 7
  s_add_u32 s40, s40, s3
  s_add_u32 s40, s40, 3145728
  s_mul_i32 s41, s29, 1835008
  s_lshl_b32 s3, s39, 7
  s_add_u32 s41, s41, s3
  s_lshl_b32 s6, s29, 5
  s_add_u32 s3, s3, s6
  v_lshrrev_b32 v4, 3, v0
  v_lshlrev_b32 v4, 1, v4
  s_waitcnt lgkmcnt(0)
  buffer_load_ushort v14, v4, s[16:19], s3 offen
  buffer_load_ushort v15, v4, s[16:19], s3 offen offset:16
  s_mul_i32 s34, s38, 0
  s_lshr_b32 s34, s34, 3
  s_mul_i32 s37, s34, 131072
  s_add_u32 s37, s37, s41
  s_add_u32 s34, s34, 1
  s_cmp_eq_u32 s34, 14
  s_cselect_b32 s34, 0, s34
  s_add_u32 m0, s36, 0
  s_add_u32 s3, s37, 0
  buffer_load_dwordx4 v7, s[12:15], s3 offen nt lds
  s_add_u32 m0, s36, 1024
  s_add_u32 s3, s37, 32768
  buffer_load_dwordx4 v7, s[12:15], s3 offen nt lds
  s_add_u32 m0, s36, 2048
  s_add_u32 s3, s37, 65536
  buffer_load_dwordx4 v7, s[12:15], s3 offen nt lds
  s_add_u32 m0, s36, 3072
  s_add_u32 s3, s37, 98304
  buffer_load_dwordx4 v7, s[12:15], s3 offen nt lds
  s_mul_i32 s37, s34, 131072
  s_add_u32 s37, s37, s41
  s_add_u32 s34, s34, 1
  s_cmp_eq_u32 s34, 14
  s_cselect_b32 s34, 0, s34
  s_add_u32 m0, s36, 4096
  s_add_u32 s3, s37, 0
  buffer_load_dwordx4 v7, s[12:15], s3 offen nt lds
  s_add_u32 m0, s36, 5120
  s_add_u32 s3, s37, 32768
  buffer_load_dwordx4 v7, s[12:15], s3 offen nt lds
  s_add_u32 m0, s36, 6144
  s_add_u32 s3, s37, 65536
  buffer_load_dwordx4 v7, s[12:15], s3 offen nt lds
  s_add_u32 m0, s36, 7168
  s_add_u32 s3, s37, 98304
  buffer_load_dwordx4 v7, s[12:15], s3 offen nt lds
  s_mul_i32 s37, s34, 131072
  s_add_u32 s37, s37, s41
  s_add_u32 s34, s34, 1
  s_cmp_eq_u32 s34, 14
  s_cselect_b32 s34, 0, s34
  s_add_u32 m0, s36, 8192
  s_add_u32 s3, s37, 0
  buffer_load_dwordx4 v7, s[12:15], s3 offen nt lds
  s_add_u32 m0, s36, 9216
  s_add_u32 s3, s37, 32768
  buffer_load_dwordx4 v7, s[12:15], s3 offen nt lds
  s_add_u32 m0, s36, 10240
  s_add_u32 s3, s37, 65536
  buffer_load_dwordx4 v7, s[12:15], s3 offen nt lds
  s_add_u32 m0, s36, 11264
  s_add_u32 s3, s37, 98304
  buffer_load_dwordx4 v7, s[12:15], s3 offen nt lds
  s_mul_i32 s37, s34, 131072
  s_add_u32 s37, s37, s41
  s_add_u32 s34, s34, 1
  s_cmp_eq_u32 s34, 14
  s_cselect_b32 s34, 0, s34
  s_add_u32 m0, s36, 12288
  s_add_u32 s3, s37, 0
  buffer_load_dwordx4 v7, s[12:15], s3 offen nt lds
  s_add_u32 m0, s36, 13312
  s_add_u32 s3, s37, 32768
  buffer_load_dwordx4 v7, s[12:15], s3 offen nt lds
  s_add_u32 m0, s36, 14336
  s_add_u32 s3, s37, 65536
  buffer_load_dwordx4 v7, s[12:15], s3 offen nt lds
  s_add_u32 m0, s36, 15360
  s_add_u32 s3, s37, 98304
  buffer_load_dwordx4 v7, s[12:15], s3 offen nt lds
  s_mul_i32 s37, s34, 131072
  s_add_u32 s37, s37, s41
  s_add_u32 s34, s34, 1
  s_cmp_eq_u32 s34, 14
  s_cselect_b32 s34, 0, s34
  s_add_u32 m0, s36, 16384
  s_add_u32 s3, s37, 0
  buffer_load_dwordx4 v7, s[12:15], s3 offen nt lds
  s_add_u32 m0, s36, 17408
  s_add_u32 s3, s37, 32768
  buffer_load_dwordx4 v7, s[12:15], s3 offen nt lds
  s_add_u32 m0, s36, 18432
  s_add_u32 s3, s37, 65536
  buffer_load_dwordx4 v7, s[12:15], s3 offen nt lds
  s_add_u32 m0, s36, 19456
  s_add_u32 s3, s37, 98304
  buffer_load_dwordx4 v7, s[12:15], s3 offen nt lds
  s_mul_i32 s37, s34, 131072
  s_add_u32 s37, s37, s41
  s_add_u32 s34, s34, 1
  s_cmp_eq_u32 s34, 14
  s_cselect_b32 s34, 0, s34
  s_add_u32 m0, s36, 20480
  s_add_u32 s3, s37, 0
  buffer_load_dwordx4 v7, s[12:15], s3 offen nt lds
  s_add_u32 m0, s36, 21504
  s_add_u32 s3, s37, 32768
  buffer_load_dwordx4 v7, s[12:15], s3 offen nt lds
  s_add_u32 m0, s36, 22528
  s_add_u32 s3, s37, 65536
  buffer_load_dwordx4 v7, s[12:15], s3 offen nt lds
  s_add_u32 m0, s36, 23552
  s_add_u32 s3, s37, 98304
  buffer_load_dwordx4 v7, s[12:15], s3 offen nt lds
  s_mul_i32 s37, s34, 131072
  s_add_u32 s37, s37, s41
  s_add_u32 s34, s34, 1
  s_cmp_eq_u32 s34, 14
  s_cselect_b32 s34, 0, s34
  s_add_u32 m0, s36, 24576
  s_add_u32 s3, s37, 0
  buffer_load_dwordx4 v7, s[12:15], s3 offen nt lds
  s_add_u32 m0, s36, 25600
  s_add_u32 s3, s37, 32768
  buffer_load_dwordx4 v7, s[12:15], s3 offen nt lds
  s_add_u32 m0, s36, 26624
  s_add_u32 s3, s37, 65536
  buffer_load_dwordx4 v7, s[12:15], s3 offen nt lds
  s_add_u32 m0, s36, 27648
  s_add_u32 s3, s37, 98304
  buffer_load_dwordx4 v7, s[12:15], s3 offen nt lds
  s_mul_i32 s37, s34, 131072
  s_add_u32 s37, s37, s41
  s_add_u32 s34, s34, 1
  s_cmp_eq_u32 s34, 14
  s_cselect_b32 s34, 0, s34
  s_add_u32 m0, s36, 28672
  s_add_u32 s3, s37, 0
  buffer_load_dwordx4 v7, s[12:15], s3 offen nt lds
  s_add_u32 m0, s36, 29696
  s_add_u32 s3, s37, 32768
  buffer_load_dwordx4 v7, s[12:15], s3 offen nt lds
  s_add_u32 m0, s36, 30720
  s_add_u32 s3, s37, 65536
  buffer_load_dwordx4 v7, s[12:15], s3 offen nt lds
  s_add_u32 m0, s36, 31744
  s_add_u32 s3, s37, 98304
  buffer_load_dwordx4 v7, s[12:15], s3 offen nt lds
  s_waitcnt vmcnt(28) lgkmcnt(7)
  ds_read_b64_tr_b16 a[0:1], v80 offset:0
  ds_read_b64_tr_b16 a[2:3], v80 offset:2048
  s_mul_i32 s37, s34, 131072
  s_add_u32 s37, s37, s41
  s_add_u32 s34, s34, 1
  s_cmp_eq_u32 s34, 14
  s_cselect_b32 s34, 0, s34
  s_add_u32 m0, s36, 32768
  s_add_u32 s3, s37, 0
  buffer_load_dwordx4 v7, s[12:15], s3 offen nt lds
  ds_read_b64_tr_b16 a[4:5], v81 offset:0
  ds_read_b64_tr_b16 a[6:7], v81 offset:2048
  s_add_u32 m0, s36, 33792
  s_add_u32 s3, s37, 32768
  buffer_load_dwordx4 v7, s[12:15], s3 offen nt lds
  ds_read_b64_tr_b16 a[8:9], v82 offset:0
  ds_read_b64_tr_b16 a[10:11], v82 offset:2048
  s_add_u32 m0, s36, 34816
  s_add_u32 s3, s37, 65536
  buffer_load_dwordx4 v7, s[12:15], s3 offen nt lds
  ds_read_b64_tr_b16 a[12:13], v83 offset:0
  ds_read_b64_tr_b16 a[14:15], v83 offset:2048
  s_add_u32 m0, s36, 35840
  s_add_u32 s3, s37, 98304
  buffer_load_dwordx4 v7, s[12:15], s3 offen nt lds
  s_waitcnt vmcnt(28) lgkmcnt(7)
  ds_read_b64_tr_b16 a[16:17], v80 offset:4096
  ds_read_b64_tr_b16 a[18:19], v80 offset:6144
  s_mul_i32 s37, s34, 131072
  s_add_u32 s37, s37, s41
  s_add_u32 s34, s34, 1
  s_cmp_eq_u32 s34, 14
  s_cselect_b32 s34, 0, s34
  s_add_u32 m0, s36, 36864
  s_add_u32 s3, s37, 0
  buffer_load_dwordx4 v7, s[12:15], s3 offen nt lds
  ds_read_b64_tr_b16 a[20:21], v81 offset:4096
  ds_read_b64_tr_b16 a[22:23], v81 offset:6144
  s_add_u32 m0, s36, 37888
  s_add_u32 s3, s37, 32768
  buffer_load_dwordx4 v7, s[12:15], s3 offen nt lds
  ds_read_b64_tr_b16 a[24:25], v82 offset:4096
  ds_read_b64_tr_b16 a[26:27], v82 offset:6144
  s_add_u32 m0, s36, 38912
  s_add_u32 s3, s37, 65536
  buffer_load_dwordx4 v7, s[12:15], s3 offen nt lds
  ds_read_b64_tr_b16 a[28:29], v83 offset:4096
  ds_read_b64_tr_b16 a[30:31], v83 offset:6144
  s_add_u32 m0, s36, 39936
  s_add_u32 s3, s37, 98304
  buffer_load_dwordx4 v7, s[12:15], s3 offen nt lds
  s_waitcnt vmcnt(28) lgkmcnt(7)
  ds_read_b64_tr_b16 a[32:33], v80 offset:8192
  ds_read_b64_tr_b16 a[34:35], v80 offset:10240
  s_mul_i32 s37, s34, 131072
  s_add_u32 s37, s37, s41
  s_add_u32 s34, s34, 1
  s_cmp_eq_u32 s34, 14
  s_cselect_b32 s34, 0, s34
  s_add_u32 m0, s36, 0
  s_add_u32 s3, s37, 0
  buffer_load_dwordx4 v7, s[12:15], s3 offen nt lds
  ds_read_b64_tr_b16 a[36:37], v81 offset:8192
  ds_read_b64_tr_b16 a[38:39], v81 offset:10240
  s_add_u32 m0, s36, 1024
  s_add_u32 s3, s37, 32768
  buffer_load_dwordx4 v7, s[12:15], s3 offen nt lds
  ds_read_b64_tr_b16 a[40:41], v82 offset:8192
  ds_read_b64_tr_b16 a[42:43], v82 offset:10240
  s_add_u32 m0, s36, 2048
  s_add_u32 s3, s37, 65536
  buffer_load_dwordx4 v7, s[12:15], s3 offen nt lds
  ds_read_b64_tr_b16 a[44:45], v83 offset:8192
  ds_read_b64_tr_b16 a[46:47], v83 offset:10240
  s_add_u32 m0, s36, 3072
  s_add_u32 s3, s37, 98304
  buffer_load_dwordx4 v7, s[12:15], s3 offen nt lds
  s_waitcnt vmcnt(28) lgkmcnt(7)
  ds_read_b64_tr_b16 a[48:49], v80 offset:12288
  ds_read_b64_tr_b16 a[50:51], v80 offset:14336
  s_mul_i32 s37, s34, 131072
  s_add_u32 s37, s37, s41
  s_add_u32 s34, s34, 1
  s_cmp_eq_u32 s34, 14
  s_cselect_b32 s34, 0, s34
  s_add_u32 m0, s36, 4096
  s_add_u32 s3, s37, 0
  buffer_load_dwordx4 v7, s[12:15], s3 offen nt lds
  ds_read_b64_tr_b16 a[52:53], v81 offset:12288
  ds_read_b64_tr_b16 a[54:55], v81 offset:14336
  s_add_u32 m0, s36, 5120
  s_add_u32 s3, s37, 32768
  buffer_load_dwordx4 v7, s[12:15], s3 offen nt lds
  ds_read_b64_tr_b16 a[56:57], v82 offset:12288
  ds_read_b64_tr_b16 a[58:59], v82 offset:14336
  s_add_u32 m0, s36, 6144
  s_add_u32 s3, s37, 65536
  buffer_load_dwordx4 v7, s[12:15], s3 offen nt lds
  ds_read_b64_tr_b16 a[60:61], v83 offset:12288
  ds_read_b64_tr_b16 a[62:63], v83 offset:14336
  s_add_u32 m0, s36, 7168
  s_add_u32 s3, s37, 98304
  buffer_load_dwordx4 v7, s[12:15], s3 offen nt lds
  s_waitcnt vmcnt(28) lgkmcnt(7)
  ds_read_b64_tr_b16 a[64:65], v80 offset:16384
  ds_read_b64_tr_b16 a[66:67], v80 offset:18432
  s_mul_i32 s37, s34, 131072
  s_add_u32 s37, s37, s41
  s_add_u32 s34, s34, 1
  s_cmp_eq_u32 s34, 14
  s_cselect_b32 s34, 0, s34
  s_add_u32 m0, s36, 8192
  s_add_u32 s3, s37, 0
  buffer_load_dwordx4 v7, s[12:15], s3 offen nt lds
  ds_read_b64_tr_b16 a[68:69], v81 offset:16384
  ds_read_b64_tr_b16 a[70:71], v81 offset:18432
  s_add_u32 m0, s36, 9216
  s_add_u32 s3, s37, 32768
  buffer_load_dwordx4 v7, s[12:15], s3 offen nt lds
  ds_read_b64_tr_b16 a[72:73], v82 offset:16384
  ds_read_b64_tr_b16 a[74:75], v82 offset:18432
  s_add_u32 m0, s36, 10240
  s_add_u32 s3, s37, 65536
  buffer_load_dwordx4 v7, s[12:15], s3 offen nt lds
  ds_read_b64_tr_b16 a[76:77], v83 offset:16384
  ds_read_b64_tr_b16 a[78:79], v83 offset:18432
  s_add_u32 m0, s36, 11264
  s_add_u32 s3, s37, 98304
  buffer_load_dwordx4 v7, s[12:15], s3 offen nt lds
  s_waitcnt vmcnt(28) lgkmcnt(7)
  ds_read_b64_tr_b16 a[80:81], v80 offset:20480
  ds_read_b64_tr_b16 a[82:83], v80 offset:22528
  s_mul_i32 s37, s34, 131072
  s_add_u32 s37, s37, s41
  s_add_u32 s34, s34, 1
  s_cmp_eq_u32 s34, 14
  s_cselect_b32 s34, 0, s34
  s_add_u32 m0, s36, 12288
  s_add_u32 s3, s37, 0
  buffer_load_dwordx4 v7, s[12:15], s3 offen nt lds
  ds_read_b64_tr_b16 a[84:85], v81 offset:20480
  ds_read_b64_tr_b16 a[86:87], v81 offset:22528
  s_add_u32 m0, s36, 13312
  s_add_u32 s3, s37, 32768
  buffer_load_dwordx4 v7, s[12:15], s3 offen nt lds
  ds_read_b64_tr_b16 a[88:89], v82 offset:20480
  ds_read_b64_tr_b16 a[90:91], v82 offset:22528
  s_add_u32 m0, s36, 14336
  s_add_u32 s3, s37, 65536
  buffer_load_dwordx4 v7, s[12:15], s3 offen nt lds
  ds_read_b64_tr_b16 a[92:93], v83 offset:20480
  ds_read_b64_tr_b16 a[94:95], v83 offset:22528
  s_add_u32 m0, s36, 15360
  s_add_u32 s3, s37, 98304
  buffer_load_dwordx4 v7, s[12:15], s3 offen nt lds
  s_waitcnt vmcnt(28) lgkmcnt(7)
  ds_read_b64_tr_b16 a[96:97], v80 offset:24576
  ds_read_b64_tr_b16 a[98:99], v80 offset:26624
  ds_read_b64_tr_b16 a[100:101], v81 offset:24576
  ds_read_b64_tr_b16 a[102:103], v81 offset:26624
  ds_read_b64_tr_b16 a[104:105], v82 offset:24576
  ds_read_b64_tr_b16 a[106:107], v82 offset:26624
  ds_read_b64_tr_b16 a[108:109], v83 offset:24576
  ds_read_b64_tr_b16 a[110:111], v83 offset:26624
  s_waitcnt vmcnt(24) lgkmcnt(7)
  ds_read_b64_tr_b16 a[112:113], v80 offset:28672
  ds_read_b64_tr_b16 a[114:115], v80 offset:30720
  ds_read_b64_tr_b16 a[116:117], v81 offset:28672
  ds_read_b64_tr_b16 a[118:119], v81 offset:30720
  ds_read_b64_tr_b16 a[120:121], v82 offset:28672
  ds_read_b64_tr_b16 a[122:123], v82 offset:30720
  ds_read_b64_tr_b16 a[124:125], v83 offset:28672
  ds_read_b64_tr_b16 a[126:127], v83 offset:30720
  s_waitcnt vmcnt(20) lgkmcnt(7)
  ds_read_b64_tr_b16 a[128:129], v80 offset:32768
  ds_read_b64_tr_b16 a[130:131], v80 offset:34816
  ds_read_b64_tr_b16 a[132:133], v81 offset:32768
  ds_read_b64_tr_b16 a[134:135], v81 offset:34816
  ds_read_b64_tr_b16 a[136:137], v82 offset:32768
  ds_read_b64_tr_b16 a[138:139], v82 offset:34816
  ds_read_b64_tr_b16 a[140:141], v83 offset:32768
  ds_read_b64_tr_b16 a[142:143], v83 offset:34816
  s_waitcnt vmcnt(16) lgkmcnt(7)
  ds_read_b64_tr_b16 a[144:145], v80 offset:36864
  ds_read_b64_tr_b16 a[146:147], v80 offset:38912
  ds_read_b64_tr_b16 a[148:149], v81 offset:36864
  ds_read_b64_tr_b16 a[150:151], v81 offset:38912
  ds_read_b64_tr_b16 a[152:153], v82 offset:36864
  ds_read_b64_tr_b16 a[154:155], v82 offset:38912
  ds_read_b64_tr_b16 a[156:157], v83 offset:36864
  ds_read_b64_tr_b16 a[158:159], v83 offset:38912
  s_waitcnt vmcnt(12) lgkmcnt(7)
  ds_read_b64_tr_b16 a[160:161], v80 offset:0
  ds_read_b64_tr_b16 a[162:163], v80 offset:2048
  ds_read_b64_tr_b16 a[164:165], v81 offset:0
  ds_read_b64_tr_b16 a[166:167], v81 offset:2048
  ds_read_b64_tr_b16 a[168:169], v82 offset:0
  ds_read_b64_tr_b16 a[170:171], v82 offset:2048
  ds_read_b64_tr_b16 a[172:173], v83 offset:0
  ds_read_b64_tr_b16 a[174:175], v83 offset:2048
  s_waitcnt vmcnt(8) lgkmcnt(7)
  ds_read_b64_tr_b16 a[176:177], v80 offset:4096
  ds_read_b64_tr_b16 a[178:179], v80 offset:6144
  ds_read_b64_tr_b16 a[180:181], v81 offset:4096
  ds_read_b64_tr_b16 a[182:183], v81 offset:6144
  ds_read_b64_tr_b16 a[184:185], v82 offset:4096
  ds_read_b64_tr_b16 a[186:187], v82 offset:6144
  ds_read_b64_tr_b16 a[188:189], v83 offset:4096
  ds_read_b64_tr_b16 a[190:191], v83 offset:6144
  s_waitcnt vmcnt(4) lgkmcnt(7)
  ds_read_b64_tr_b16 a[192:193], v80 offset:8192
  ds_read_b64_tr_b16 a[194:195], v80 offset:10240
  ds_read_b64_tr_b16 a[196:197], v81 offset:8192
  ds_read_b64_tr_b16 a[198:199], v81 offset:10240
  ds_read_b64_tr_b16 a[200:201], v82 offset:8192
  ds_read_b64_tr_b16 a[202:203], v82 offset:10240
  ds_read_b64_tr_b16 a[204:205], v83 offset:8192
  ds_read_b64_tr_b16 a[206:207], v83 offset:10240
  s_waitcnt vmcnt(0) lgkmcnt(7)
  ds_read_b64_tr_b16 a[208:209], v80 offset:12288
  ds_read_b64_tr_b16 a[210:211], v80 offset:14336
  ds_read_b64_tr_b16 a[212:213], v81 offset:12288
  ds_read_b64_tr_b16 a[214:215], v81 offset:14336
  ds_read_b64_tr_b16 a[216:217], v82 offset:12288
  ds_read_b64_tr_b16 a[218:219], v82 offset:14336
  ds_read_b64_tr_b16 a[220:221], v83 offset:12288
  ds_read_b64_tr_b16 a[222:223], v83 offset:14336
  s_waitcnt lgkmcnt(0)
  v_min_u32 v4, 6, v0
  v_lshlrev_b32 v4, 2, v4
init_30:
  buffer_load_dword v5, v4, s[52:55], 0 offen offset:132 sc1
  s_add_u32 s44, s44, 1
  s_cmp_gt_u32 s44, 400000
  s_cbranch_scc1 init_30x
  s_waitcnt vmcnt(0)
  v_cmp_gt_u32 vcc, 32, v5
  s_cbranch_vccz init_30x
  s_sleep 8
  s_branch init_30
init_30x:
  s_waitcnt vmcnt(0)
  v_min_u32 v5, 55, v0
  v_lshlrev_b32 v5, 4, v5
  v_add_u32 v5, 598016, v5
  v_cmp_le_u32 vcc, 32, v0
  s_nop 1
  v_cndmask_b32 v12, 2, 2, vcc
  v_cmp_le_u32 vcc, 48, v0
  s_nop 1
  v_cndmask_b32 v12, v12, 2, vcc
W_spin_31:
  buffer_load_dwordx4 v[8:11], v5, s[8:11], 0 offen sc1
W_spin_31h:
  s_add_u32 s44, s44, 1
  s_cmp_gt_u32 s44, 400000
  s_cbranch_scc1 W_spin_31x
  s_waitcnt vmcnt(0)
  v_min3_u32 v8, v8, v9, v10
  v_min_u32 v8, v8, v11
  v_cmp_gt_u32 vcc, v12, v8
  s_cbranch_vccz W_spin_31x
  s_sleep 8
  s_branch W_spin_31
W_spin_31x:
  s_waitcnt vmcnt(0)
  s_mul_i32 s34, s38, 0
  s_lshr_b32 s34, s34, 3
  s_mul_i32 s37, s34, 32768
  s_add_u32 s37, s37, s40
  s_add_u32 s34, s34, 1
  s_cmp_eq_u32 s34, 14
  s_cselect_b32 s34, 0, s34
  s_add_u32 m0, s36, 0
  s_add_u32 s3, s37, 0
  buffer_load_dwordx4 v6, s[8:11], s3 offen sc1 lds
  s_add_u32 m0, s36, 1024
  s_add_u32 s3, s37, 8192
  buffer_load_dwordx4 v6, s[8:11], s3 offen sc1 lds
  s_add_u32 m0, s36, 2048
  s_add_u32 s3, s37, 16384
  buffer_load_dwordx4 v6, s[8:11], s3 offen sc1 lds
  s_add_u32 m0, s36, 3072
  s_add_u32 s3, s37, 24576
  buffer_load_dwordx4 v6, s[8:11], s3 offen sc1 lds
  s_mul_i32 s37, s34, 32768
  s_add_u32 s37, s37, s40
  s_add_u32 s34, s34, 1
  s_cmp_eq_u32 s34, 14
  s_cselect_b32 s34, 0, s34
  s_add_u32 m0, s36, 4096
  s_add_u32 s3, s37, 0
  buffer_load_dwordx4 v6, s[8:11], s3 offen sc1 lds
  s_add_u32 m0, s36, 5120
  s_add_u32 s3, s37, 8192
  buffer_load_dwordx4 v6, s[8:11], s3 offen sc1 lds
  s_add_u32 m0, s36, 6144
  s_add_u32 s3, s37, 16384
  buffer_load_dwordx4 v6, s[8:11], s3 offen sc1 lds
  s_add_u32 m0, s36, 7168
  s_add_u32 s3, s37, 24576
  buffer_load_dwordx4 v6, s[8:11], s3 offen sc1 lds
  s_mul_i32 s37, s34, 32768
  s_add_u32 s37, s37, s40
  s_add_u32 s34, s34, 1
  s_cmp_eq_u32 s34, 14
  s_cselect_b32 s34, 0, s34
  s_add_u32 m0, s36, 8192
  s_add_u32 s3, s37, 0
  buffer_load_dwordx4 v6, s[8:11], s3 offen sc1 lds
  s_add_u32 m0, s36, 9216
  s_add_u32 s3, s37, 8192
  buffer_load_dwordx4 v6, s[8:11], s3 offen sc1 lds
  s_add_u32 m0, s36, 10240
  s_add_u32 s3, s37, 16384
  buffer_load_dwordx4 v6, s[8:11], s3 offen sc1 lds
  s_add_u32 m0, s36, 11264
  s_add_u32 s3, s37, 24576
  buffer_load_dwordx4 v6, s[8:11], s3 offen sc1 lds
  s_mul_i32 s37, s34, 32768
  s_add_u32 s37, s37, s40
  s_add_u32 s34, s34, 1
  s_cmp_eq_u32 s34, 14
  s_cselect_b32 s34, 0, s34
  s_add_u32 m0, s36, 12288
  s_add_u32 s3, s37, 0
  buffer_load_dwordx4 v6, s[8:11], s3 offen sc1 lds
  s_add_u32 m0, s36, 13312
  s_add_u32 s3, s37, 8192
  buffer_load_dwordx4 v6, s[8:11], s3 offen sc1 lds
  s_add_u32 m0, s36, 14336
  s_add_u32 s3, s37, 16384
  buffer_load_dwordx4 v6, s[8:11], s3 offen sc1 lds
  s_add_u32 m0, s36, 15360
  s_add_u32 s3, s37, 24576
  buffer_load_dwordx4 v6, s[8:11], s3 offen sc1 lds
  s_mul_i32 s37, s34, 32768
  s_add_u32 s37, s37, s40
  s_add_u32 s34, s34, 1
  s_cmp_eq_u32 s34, 14
  s_cselect_b32 s34, 0, s34
  s_add_u32 m0, s36, 16384
  s_add_u32 s3, s37, 0
  buffer_load_dwordx4 v6, s[8:11], s3 offen sc1 lds
  s_add_u32 m0, s36, 17408
  s_add_u32 s3, s37, 8192
  buffer_load_dwordx4 v6, s[8:11], s3 offen sc1 lds
  s_add_u32 m0, s36, 18432
  s_add_u32 s3, s37, 16384
  buffer_load_dwordx4 v6, s[8:11], s3 offen sc1 lds
  s_add_u32 m0, s36, 19456
  s_add_u32 s3, s37, 24576
  buffer_load_dwordx4 v6, s[8:11], s3 offen sc1 lds
  s_mul_i32 s37, s34, 32768
  s_add_u32 s37, s37, s40
  s_add_u32 s34, s34, 1
  s_cmp_eq_u32 s34, 14
  s_cselect_b32 s34, 0, s34
  s_add_u32 m0, s36, 20480
  s_add_u32 s3, s37, 0
  buffer_load_dwordx4 v6, s[8:11], s3 offen sc1 lds
  s_add_u32 m0, s36, 21504
  s_add_u32 s3, s37, 8192
  buffer_load_dwordx4 v6, s[8:11], s3 offen sc1 lds
  s_add_u32 m0, s36, 22528
  s_add_u32 s3, s37, 16384
  buffer_load_dwordx4 v6, s[8:11], s3 offen sc1 lds
  s_add_u32 m0, s36, 23552
  s_add_u32 s3, s37, 24576
  buffer_load_dwordx4 v6, s[8:11], s3 offen sc1 lds
  s_mul_i32 s37, s34, 32768
  s_add_u32 s37, s37, s40
  s_add_u32 s34, s34, 1
  s_cmp_eq_u32 s34, 14
  s_cselect_b32 s34, 0, s34
  s_add_u32 m0, s36, 24576
  s_add_u32 s3, s37, 0
  buffer_load_dwordx4 v6, s[8:11], s3 offen sc1 lds
  s_add_u32 m0, s36, 25600
  s_add_u32 s3, s37, 8192
  buffer_load_dwordx4 v6, s[8:11], s3 offen sc1 lds
  s_add_u32 m0, s36, 26624
  s_add_u32 s3, s37, 16384
  buffer_load_dwordx4 v6, s[8:11], s3 offen sc1 lds
  s_add_u32 m0, s36, 27648
  s_add_u32 s3, s37, 24576
  buffer_load_dwordx4 v6, s[8:11], s3 offen sc1 lds
  s_mul_i32 s37, s34, 32768
  s_add_u32 s37, s37, s40
  s_add_u32 s34, s34, 1
  s_cmp_eq_u32 s34, 14
  s_cselect_b32 s34, 0, s34
  s_add_u32 m0, s36, 28672
  s_add_u32 s3, s37, 0
  buffer_load_dwordx4 v6, s[8:11], s3 offen sc1 lds
  s_add_u32 m0, s36, 29696
  s_add_u32 s3, s37, 8192
  buffer_load_dwordx4 v6, s[8:11], s3 offen sc1 lds
  s_add_u32 m0, s36, 30720
  s_add_u32 s3, s37, 16384
  buffer_load_dwordx4 v6, s[8:11], s3 offen sc1 lds
  s_add_u32 m0, s36, 31744
  s_add_u32 s3, s37, 24576
  buffer_load_dwordx4 v6, s[8:11], s3 offen sc1 lds
  s_waitcnt vmcnt(28)
  ds_read_b64_tr_b16 v[16:17], v80 offset:0
  ds_read_b64_tr_b16 v[18:19], v80 offset:2048
  ds_read_b64_tr_b16 v[20:21], v81 offset:0
  ds_read_b64_tr_b16 v[22:23], v81 offset:2048
  ds_read_b64_tr_b16 v[24:25], v82 offset:0
  ds_read_b64_tr_b16 v[26:27], v82 offset:2048
  ds_read_b64_tr_b16 v[28:29], v83 offset:0
  ds_read_b64_tr_b16 v[30:31], v83 offset:2048
  s_waitcnt lgkmcnt(0) vmcnt(24)
  v_mfma_f32_16x16x32_bf16 v[128:131], v[16:19], a[0:3], 0
  ds_read_b64_tr_b16 v[32:33], v80 offset:4096
  v_mfma_f32_16x16x32_bf16 v[144:147], v[16:19], a[4:7], 0
  ds_read_b64_tr_b16 v[34:35], v80 offset:6144
  v_mfma_f32_16x16x32_bf16 v[160:163], v[16:19], a[8:11], 0
  ds_read_b64_tr_b16 v[36:37], v81 offset:4096
  v_mfma_f32_16x16x32_bf16 v[176:179], v[16:19], a[12:15], 0
  ds_read_b64_tr_b16 v[38:39], v81 offset:6144
  v_mfma_f32_16x16x32_bf16 v[132:135], v[20:23], a[0:3], 0
  ds_read_b64_tr_b16 v[40:41], v82 offset:4096
  v_mfma_f32_16x16x32_bf16 v[148:151], v[20:23], a[4:7], 0
  ds_read_b64_tr_b16 v[42:43], v82 offset:6144
  v_mfma_f32_16x16x32_bf16 v[164:167], v[20:23], a[8:11], 0
  ds_read_b64_tr_b16 v[44:45], v83 offset:4096
  v_mfma_f32_16x16x32_bf16 v[180:183], v[20:23], a[12:15], 0
  ds_read_b64_tr_b16 v[46:47], v83 offset:6144
  v_mfma_f32_16x16x32_bf16 v[136:139], v[24:27], a[0:3], 0
  v_mfma_f32_16x16x32_bf16 v[152:155], v[24:27], a[4:7], 0
  s_mul_i32 s37, s34, 32768
  s_add_u32 s37, s37, s40
  s_add_u32 s34, s34, 1
  s_cmp_eq_u32 s34, 14
  s_cselect_b32 s34, 0, s34
  s_add_u32 m0, s36, 32768
  s_add_u32 s3, s37, 0
  buffer_load_dwordx4 v6, s[8:11], s3 offen sc1 lds
  v_mfma_f32_16x16x32_bf16 v[168:171], v[24:27], a[8:11], 0
  v_mfma_f32_16x16x32_bf16 v[184:187], v[24:27], a[12:15], 0
  s_add_u32 m0, s36, 33792
  s_add_u32 s3, s37, 8192
  buffer_load_dwordx4 v6, s[8:11], s3 offen sc1 lds
  v_mfma_f32_16x16x32_bf16 v[140:143], v[28:31], a[0:3], 0
  v_mfma_f32_16x16x32_bf16 v[156:159], v[28:31], a[4:7], 0
  s_add_u32 m0, s36, 34816
  s_add_u32 s3, s37, 16384
  buffer_load_dwordx4 v6, s[8:11], s3 offen sc1 lds
  v_mfma_f32_16x16x32_bf16 v[172:175], v[28:31], a[8:11], 0
  v_mfma_f32_16x16x32_bf16 v[188:191], v[28:31], a[12:15], 0
  s_add_u32 m0, s36, 35840
  s_add_u32 s3, s37, 24576
  buffer_load_dwordx4 v6, s[8:11], s3 offen sc1 lds
  s_waitcnt lgkmcnt(0) vmcnt(24)
  v_mfma_f32_16x16x32_bf16 v[128:131], v[32:35], a[16:19], v[128:131]
  ds_read_b64_tr_b16 v[16:17], v80 offset:8192
  v_mfma_f32_16x16x32_bf16 v[144:147], v[32:35], a[20:23], v[144:147]
  ds_read_b64_tr_b16 v[18:19], v80 offset:10240
  v_mfma_f32_16x16x32_bf16 v[160:163], v[32:35], a[24:27], v[160:163]
  ds_read_b64_tr_b16 v[20:21], v81 offset:8192
  v_mfma_f32_16x16x32_bf16 v[176:179], v[32:35], a[28:31], v[176:179]
  ds_read_b64_tr_b16 v[22:23], v81 offset:10240
  v_mfma_f32_16x16x32_bf16 v[132:135], v[36:39], a[16:19], v[132:135]
  ds_read_b64_tr_b16 v[24:25], v82 offset:8192
  v_mfma_f32_16x16x32_bf16 v[148:151], v[36:39], a[20:23], v[148:151]
  ds_read_b64_tr_b16 v[26:27], v82 offset:10240
  v_mfma_f32_16x16x32_bf16 v[164:167], v[36:39], a[24:27], v[164:167]
  ds_read_b64_tr_b16 v[28:29], v83 offset:8192
  v_mfma_f32_16x16x32_bf16 v[180:183], v[36:39], a[28:31], v[180:183]
  ds_read_b64_tr_b16 v[30:31], v83 offset:10240
  v_mfma_f32_16x16x32_bf16 v[136:139], v[40:43], a[16:19], v[136:139]
  v_mfma_f32_16x16x32_bf16 v[152:155], v[40:43], a[20:23], v[152:155]
  s_mul_i32 s37, s34, 32768
  s_add_u32 s37, s37, s40
  s_add_u32 s34, s34, 1
  s_cmp_eq_u32 s34, 14
  s_cselect_b32 s34, 0, s34
  s_add_u32 m0, s36, 36864
  s_add_u32 s3, s37, 0
  buffer_load_dwordx4 v6, s[8:11], s3 offen sc1 lds
  v_mfma_f32_16x16x32_bf16 v[168:171], v[40:43], a[24:27], v[168:171]
  v_mfma_f32_16x16x32_bf16 v[184:187], v[40:43], a[28:31], v[184:187]
  s_add_u32 m0, s36, 37888
  s_add_u32 s3, s37, 8192
  buffer_load_dwordx4 v6, s[8:11], s3 offen sc1 lds
  v_mfma_f32_16x16x32_bf16 v[140:143], v[44:47], a[16:19], v[140:143]
  v_mfma_f32_16x16x32_bf16 v[156:159], v[44:47], a[20:23], v[156:159]
  s_add_u32 m0, s36, 38912
  s_add_u32 s3, s37, 16384
  buffer_load_dwordx4 v6, s[8:11], s3 offen sc1 lds
  v_mfma_f32_16x16x32_bf16 v[172:175], v[44:47], a[24:27], v[172:175]
  v_mfma_f32_16x16x32_bf16 v[188:191], v[44:47], a[28:31], v[188:191]
  s_add_u32 m0, s36, 39936
  s_add_u32 s3, s37, 24576
  buffer_load_dwordx4 v6, s[8:11], s3 offen sc1 lds
  s_waitcnt lgkmcnt(0) vmcnt(24)
  v_mfma_f32_16x16x32_bf16 v[128:131], v[16:19], a[32:35], v[128:131]
  ds_read_b64_tr_b16 v[32:33], v80 offset:12288
  v_mfma_f32_16x16x32_bf16 v[144:147], v[16:19], a[36:39], v[144:147]
  ds_read_b64_tr_b16 v[34:35], v80 offset:14336
  v_mfma_f32_16x16x32_bf16 v[160:163], v[16:19], a[40:43], v[160:163]
  ds_read_b64_tr_b16 v[36:37], v81 offset:12288
  v_mfma_f32_16x16x32_bf16 v[176:179], v[16:19], a[44:47], v[176:179]
  ds_read_b64_tr_b16 v[38:39], v81 offset:14336
  v_mfma_f32_16x16x32_bf16 v[132:135], v[20:23], a[32:35], v[132:135]
  ds_read_b64_tr_b16 v[40:41], v82 offset:12288
  v_mfma_f32_16x16x32_bf16 v[148:151], v[20:23], a[36:39], v[148:151]
  ds_read_b64_tr_b16 v[42:43], v82 offset:14336
  v_mfma_f32_16x16x32_bf16 v[164:167], v[20:23], a[40:43], v[164:167]
  ds_read_b64_tr_b16 v[44:45], v83 offset:12288
  v_mfma_f32_16x16x32_bf16 v[180:183], v[20:23], a[44:47], v[180:183]
  ds_read_b64_tr_b16 v[46:47], v83 offset:14336
  v_mfma_f32_16x16x32_bf16 v[136:139], v[24:27], a[32:35], v[136:139]
  v_mfma_f32_16x16x32_bf16 v[152:155], v[24:27], a[36:39], v[152:155]
  s_mul_i32 s37, s34, 32768
  s_add_u32 s37, s37, s40
  s_add_u32 s34, s34, 1
  s_cmp_eq_u32 s34, 14
  s_cselect_b32 s34, 0, s34
  s_add_u32 m0, s36, 0
  s_add_u32 s3, s37, 0
  buffer_load_dwordx4 v6, s[8:11], s3 offen sc1 lds
  v_mfma_f32_16x16x32_bf16 v[168:171], v[24:27], a[40:43], v[168:171]
  v_mfma_f32_16x16x32_bf16 v[184:187], v[24:27], a[44:47], v[184:187]
  s_add_u32 m0, s36, 1024
  s_add_u32 s3, s37, 8192
  buffer_load_dwordx4 v6, s[8:11], s3 offen sc1 lds
  v_mfma_f32_16x16x32_bf16 v[140:143], v[28:31], a[32:35], v[140:143]
  v_mfma_f32_16x16x32_bf16 v[156:159], v[28:31], a[36:39], v[156:159]
  s_add_u32 m0, s36, 2048
  s_add_u32 s3, s37, 16384
  buffer_load_dwordx4 v6, s[8:11], s3 offen sc1 lds
  v_mfma_f32_16x16x32_bf16 v[172:175], v[28:31], a[40:43], v[172:175]
  v_mfma_f32_16x16x32_bf16 v[188:191], v[28:31], a[44:47], v[188:191]
  s_add_u32 m0, s36, 3072
  s_add_u32 s3, s37, 24576
  buffer_load_dwordx4 v6, s[8:11], s3 offen sc1 lds
  s_waitcnt lgkmcnt(0) vmcnt(24)
  v_mfma_f32_16x16x32_bf16 v[128:131], v[32:35], a[48:51], v[128:131]
  ds_read_b64_tr_b16 v[16:17], v80 offset:16384
  v_mfma_f32_16x16x32_bf16 v[144:147], v[32:35], a[52:55], v[144:147]
  ds_read_b64_tr_b16 v[18:19], v80 offset:18432
  v_mfma_f32_16x16x32_bf16 v[160:163], v[32:35], a[56:59], v[160:163]
  ds_read_b64_tr_b16 v[20:21], v81 offset:16384
  v_mfma_f32_16x16x32_bf16 v[176:179], v[32:35], a[60:63], v[176:179]
  ds_read_b64_tr_b16 v[22:23], v81 offset:18432
  v_mfma_f32_16x16x32_bf16 v[132:135], v[36:39], a[48:51], v[132:135]
  ds_read_b64_tr_b16 v[24:25], v82 offset:16384
  v_mfma_f32_16x16x32_bf16 v[148:151], v[36:39], a[52:55], v[148:151]
  ds_read_b64_tr_b16 v[26:27], v82 offset:18432
  v_mfma_f32_16x16x32_bf16 v[164:167], v[36:39], a[56:59], v[164:167]
  ds_read_b64_tr_b16 v[28:29], v83 offset:16384
  v_mfma_f32_16x16x32_bf16 v[180:183], v[36:39], a[60:63], v[180:183]
  ds_read_b64_tr_b16 v[30:31], v83 offset:18432
  v_mfma_f32_16x16x32_bf16 v[136:139], v[40:43], a[48:51], v[136:139]
  v_mfma_f32_16x16x32_bf16 v[152:155], v[40:43], a[52:55], v[152:155]
  s_mul_i32 s37, s34, 32768
  s_add_u32 s37, s37, s40
  s_add_u32 s34, s34, 1
  s_cmp_eq_u32 s34, 14
  s_cselect_b32 s34, 0, s34
  s_add_u32 m0, s36, 4096
  s_add_u32 s3, s37, 0
  buffer_load_dwordx4 v6, s[8:11], s3 offen sc1 lds
  v_mfma_f32_16x16x32_bf16 v[168:171], v[40:43], a[56:59], v[168:171]
  v_mfma_f32_16x16x32_bf16 v[184:187], v[40:43], a[60:63], v[184:187]
  s_add_u32 m0, s36, 5120
  s_add_u32 s3, s37, 8192
  buffer_load_dwordx4 v6, s[8:11], s3 offen sc1 lds
  v_mfma_f32_16x16x32_bf16 v[140:143], v[44:47], a[48:51], v[140:143]
  v_mfma_f32_16x16x32_bf16 v[156:159], v[44:47], a[52:55], v[156:159]
  s_add_u32 m0, s36, 6144
  s_add_u32 s3, s37, 16384
  buffer_load_dwordx4 v6, s[8:11], s3 offen sc1 lds
  v_mfma_f32_16x16x32_bf16 v[172:175], v[44:47], a[56:59], v[172:175]
  v_mfma_f32_16x16x32_bf16 v[188:191], v[44:47], a[60:63], v[188:191]
  s_add_u32 m0, s36, 7168
  s_add_u32 s3, s37, 24576
  buffer_load_dwordx4 v6, s[8:11], s3 offen sc1 lds
  s_waitcnt lgkmcnt(0) vmcnt(24)
  v_mfma_f32_16x16x32_bf16 v[128:131], v[16:19], a[64:67], v[128:131]
  ds_read_b64_tr_b16 v[32:33], v80 offset:20480
  v_mfma_f32_16x16x32_bf16 v[144:147], v[16:19], a[68:71], v[144:147]
  ds_read_b64_tr_b16 v[34:35], v80 offset:22528
  v_mfma_f32_16x16x32_bf16 v[160:163], v[16:19], a[72:75], v[160:163]
  ds_read_b64_tr_b16 v[36:37], v81 offset:20480
  v_mfma_f32_16x16x32_bf16 v[176:179], v[16:19], a[76:79], v[176:179]
  ds_read_b64_tr_b16 v[38:39], v81 offset:22528
  v_mfma_f32_16x16x32_bf16 v[132:135], v[20:23], a[64:67], v[132:135]
  ds_read_b64_tr_b16 v[40:41], v82 offset:20480
  v_mfma_f32_16x16x32_bf16 v[148:151], v[20:23], a[68:71], v[148:151]
  ds_read_b64_tr_b16 v[42:43], v82 offset:22528
  v_mfma_f32_16x16x32_bf16 v[164:167], v[20:23], a[72:75], v[164:167]
  ds_read_b64_tr_b16 v[44:45], v83 offset:20480
  v_mfma_f32_16x16x32_bf16 v[180:183], v[20:23], a[76:79], v[180:183]
  ds_read_b64_tr_b16 v[46:47], v83 offset:22528
  v_mfma_f32_16x16x32_bf16 v[136:139], v[24:27], a[64:67], v[136:139]
  v_mfma_f32_16x16x32_bf16 v[152:155], v[24:27], a[68:71], v[152:155]
  s_mul_i32 s37, s34, 32768
  s_add_u32 s37, s37, s40
  s_add_u32 s34, s34, 1
  s_cmp_eq_u32 s34, 14
  s_cselect_b32 s34, 0, s34
  s_add_u32 m0, s36, 8192
  s_add_u32 s3, s37, 0
  buffer_load_dwordx4 v6, s[8:11], s3 offen sc1 lds
  v_mfma_f32_16x16x32_bf16 v[168:171], v[24:27], a[72:75], v[168:171]
  v_mfma_f32_16x16x32_bf16 v[184:187], v[24:27], a[76:79], v[184:187]
  s_add_u32 m0, s36, 9216
  s_add_u32 s3, s37, 8192
  buffer_load_dwordx4 v6, s[8:11], s3 offen sc1 lds
  v_mfma_f32_16x16x32_bf16 v[140:143], v[28:31], a[64:67], v[140:143]
  v_mfma_f32_16x16x32_bf16 v[156:159], v[28:31], a[68:71], v[156:159]
  s_add_u32 m0, s36, 10240
  s_add_u32 s3, s37, 16384
  buffer_load_dwordx4 v6, s[8:11], s3 offen sc1 lds
  v_mfma_f32_16x16x32_bf16 v[172:175], v[28:31], a[72:75], v[172:175]
  v_mfma_f32_16x16x32_bf16 v[188:191], v[28:31], a[76:79], v[188:191]
  s_add_u32 m0, s36, 11264
  s_add_u32 s3, s37, 24576
  buffer_load_dwordx4 v6, s[8:11], s3 offen sc1 lds
  s_waitcnt lgkmcnt(0) vmcnt(24)
  v_mfma_f32_16x16x32_bf16 v[128:131], v[32:35], a[80:83], v[128:131]
  ds_read_b64_tr_b16 v[16:17], v80 offset:24576
  v_mfma_f32_16x16x32_bf16 v[144:147], v[32:35], a[84:87], v[144:147]
  ds_read_b64_tr_b16 v[18:19], v80 offset:26624
  v_mfma_f32_16x16x32_bf16 v[160:163], v[32:35], a[88:91], v[160:163]
  ds_read_b64_tr_b16 v[20:21], v81 offset:24576
  v_mfma_f32_16x16x32_bf16 v[176:179], v[32:35], a[92:95], v[176:179]
  ds_read_b64_tr_b16 v[22:23], v81 offset:26624
  v_mfma_f32_16x16x32_bf16 v[132:135], v[36:39], a[80:83], v[132:135]
  ds_read_b64_tr_b16 v[24:25], v82 offset:24576
  v_mfma_f32_16x16x32_bf16 v[148:151], v[36:39], a[84:87], v[148:151]
  ds_read_b64_tr_b16 v[26:27], v82 offset:26624
  v_mfma_f32_16x16x32_bf16 v[164:167], v[36:39], a[88:91], v[164:167]
  ds_read_b64_tr_b16 v[28:29], v83 offset:24576
  v_mfma_f32_16x16x32_bf16 v[180:183], v[36:39], a[92:95], v[180:183]
  ds_read_b64_tr_b16 v[30:31], v83 offset:26624
  v_mfma_f32_16x16x32_bf16 v[136:139], v[40:43], a[80:83], v[136:139]
  v_mfma_f32_16x16x32_bf16 v[152:155], v[40:43], a[84:87], v[152:155]
  s_mul_i32 s37, s34, 32768
  s_add_u32 s37, s37, s40
  s_add_u32 s34, s34, 1
  s_cmp_eq_u32 s34, 14
  s_cselect_b32 s34, 0, s34
  s_add_u32 m0, s36, 12288
  s_add_u32 s3, s37, 0
  buffer_load_dwordx4 v6, s[8:11], s3 offen sc1 lds
  v_mfma_f32_16x16x32_bf16 v[168:171], v[40:43], a[88:91], v[168:171]
  v_mfma_f32_16x16x32_bf16 v[184:187], v[40:43], a[92:95], v[184:187]
  s_add_u32 m0, s36, 13312
  s_add_u32 s3, s37, 8192
  buffer_load_dwordx4 v6, s[8:11], s3 offen sc1 lds
  v_mfma_f32_16x16x32_bf16 v[140:143], v[44:47], a[80:83], v[140:143]
  v_mfma_f32_16x16x32_bf16 v[156:159], v[44:47], a[84:87], v[156:159]
  s_add_u32 m0, s36, 14336
  s_add_u32 s3, s37, 16384
  buffer_load_dwordx4 v6, s[8:11], s3 offen sc1 lds
  v_mfma_f32_16x16x32_bf16 v[172:175], v[44:47], a[88:91], v[172:175]
  v_mfma_f32_16x16x32_bf16 v[188:191], v[44:47], a[92:95], v[188:191]
  s_add_u32 m0, s36, 15360
  s_add_u32 s3, s37, 24576
  buffer_load_dwordx4 v6, s[8:11], s3 offen sc1 lds
  s_waitcnt lgkmcnt(0) vmcnt(24)
  v_mfma_f32_16x16x32_bf16 v[128:131], v[16:19], a[96:99], v[128:131]
  ds_read_b64_tr_b16 v[32:33], v80 offset:28672
  v_mfma_f32_16x16x32_bf16 v[144:147], v[16:19], a[100:103], v[144:147]
  ds_read_b64_tr_b16 v[34:35], v80 offset:30720
  v_mfma_f32_16x16x32_bf16 v[160:163], v[16:19], a[104:107], v[160:163]
  ds_read_b64_tr_b16 v[36:37], v81 offset:28672
  v_mfma_f32_16x16x32_bf16 v[176:179], v[16:19], a[108:111], v[176:179]
  ds_read_b64_tr_b16 v[38:39], v81 offset:30720
  v_mfma_f32_16x16x32_bf16 v[132:135], v[20:23], a[96:99], v[132:135]
  ds_read_b64_tr_b16 v[40:41], v82 offset:28672
  v_mfma_f32_16x16x32_bf16 v[148:151], v[20:23], a[100:103], v[148:151]
  ds_read_b64_tr_b16 v[42:43], v82 offset:30720
  v_mfma_f32_16x16x32_bf16 v[164:167], v[20:23], a[104:107], v[164:167]
  ds_read_b64_tr_b16 v[44:45], v83 offset:28672
  v_mfma_f32_16x16x32_bf16 v[180:183], v[20:23], a[108:111], v[180:183]
  ds_read_b64_tr_b16 v[46:47], v83 offset:30720
  v_mfma_f32_16x16x32_bf16 v[136:139], v[24:27], a[96:99], v[136:139]
  v_mfma_f32_16x16x32_bf16 v[152:155], v[24:27], a[100:103], v[152:155]
  v_mfma_f32_16x16x32_bf16 v[168:171], v[24:27], a[104:107], v[168:171]
  v_mfma_f32_16x16x32_bf16 v[184:187], v[24:27], a[108:111], v[184:187]
  v_mfma_f32_16x16x32_bf16 v[140:143], v[28:31], a[96:99], v[140:143]
  v_mfma_f32_16x16x32_bf16 v[156:159], v[28:31], a[100:103], v[156:159]
  v_mfma_f32_16x16x32_bf16 v[172:175], v[28:31], a[104:107], v[172:175]
  v_mfma_f32_16x16x32_bf16 v[188:191], v[28:31], a[108:111], v[188:191]
  s_waitcnt lgkmcnt(0) vmcnt(20)
  v_mfma_f32_16x16x32_bf16 v[128:131], v[32:35], a[112:115], v[128:131]
  ds_read_b64_tr_b16 v[16:17], v80 offset:32768
  v_mfma_f32_16x16x32_bf16 v[144:147], v[32:35], a[116:119], v[144:147]
  ds_read_b64_tr_b16 v[18:19], v80 offset:34816
  v_mfma_f32_16x16x32_bf16 v[160:163], v[32:35], a[120:123], v[160:163]
  ds_read_b64_tr_b16 v[20:21], v81 offset:32768
  v_mfma_f32_16x16x32_bf16 v[176:179], v[32:35], a[124:127], v[176:179]
  ds_read_b64_tr_b16 v[22:23], v81 offset:34816
  v_mfma_f32_16x16x32_bf16 v[132:135], v[36:39], a[112:115], v[132:135]
  ds_read_b64_tr_b16 v[24:25], v82 offset:32768
  v_mfma_f32_16x16x32_bf16 v[148:151], v[36:39], a[116:119], v[148:151]
  ds_read_b64_tr_b16 v[26:27], v82 offset:34816
  v_mfma_f32_16x16x32_bf16 v[164:167], v[36:39], a[120:123], v[164:167]
  ds_read_b64_tr_b16 v[28:29], v83 offset:32768
  v_mfma_f32_16x16x32_bf16 v[180:183], v[36:39], a[124:127], v[180:183]
  ds_read_b64_tr_b16 v[30:31], v83 offset:34816
  v_mfma_f32_16x16x32_bf16 v[136:139], v[40:43], a[112:115], v[136:139]
  v_mfma_f32_16x16x32_bf16 v[152:155], v[40:43], a[116:119], v[152:155]
  v_mfma_f32_16x16x32_bf16 v[168:171], v[40:43], a[120:123], v[168:171]
  v_mfma_f32_16x16x32_bf16 v[184:187], v[40:43], a[124:127], v[184:187]
  v_mfma_f32_16x16x32_bf16 v[140:143], v[44:47], a[112:115], v[140:143]
  v_mfma_f32_16x16x32_bf16 v[156:159], v[44:47], a[116:119], v[156:159]
  v_mfma_f32_16x16x32_bf16 v[172:175], v[44:47], a[120:123], v[172:175]
  v_mfma_f32_16x16x32_bf16 v[188:191], v[44:47], a[124:127], v[188:191]
  s_waitcnt lgkmcnt(0) vmcnt(16)
  v_mfma_f32_16x16x32_bf16 v[128:131], v[16:19], a[128:131], v[128:131]
  ds_read_b64_tr_b16 v[32:33], v80 offset:36864
  v_mfma_f32_16x16x32_bf16 v[144:147], v[16:19], a[132:135], v[144:147]
  ds_read_b64_tr_b16 v[34:35], v80 offset:38912
  v_mfma_f32_16x16x32_bf16 v[160:163], v[16:19], a[136:139], v[160:163]
  ds_read_b64_tr_b16 v[36:37], v81 offset:36864
  v_mfma_f32_16x16x32_bf16 v[176:179], v[16:19], a[140:143], v[176:179]
  ds_read_b64_tr_b16 v[38:39], v81 offset:38912
  v_mfma_f32_16x16x32_bf16 v[132:135], v[20:23], a[128:131], v[132:135]
  ds_read_b64_tr_b16 v[40:41], v82 offset:36864
  v_mfma_f32_16x16x32_bf16 v[148:151], v[20:23], a[132:135], v[148:151]
  ds_read_b64_tr_b16 v[42:43], v82 offset:38912
  v_mfma_f32_16x16x32_bf16 v[164:167], v[20:23], a[136:139], v[164:167]
  ds_read_b64_tr_b16 v[44:45], v83 offset:36864
  v_mfma_f32_16x16x32_bf16 v[180:183], v[20:23], a[140:143], v[180:183]
  ds_read_b64_tr_b16 v[46:47], v83 offset:38912
  v_mfma_f32_16x16x32_bf16 v[136:139], v[24:27], a[128:131], v[136:139]
  v_mfma_f32_16x16x32_bf16 v[152:155], v[24:27], a[132:135], v[152:155]
  v_mfma_f32_16x16x32_bf16 v[168:171], v[24:27], a[136:139], v[168:171]
  v_mfma_f32_16x16x32_bf16 v[184:187], v[24:27], a[140:143], v[184:187]
  v_mfma_f32_16x16x32_bf16 v[140:143], v[28:31], a[128:131], v[140:143]
  v_mfma_f32_16x16x32_bf16 v[156:159], v[28:31], a[132:135], v[156:159]
  v_mfma_f32_16x16x32_bf16 v[172:175], v[28:31], a[136:139], v[172:175]
  v_mfma_f32_16x16x32_bf16 v[188:191], v[28:31], a[140:143], v[188:191]
  s_waitcnt lgkmcnt(0) vmcnt(12)
  v_mfma_f32_16x16x32_bf16 v[128:131], v[32:35], a[144:147], v[128:131]
  ds_read_b64_tr_b16 v[16:17], v80 offset:0
  v_mfma_f32_16x16x32_bf16 v[144:147], v[32:35], a[148:151], v[144:147]
  ds_read_b64_tr_b16 v[18:19], v80 offset:2048
  v_mfma_f32_16x16x32_bf16 v[160:163], v[32:35], a[152:155], v[160:163]
  ds_read_b64_tr_b16 v[20:21], v81 offset:0
  v_mfma_f32_16x16x32_bf16 v[176:179], v[32:35], a[156:159], v[176:179]
  ds_read_b64_tr_b16 v[22:23], v81 offset:2048
  v_mfma_f32_16x16x32_bf16 v[132:135], v[36:39], a[144:147], v[132:135]
  ds_read_b64_tr_b16 v[24:25], v82 offset:0
  v_mfma_f32_16x16x32_bf16 v[148:151], v[36:39], a[148:151], v[148:151]
  ds_read_b64_tr_b16 v[26:27], v82 offset:2048
  v_mfma_f32_16x16x32_bf16 v[164:167], v[36:39], a[152:155], v[164:167]
  ds_read_b64_tr_b16 v[28:29], v83 offset:0
  v_mfma_f32_16x16x32_bf16 v[180:183], v[36:39], a[156:159], v[180:183]
  ds_read_b64_tr_b16 v[30:31], v83 offset:2048
  v_mfma_f32_16x16x32_bf16 v[136:139], v[40:43], a[144:147], v[136:139]
  v_mfma_f32_16x16x32_bf16 v[152:155], v[40:43], a[148:151], v[152:155]
  v_mfma_f32_16x16x32_bf16 v[168:171], v[40:43], a[152:155], v[168:171]
  v_mfma_f32_16x16x32_bf16 v[184:187], v[40:43], a[156:159], v[184:187]
  v_mfma_f32_16x16x32_bf16 v[140:143], v[44:47], a[144:147], v[140:143]
  v_mfma_f32_16x16x32_bf16 v[156:159], v[44:47], a[148:151], v[156:159]
  v_mfma_f32_16x16x32_bf16 v[172:175], v[44:47], a[152:155], v[172:175]
  v_mfma_f32_16x16x32_bf16 v[188:191], v[44:47], a[156:159], v[188:191]
  s_waitcnt lgkmcnt(0) vmcnt(8)
  v_mfma_f32_16x16x32_bf16 v[128:131], v[16:19], a[160:163], v[128:131]
  ds_read_b64_tr_b16 v[32:33], v80 offset:4096
  v_mfma_f32_16x16x32_bf16 v[144:147], v[16:19], a[164:167], v[144:147]
  ds_read_b64_tr_b16 v[34:35], v80 offset:6144
  v_mfma_f32_16x16x32_bf16 v[160:163], v[16:19], a[168:171], v[160:163]
  ds_read_b64_tr_b16 v[36:37], v81 offset:4096
  v_mfma_f32_16x16x32_bf16 v[176:179], v[16:19], a[172:175], v[176:179]
  ds_read_b64_tr_b16 v[38:39], v81 offset:6144
  v_mfma_f32_16x16x32_bf16 v[132:135], v[20:23], a[160:163], v[132:135]
  ds_read_b64_tr_b16 v[40:41], v82 offset:4096
  v_mfma_f32_16x16x32_bf16 v[148:151], v[20:23], a[164:167], v[148:151]
  ds_read_b64_tr_b16 v[42:43], v82 offset:6144
  v_mfma_f32_16x16x32_bf16 v[164:167], v[20:23], a[168:171], v[164:167]
  ds_read_b64_tr_b16 v[44:45], v83 offset:4096
  v_mfma_f32_16x16x32_bf16 v[180:183], v[20:23], a[172:175], v[180:183]
  ds_read_b64_tr_b16 v[46:47], v83 offset:6144
  v_mfma_f32_16x16x32_bf16 v[136:139], v[24:27], a[160:163], v[136:139]
  v_mfma_f32_16x16x32_bf16 v[152:155], v[24:27], a[164:167], v[152:155]
  v_mfma_f32_16x16x32_bf16 v[168:171], v[24:27], a[168:171], v[168:171]
  v_mfma_f32_16x16x32_bf16 v[184:187], v[24:27], a[172:175], v[184:187]
  v_mfma_f32_16x16x32_bf16 v[140:143], v[28:31], a[160:163], v[140:143]
  v_mfma_f32_16x16x32_bf16 v[156:159], v[28:31], a[164:167], v[156:159]
  v_mfma_f32_16x16x32_bf16 v[172:175], v[28:31], a[168:171], v[172:175]
  v_mfma_f32_16x16x32_bf16 v[188:191], v[28:31], a[172:175], v[188:191]
  s_waitcnt lgkmcnt(0) vmcnt(4)
  v_mfma_f32_16x16x32_bf16 v[128:131], v[32:35], a[176:179], v[128:131]
  ds_read_b64_tr_b16 v[16:17], v80 offset:8192
  v_mfma_f32_16x16x32_bf16 v[144:147], v[32:35], a[180:183], v[144:147]
  ds_read_b64_tr_b16 v[18:19], v80 offset:10240
  v_mfma_f32_16x16x32_bf16 v[160:163], v[32:35], a[184:187], v[160:163]
  ds_read_b64_tr_b16 v[20:21], v81 offset:8192
  v_mfma_f32_16x16x32_bf16 v[176:179], v[32:35], a[188:191], v[176:179]
  ds_read_b64_tr_b16 v[22:23], v81 offset:10240
  v_mfma_f32_16x16x32_bf16 v[132:135], v[36:39], a[176:179], v[132:135]
  ds_read_b64_tr_b16 v[24:25], v82 offset:8192
  v_mfma_f32_16x16x32_bf16 v[148:151], v[36:39], a[180:183], v[148:151]
  ds_read_b64_tr_b16 v[26:27], v82 offset:10240
  v_mfma_f32_16x16x32_bf16 v[164:167], v[36:39], a[184:187], v[164:167]
  ds_read_b64_tr_b16 v[28:29], v83 offset:8192
  v_mfma_f32_16x16x32_bf16 v[180:183], v[36:39], a[188:191], v[180:183]
  ds_read_b64_tr_b16 v[30:31], v83 offset:10240
  v_mfma_f32_16x16x32_bf16 v[136:139], v[40:43], a[176:179], v[136:139]
  v_mfma_f32_16x16x32_bf16 v[152:155], v[40:43], a[180:183], v[152:155]
  v_mfma_f32_16x16x32_bf16 v[168:171], v[40:43], a[184:187], v[168:171]
  v_mfma_f32_16x16x32_bf16 v[184:187], v[40:43], a[188:191], v[184:187]
  v_mfma_f32_16x16x32_bf16 v[140:143], v[44:47], a[176:179], v[140:143]
  v_mfma_f32_16x16x32_bf16 v[156:159], v[44:47], a[180:183], v[156:159]
  v_mfma_f32_16x16x32_bf16 v[172:175], v[44:47], a[184:187], v[172:175]
  v_mfma_f32_16x16x32_bf16 v[188:191], v[44:47], a[188:191], v[188:191]
  s_waitcnt lgkmcnt(0) vmcnt(0)
  v_mfma_f32_16x16x32_bf16 v[128:131], v[16:19], a[192:195], v[128:131]
  ds_read_b64_tr_b16 v[32:33], v80 offset:12288
  v_mfma_f32_16x16x32_bf16 v[144:147], v[16:19], a[196:199], v[144:147]
  ds_read_b64_tr_b16 v[34:35], v80 offset:14336
  v_mfma_f32_16x16x32_bf16 v[160:163], v[16:19], a[200:203], v[160:163]
  ds_read_b64_tr_b16 v[36:37], v81 offset:12288
  v_mfma_f32_16x16x32_bf16 v[176:179], v[16:19], a[204:207], v[176:179]
  ds_read_b64_tr_b16 v[38:39], v81 offset:14336
  v_mfma_f32_16x16x32_bf16 v[132:135], v[20:23], a[192:195], v[132:135]
  ds_read_b64_tr_b16 v[40:41], v82 offset:12288
  v_mfma_f32_16x16x32_bf16 v[148:151], v[20:23], a[196:199], v[148:151]
  ds_read_b64_tr_b16 v[42:43], v82 offset:14336
  v_mfma_f32_16x16x32_bf16 v[164:167], v[20:23], a[200:203], v[164:167]
  ds_read_b64_tr_b16 v[44:45], v83 offset:12288
  v_mfma_f32_16x16x32_bf16 v[180:183], v[20:23], a[204:207], v[180:183]
  ds_read_b64_tr_b16 v[46:47], v83 offset:14336
  v_mfma_f32_16x16x32_bf16 v[136:139], v[24:27], a[192:195], v[136:139]
  v_mfma_f32_16x16x32_bf16 v[152:155], v[24:27], a[196:199], v[152:155]
  v_mfma_f32_16x16x32_bf16 v[168:171], v[24:27], a[200:203], v[168:171]
  v_mfma_f32_16x16x32_bf16 v[184:187], v[24:27], a[204:207], v[184:187]
  v_mfma_f32_16x16x32_bf16 v[140:143], v[28:31], a[192:195], v[140:143]
  v_mfma_f32_16x16x32_bf16 v[156:159], v[28:31], a[196:199], v[156:159]
  v_mfma_f32_16x16x32_bf16 v[172:175], v[28:31], a[200:203], v[172:175]
  v_mfma_f32_16x16x32_bf16 v[188:191], v[28:31], a[204:207], v[188:191]
  s_waitcnt lgkmcnt(0)
  v_mfma_f32_16x16x32_bf16 v[128:131], v[32:35], a[208:211], v[128:131]
  v_mfma_f32_16x16x32_bf16 v[144:147], v[32:35], a[212:215], v[144:147]
  v_mfma_f32_16x16x32_bf16 v[160:163], v[32:35], a[216:219], v[160:163]
  v_mfma_f32_16x16x32_bf16 v[176:179], v[32:35], a[220:223], v[176:179]
  v_mfma_f32_16x16x32_bf16 v[132:135], v[36:39], a[208:211], v[132:135]
  v_mfma_f32_16x16x32_bf16 v[148:151], v[36:39], a[212:215], v[148:151]
  v_mfma_f32_16x16x32_bf16 v[164:167], v[36:39], a[216:219], v[164:167]
  v_mfma_f32_16x16x32_bf16 v[180:183], v[36:39], a[220:223], v[180:183]
  v_mfma_f32_16x16x32_bf16 v[136:139], v[40:43], a[208:211], v[136:139]
  v_mfma_f32_16x16x32_bf16 v[152:155], v[40:43], a[212:215], v[152:155]
  v_mfma_f32_16x16x32_bf16 v[168:171], v[40:43], a[216:219], v[168:171]
  v_mfma_f32_16x16x32_bf16 v[184:187], v[40:43], a[220:223], v[184:187]
  v_mfma_f32_16x16x32_bf16 v[140:143], v[44:47], a[208:211], v[140:143]
  v_mfma_f32_16x16x32_bf16 v[156:159], v[44:47], a[212:215], v[156:159]
  v_mfma_f32_16x16x32_bf16 v[172:175], v[44:47], a[216:219], v[172:175]
  v_mfma_f32_16x16x32_bf16 v[188:191], v[44:47], a[220:223], v[188:191]
  s_barrier
  s_lshl_b32 s3, s29, 14
  v_add_u32 v4, s3, v1
  ds_write_b128 v4, v[128:131] offset:0
  ds_write_b128 v4, v[132:135] offset:1024
  ds_write_b128 v4, v[136:139] offset:2048
  ds_write_b128 v4, v[140:143] offset:3072
  ds_write_b128 v4, v[144:147] offset:4096
  ds_write_b128 v4, v[148:151] offset:5120
  ds_write_b128 v4, v[152:155] offset:6144
  ds_write_b128 v4, v[156:159] offset:7168
  s_waitcnt lgkmcnt(0)
  ds_write_b128 v4, v[160:163] offset:8192
  ds_write_b128 v4, v[164:167] offset:9216
  ds_write_b128 v4, v[168:171] offset:10240
  ds_write_b128 v4, v[172:175] offset:11264
  ds_write_b128 v4, v[176:179] offset:12288
  ds_write_b128 v4, v[180:183] offset:13312
  ds_write_b128 v4, v[184:187] offset:14336
  ds_write_b128 v4, v[188:191] offset:15360
  s_waitcnt lgkmcnt(0)
  v_bfe_u32 v4, v0, 0, 1
  v_lshlrev_b32 v5, 9, v4
  v_bfe_u32 v4, v0, 1, 1
  v_lshl_add_u32 v5, v4, 10, v5
  v_bfe_u32 v4, v0, 2, 1
  v_lshl_add_u32 v5, v4, 11, v5
  v_bfe_u32 v4, v0, 3, 1
  v_lshl_add_u32 v5, v4, 4, v5
  v_bfe_u32 v4, v0, 4, 1
  v_lshl_add_u32 v5, v4, 5, v5
  v_bfe_u32 v4, v0, 5, 1
  v_lshl_add_u32 v5, v4, 6, v5
  s_barrier
  s_lshl_b32 s3, s29, 12
  v_add_u32 v4, s3, v5
  ds_read_b128 v[16:19], v4 offset:0
  ds_read_b128 v[20:23], v4 offset:256
  ds_read_b128 v[24:27], v4 offset:128
  ds_read_b128 v[28:31], v4 offset:384
  ds_read_b128 v[32:35], v4 offset:16384
  ds_read_b128 v[36:39], v4 offset:16640
  ds_read_b128 v[40:43], v4 offset:16512
  ds_read_b128 v[44:47], v4 offset:16768
  s_waitcnt lgkmcnt(0)
  ds_read_b128 v[48:51], v4 offset:32768
  ds_read_b128 v[52:55], v4 offset:33024
  ds_read_b128 v[56:59], v4 offset:32896
  ds_read_b128 v[60:63], v4 offset:33152
  ds_read_b128 v[64:67], v4 offset:49152
  ds_read_b128 v[68:71], v4 offset:49408
  ds_read_b128 v[72:75], v4 offset:49280
  ds_read_b128 v[76:79], v4 offset:49536
  s_waitcnt lgkmcnt(0)
  v_lshlrev_b32 v14, 16, v14
  v_lshlrev_b32 v15, 16, v15
  v_add_f32 v16, v16, v32
  v_add_f32 v48, v48, v64
  v_add_f32 v16, v16, v48
  v_add_f32 v17, v17, v33
  v_add_f32 v49, v49, v65
  v_add_f32 v17, v17, v49
  v_add_f32 v18, v18, v34
  v_add_f32 v50, v50, v66
  v_add_f32 v18, v18, v50
  v_add_f32 v19, v19, v35
  v_add_f32 v51, v51, v67
  v_add_f32 v19, v19, v51
  v_add_f32 v20, v20, v36
  v_add_f32 v52, v52, v68
  v_add_f32 v20, v20, v52
  v_add_f32 v21, v21, v37
  v_add_f32 v53, v53, v69
  v_add_f32 v21, v21, v53
  v_add_f32 v22, v22, v38
  v_add_f32 v54, v54, v70
  v_add_f32 v22, v22, v54
  v_add_f32 v23, v23, v39
  v_add_f32 v55, v55, v71
  v_add_f32 v23, v23, v55
  v_add_f32 v24, v24, v40
  v_add_f32 v56, v56, v72
  v_add_f32 v24, v24, v56
  v_add_f32 v25, v25, v41
  v_add_f32 v57, v57, v73
  v_add_f32 v25, v25, v57
  v_add_f32 v26, v26, v42
  v_add_f32 v58, v58, v74
  v_add_f32 v26, v26, v58
  v_add_f32 v27, v27, v43
  v_add_f32 v59, v59, v75
  v_add_f32 v27, v27, v59
  v_add_f32 v28, v28, v44
  v_add_f32 v60, v60, v76
  v_add_f32 v28, v28, v60
  v_add_f32 v29, v29, v45
  v_add_f32 v61, v61, v77
  v_add_f32 v29, v29, v61
  v_add_f32 v30, v30, v46
  v_add_f32 v62, v62, v78
  v_add_f32 v30, v30, v62
  v_add_f32 v31, v31, v47
  v_add_f32 v63, v63, v79
  v_add_f32 v31, v31, v63
  v_cvt_pk_bf16_f32 v32, v16, v17
  v_and_b32 v17, 0xffff0000, v32
  v_lshlrev_b32 v16, 16, v32
  v_add_f32 v16, v16, v14
  v_add_f32 v17, v17, v14
  v_cvt_pk_bf16_f32 v32, v16, v17
  v_cvt_pk_bf16_f32 v33, v18, v19
  v_and_b32 v19, 0xffff0000, v33
  v_lshlrev_b32 v18, 16, v33
  v_add_f32 v18, v18, v14
  v_add_f32 v19, v19, v14
  v_cvt_pk_bf16_f32 v33, v18, v19
  v_cvt_pk_bf16_f32 v34, v20, v21
  v_and_b32 v21, 0xffff0000, v34
  v_lshlrev_b32 v20, 16, v34
  v_add_f32 v20, v20, v14
  v_add_f32 v21, v21, v14
  v_cvt_pk_bf16_f32 v34, v20, v21
  v_cvt_pk_bf16_f32 v35, v22, v23
  v_and_b32 v23, 0xffff0000, v35
  v_lshlrev_b32 v22, 16, v35
  v_add_f32 v22, v22, v14
  v_add_f32 v23, v23, v14
  v_cvt_pk_bf16_f32 v35, v22, v23
  v_cvt_pk_bf16_f32 v36, v24, v25
  v_and_b32 v25, 0xffff0000, v36
  v_lshlrev_b32 v24, 16, v36
  v_add_f32 v24, v24, v15
  v_add_f32 v25, v25, v15
  v_cvt_pk_bf16_f32 v36, v24, v25
  v_cvt_pk_bf16_f32 v37, v26, v27
  v_and_b32 v27, 0xffff0000, v37
  v_lshlrev_b32 v26, 16, v37
  v_add_f32 v26, v26, v15
  v_add_f32 v27, v27, v15
  v_cvt_pk_bf16_f32 v37, v26, v27
  v_cvt_pk_bf16_f32 v38, v28, v29
  v_and_b32 v29, 0xffff0000, v38
  v_lshlrev_b32 v28, 16, v38
  v_add_f32 v28, v28, v15
  v_add_f32 v29, v29, v15
  v_cvt_pk_bf16_f32 v38, v28, v29
  v_cvt_pk_bf16_f32 v39, v30, v31
  v_and_b32 v31, 0xffff0000, v39
  v_lshlrev_b32 v30, 16, v39
  v_add_f32 v30, v30, v15
  v_add_f32 v31, v31, v15
  v_cvt_pk_bf16_f32 v39, v30, v31
  v_bfe_u32 v4, v0, 0, 1
  v_lshlrev_b32 v5, 4, v4
  v_bfe_u32 v4, v0, 1, 1
  v_lshl_add_u32 v5, v4, 5, v5
  v_bfe_u32 v4, v0, 2, 1
  v_lshl_add_u32 v5, v4, 6, v5
  v_bfe_u32 v4, v0, 3, 1
  v_lshl_add_u32 v5, v4, 10, v5
  v_bfe_u32 v4, v0, 4, 1
  v_lshl_add_u32 v5, v4, 11, v5
  v_bfe_u32 v4, v0, 5, 1
  v_lshl_add_u32 v5, v4, 12, v5
  s_lshl_b32 s3, s39, 16
  s_lshl_b32 s6, s29, 14
  s_add_u32 s3, s3, s6
  s_lshl_b32 s6, s38, 7
  s_add_u32 s3, s3, s6
  s_add_u32 s3, s3, 5242880
  buffer_store_dwordx4 v[32:35], v5, s[8:11], s3 offen sc1
  s_add_u32 s3, s3, 8192
  buffer_store_dwordx4 v[36:39], v5, s[8:11], s3 offen sc1
  s_waitcnt vmcnt(0)
  s_barrier
  s_lshl_b32 s3, s31, 2
  s_add_u32 s3, s3, 598016
  s_cmp_lg_u32 s29, 0
  s_cbranch_scc1 W_pub_32
  v_mov_b32 v4, s35
  s_mov_b64 exec, 1
  buffer_store_dword v4, off, s[8:11], s3 sc1
  s_mov_b64 exec, -1
W_pub_32:
  s_add_u32 s39, s39, 8
  s_add_u32 s35, s35, 1
  s_and_b32 s3, s39, 0x38
  s_cmp_eq_u32 s3, 24
  s_cbranch_scc1 C_top_29
  s_load_dwordx2 s[12:13], s[0:1], 40
  s_mov_b32 s14, 4194304
  s_mov_b32 s15, 0x20000
  v_bfe_u32 v4, v0, 0, 1
  v_lshlrev_b32 v6, 4, v4
  v_bfe_u32 v4, v0, 1, 1
  v_lshl_add_u32 v6, v4, 5, v6
  v_bfe_u32 v4, v0, 2, 1
  v_lshl_add_u32 v6, v4, 10, v6
  v_bfe_u32 v4, v0, 3, 1
  v_lshl_add_u32 v6, v4, 11, v6
  v_bfe_u32 v4, v0, 4, 1
  v_lshl_add_u32 v6, v4, 12, v6
  v_bfe_u32 v4, v0, 5, 1
  v_lshl_add_u32 v6, v4, 13, v6
  v_bfe_u32 v4, v0, 0, 1
  v_lshlrev_b32 v7, 3, v4
  v_bfe_u32 v4, v0, 1, 1
  v_lshl_add_u32 v7, v4, 4, v7
  v_bfe_u32 v4, v0, 2, 1
  v_lshl_add_u32 v7, v4, 6, v7
  v_bfe_u32 v4, v0, 3, 1
  v_lshl_add_u32 v7, v4, 7, v7
  v_bfe_u32 v4, v0, 4, 1
  v_lshl_add_u32 v7, v4, 8, v7
  v_bfe_u32 v4, v0, 5, 1
  v_lshl_add_u32 v7, v4, 9, v7
  s_and_b32 s3, s30, 15
  s_lshl_b32 s3, s3, 6
  s_lshl_b32 s6, s29, 20
  s_add_u32 s3, s3, s6
  v_add_u32 v6, s3, v6
  s_lshl_b32 s36, s29, 15
  s_add_u32 s36, s36, 32768
  v_add_u32 v7, s36, v7
  s_bfe_u32 s33, s30, 196609
  s_lshl_b32 s42, s33, 17
  s_lshl_b32 s33, s33, 12
  s_waitcnt lgkmcnt(0)
  s_add_u32 m0, s36, 0
  s_xor_b32 s3, s42, 0
  buffer_load_dwordx4 v6, s[12:15], s3 offen  lds
  s_add_u32 m0, s36, 1024
  s_xor_b32 s3, s42, 16384
  buffer_load_dwordx4 v6, s[12:15], s3 offen  lds
  s_add_u32 m0, s36, 2048
  s_xor_b32 s3, s42, 32768
  buffer_load_dwordx4 v6, s[12:15], s3 offen  lds
  s_add_u32 m0, s36, 3072
  s_xor_b32 s3, s42, 49152
  buffer_load_dwordx4 v6, s[12:15], s3 offen  lds
  s_add_u32 m0, s36, 4096
  s_xor_b32 s3, s42, 65536
  buffer_load_dwordx4 v6, s[12:15], s3 offen  lds
  s_add_u32 m0, s36, 5120
  s_xor_b32 s3, s42, 81920
  buffer_load_dwordx4 v6, s[12:15], s3 offen  lds
  s_add_u32 m0, s36, 6144
  s_xor_b32 s3, s42, 98304
  buffer_load_dwordx4 v6, s[12:15], s3 offen  lds
  s_add_u32 m0, s36, 7168
  s_xor_b32 s3, s42, 114688
  buffer_load_dwordx4 v6, s[12:15], s3 offen  lds
  s_add_u32 m0, s36, 8192
  s_xor_b32 s3, s42, 131072
  buffer_load_dwordx4 v6, s[12:15], s3 offen  lds
  s_add_u32 m0, s36, 9216
  s_xor_b32 s3, s42, 147456
  buffer_load_dwordx4 v6, s[12:15], s3 offen  lds
  s_add_u32 m0, s36, 10240
  s_xor_b32 s3, s42, 163840
  buffer_load_dwordx4 v6, s[12:15], s3 offen  lds
  s_add_u32 m0, s36, 11264
  s_xor_b32 s3, s42, 180224
  buffer_load_dwordx4 v6, s[12:15], s3 offen  lds
  s_add_u32 m0, s36, 12288
  s_xor_b32 s3, s42, 196608
  buffer_load_dwordx4 v6, s[12:15], s3 offen  lds
  s_add_u32 m0, s36, 13312
  s_xor_b32 s3, s42, 212992
  buffer_load_dwordx4 v6, s[12:15], s3 offen  lds
  s_add_u32 m0, s36, 14336
  s_xor_b32 s3, s42, 229376
  buffer_load_dwordx4 v6, s[12:15], s3 offen  lds
  s_add_u32 m0, s36, 15360
  s_xor_b32 s3, s42, 245760
  buffer_load_dwordx4 v6, s[12:15], s3 offen  lds
  s_add_u32 m0, s36, 16384
  s_xor_b32 s3, s42, 262144
  buffer_load_dwordx4 v6, s[12:15], s3 offen  lds
  s_add_u32 m0, s36, 17408
  s_xor_b32 s3, s42, 278528
  buffer_load_dwordx4 v6, s[12:15], s3 offen  lds
  s_add_u32 m0, s36, 18432
  s_xor_b32 s3, s42, 294912
  buffer_load_dwordx4 v6, s[12:15], s3 offen  lds
  s_add_u32 m0, s36, 19456
  s_xor_b32 s3, s42, 311296
  buffer_load_dwordx4 v6, s[12:15], s3 offen  lds
  s_add_u32 m0, s36, 20480
  s_xor_b32 s3, s42, 327680
  buffer_load_dwordx4 v6, s[12:15], s3 offen  lds
  s_add_u32 m0, s36, 21504
  s_xor_b32 s3, s42, 344064
  buffer_load_dwordx4 v6, s[12:15], s3 offen  lds
  s_add_u32 m0, s36, 22528
  s_xor_b32 s3, s42, 360448
  buffer_load_dwordx4 v6, s[12:15], s3 offen  lds
  s_add_u32 m0, s36, 23552
  s_xor_b32 s3, s42, 376832
  buffer_load_dwordx4 v6, s[12:15], s3 offen  lds
  s_add_u32 m0, s36, 24576
  s_xor_b32 s3, s42, 393216
  buffer_load_dwordx4 v6, s[12:15], s3 offen  lds
  s_add_u32 m0, s36, 25600
  s_xor_b32 s3, s42, 409600
  buffer_load_dwordx4 v6, s[12:15], s3 offen  lds
  s_add_u32 m0, s36, 26624
  s_xor_b32 s3, s42, 425984
  buffer_load_dwordx4 v6, s[12:15], s3 offen  lds
  s_add_u32 m0, s36, 27648
  s_xor_b32 s3, s42, 442368
  buffer_load_dwordx4 v6, s[12:15], s3 offen  lds
  s_add_u32 m0, s36, 28672
  s_xor_b32 s3, s42, 458752
  buffer_load_dwordx4 v6, s[12:15], s3 offen  lds
  s_add_u32 m0, s36, 29696
  s_xor_b32 s3, s42, 475136
  buffer_load_dwordx4 v6, s[12:15], s3 offen  lds
  s_add_u32 m0, s36, 30720
  s_xor_b32 s3, s42, 491520
  buffer_load_dwordx4 v6, s[12:15], s3 offen  lds
  s_add_u32 m0, s36, 31744
  s_xor_b32 s3, s42, 507904
  buffer_load_dwordx4 v6, s[12:15], s3 offen  lds
  s_waitcnt vmcnt(28)
  ds_read_b64_tr_b16 a[0:1], v7 offset:0
  ds_read_b64_tr_b16 a[2:3], v7 offset:1024
  ds_read_b64_tr_b16 a[4:5], v7 offset:2048
  ds_read_b64_tr_b16 a[6:7], v7 offset:3072
  ds_read_b64_tr_b16 a[8:9], v7 offset:32
  ds_read_b64_tr_b16 a[10:11], v7 offset:1056
  ds_read_b64_tr_b16 a[12:13], v7 offset:2080
  ds_read_b64_tr_b16 a[14:15], v7 offset:3104
  s_waitcnt lgkmcnt(0)
  s_add_u32 m0, s36, 0
  s_xor_b32 s3, s42, 524288
  buffer_load_dwordx4 v6, s[12:15], s3 offen  lds
  s_add_u32 m0, s36, 1024
  s_xor_b32 s3, s42, 540672
  buffer_load_dwordx4 v6, s[12:15], s3 offen  lds
  s_add_u32 m0, s36, 2048
  s_xor_b32 s3, s42, 557056
  buffer_load_dwordx4 v6, s[12:15], s3 offen  lds
  s_add_u32 m0, s36, 3072
  s_xor_b32 s3, s42, 573440
  buffer_load_dwordx4 v6, s[12:15], s3 offen  lds
  s_waitcnt vmcnt(28)
  ds_read_b64_tr_b16 a[16:17], v7 offset:4096
  ds_read_b64_tr_b16 a[18:19], v7 offset:5120
  ds_read_b64_tr_b16 a[20:21], v7 offset:6144
  ds_read_b64_tr_b16 a[22:23], v7 offset:7168
  ds_read_b64_tr_b16 a[24:25], v7 offset:4128
  ds_read_b64_tr_b16 a[26:27], v7 offset:5152
  ds_read_b64_tr_b16 a[28:29], v7 offset:6176
  ds_read_b64_tr_b16 a[30:31], v7 offset:7200
  s_waitcnt lgkmcnt(0)
  s_add_u32 m0, s36, 4096
  s_xor_b32 s3, s42, 589824
  buffer_load_dwordx4 v6, s[12:15], s3 offen  lds
  s_add_u32 m0, s36, 5120
  s_xor_b32 s3, s42, 606208
  buffer_load_dwordx4 v6, s[12:15], s3 offen  lds
  s_add_u32 m0, s36, 6144
  s_xor_b32 s3, s42, 622592
  buffer_load_dwordx4 v6, s[12:15], s3 offen  lds
  s_add_u32 m0, s36, 7168
  s_xor_b32 s3, s42, 638976
  buffer_load_dwordx4 v6, s[12:15], s3 offen  lds
  s_waitcnt vmcnt(28)
  ds_read_b64_tr_b16 a[32:33], v7 offset:8192
  ds_read_b64_tr_b16 a[34:35], v7 offset:9216
  ds_read_b64_tr_b16 a[36:37], v7 offset:10240
  ds_read_b64_tr_b16 a[38:39], v7 offset:11264
  ds_read_b64_tr_b16 a[40:41], v7 offset:8224
  ds_read_b64_tr_b16 a[42:43], v7 offset:9248
  ds_read_b64_tr_b16 a[44:45], v7 offset:10272
  ds_read_b64_tr_b16 a[46:47], v7 offset:11296
  s_waitcnt lgkmcnt(0)
  s_add_u32 m0, s36, 8192
  s_xor_b32 s3, s42, 655360
  buffer_load_dwordx4 v6, s[12:15], s3 offen  lds
  s_add_u32 m0, s36, 9216
  s_xor_b32 s3, s42, 671744
  buffer_load_dwordx4 v6, s[12:15], s3 offen  lds
  s_add_u32 m0, s36, 10240
  s_xor_b32 s3, s42, 688128
  buffer_load_dwordx4 v6, s[12:15], s3 offen  lds
  s_add_u32 m0, s36, 11264
  s_xor_b32 s3, s42, 704512
  buffer_load_dwordx4 v6, s[12:15], s3 offen  lds
  s_waitcnt vmcnt(28)
  ds_read_b64_tr_b16 a[48:49], v7 offset:12288
  ds_read_b64_tr_b16 a[50:51], v7 offset:13312
  ds_read_b64_tr_b16 a[52:53], v7 offset:14336
  ds_read_b64_tr_b16 a[54:55], v7 offset:15360
  ds_read_b64_tr_b16 a[56:57], v7 offset:12320
  ds_read_b64_tr_b16 a[58:59], v7 offset:13344
  ds_read_b64_tr_b16 a[60:61], v7 offset:14368
  ds_read_b64_tr_b16 a[62:63], v7 offset:15392
  s_waitcnt lgkmcnt(0)
  s_add_u32 m0, s36, 12288
  s_xor_b32 s3, s42, 720896
  buffer_load_dwordx4 v6, s[12:15], s3 offen  lds
  s_add_u32 m0, s36, 13312
  s_xor_b32 s3, s42, 737280
  buffer_load_dwordx4 v6, s[12:15], s3 offen  lds
  s_add_u32 m0, s36, 14336
  s_xor_b32 s3, s42, 753664
  buffer_load_dwordx4 v6, s[12:15], s3 offen  lds
  s_add_u32 m0, s36, 15360
  s_xor_b32 s3, s42, 770048
  buffer_load_dwordx4 v6, s[12:15], s3 offen  lds
  s_waitcnt vmcnt(28)
  ds_read_b64_tr_b16 a[64:65], v7 offset:16384
  ds_read_b64_tr_b16 a[66:67], v7 offset:17408
  ds_read_b64_tr_b16 a[68:69], v7 offset:18432
  ds_read_b64_tr_b16 a[70:71], v7 offset:19456
  ds_read_b64_tr_b16 a[72:73], v7 offset:16416
  ds_read_b64_tr_b16 a[74:75], v7 offset:17440
  ds_read_b64_tr_b16 a[76:77], v7 offset:18464
  ds_read_b64_tr_b16 a[78:79], v7 offset:19488
  s_waitcnt lgkmcnt(0)
  s_add_u32 m0, s36, 16384
  s_xor_b32 s3, s42, 786432
  buffer_load_dwordx4 v6, s[12:15], s3 offen  lds
  s_add_u32 m0, s36, 17408
  s_xor_b32 s3, s42, 802816
  buffer_load_dwordx4 v6, s[12:15], s3 offen  lds
  s_add_u32 m0, s36, 18432
  s_xor_b32 s3, s42, 819200
  buffer_load_dwordx4 v6, s[12:15], s3 offen  lds
  s_add_u32 m0, s36, 19456
  s_xor_b32 s3, s42, 835584
  buffer_load_dwordx4 v6, s[12:15], s3 offen  lds
  s_waitcnt vmcnt(28)
  ds_read_b64_tr_b16 a[80:81], v7 offset:20480
  ds_read_b64_tr_b16 a[82:83], v7 offset:21504
  ds_read_b64_tr_b16 a[84:85], v7 offset:22528
  ds_read_b64_tr_b16 a[86:87], v7 offset:23552
  ds_read_b64_tr_b16 a[88:89], v7 offset:20512
  ds_read_b64_tr_b16 a[90:91], v7 offset:21536
  ds_read_b64_tr_b16 a[92:93], v7 offset:22560
  ds_read_b64_tr_b16 a[94:95], v7 offset:23584
  s_waitcnt lgkmcnt(0)
  s_add_u32 m0, s36, 20480
  s_xor_b32 s3, s42, 851968
  buffer_load_dwordx4 v6, s[12:15], s3 offen  lds
  s_add_u32 m0, s36, 21504
  s_xor_b32 s3, s42, 868352
  buffer_load_dwordx4 v6, s[12:15], s3 offen  lds
  s_add_u32 m0, s36, 22528
  s_xor_b32 s3, s42, 884736
  buffer_load_dwordx4 v6, s[12:15], s3 offen  lds
  s_add_u32 m0, s36, 23552
  s_xor_b32 s3, s42, 901120
  buffer_load_dwordx4 v6, s[12:15], s3 offen  lds
  s_waitcnt vmcnt(28)
  ds_read_b64_tr_b16 a[96:97], v7 offset:24576
  ds_read_b64_tr_b16 a[98:99], v7 offset:25600
  ds_read_b64_tr_b16 a[100:101], v7 offset:26624
  ds_read_b64_tr_b16 a[102:103], v7 offset:27648
  ds_read_b64_tr_b16 a[104:105], v7 offset:24608
  ds_read_b64_tr_b16 a[106:107], v7 offset:25632
  ds_read_b64_tr_b16 a[108:109], v7 offset:26656
  ds_read_b64_tr_b16 a[110:111], v7 offset:27680
  s_waitcnt lgkmcnt(0)
  s_add_u32 m0, s36, 24576
  s_xor_b32 s3, s42, 917504
  buffer_load_dwordx4 v6, s[12:15], s3 offen  lds
  s_add_u32 m0, s36, 25600
  s_xor_b32 s3, s42, 933888
  buffer_load_dwordx4 v6, s[12:15], s3 offen  lds
  s_add_u32 m0, s36, 26624
  s_xor_b32 s3, s42, 950272
  buffer_load_dwordx4 v6, s[12:15], s3 offen  lds
  s_add_u32 m0, s36, 27648
  s_xor_b32 s3, s42, 966656
  buffer_load_dwordx4 v6, s[12:15], s3 offen  lds
  s_waitcnt vmcnt(28)
  ds_read_b64_tr_b16 a[112:113], v7 offset:28672
  ds_read_b64_tr_b16 a[114:115], v7 offset:29696
  ds_read_b64_tr_b16 a[116:117], v7 offset:30720
  ds_read_b64_tr_b16 a[118:119], v7 offset:31744
  ds_read_b64_tr_b16 a[120:121], v7 offset:28704
  ds_read_b64_tr_b16 a[122:123], v7 offset:29728
  ds_read_b64_tr_b16 a[124:125], v7 offset:30752
  ds_read_b64_tr_b16 a[126:127], v7 offset:31776
  s_waitcnt lgkmcnt(0)
  s_add_u32 m0, s36, 28672
  s_xor_b32 s3, s42, 983040
  buffer_load_dwordx4 v6, s[12:15], s3 offen  lds
  s_add_u32 m0, s36, 29696
  s_xor_b32 s3, s42, 999424
  buffer_load_dwordx4 v6, s[12:15], s3 offen  lds
  s_add_u32 m0, s36, 30720
  s_xor_b32 s3, s42, 1015808
  buffer_load_dwordx4 v6, s[12:15], s3 offen  lds
  s_add_u32 m0, s36, 31744
  s_xor_b32 s3, s42, 1032192
  buffer_load_dwordx4 v6, s[12:15], s3 offen  lds
  s_waitcnt vmcnt(28)
  ds_read_b64_tr_b16 a[128:129], v7 offset:0
  ds_read_b64_tr_b16 a[130:131], v7 offset:1024
  ds_read_b64_tr_b16 a[132:133], v7 offset:2048
  ds_read_b64_tr_b16 a[134:135], v7 offset:3072
  ds_read_b64_tr_b16 a[136:137], v7 offset:32
  ds_read_b64_tr_b16 a[138:139], v7 offset:1056
  ds_read_b64_tr_b16 a[140:141], v7 offset:2080
  ds_read_b64_tr_b16 a[142:143], v7 offset:3104
  s_waitcnt lgkmcnt(0)
  s_waitcnt vmcnt(24)
  ds_read_b64_tr_b16 a[144:145], v7 offset:4096
  ds_read_b64_tr_b16 a[146:147], v7 offset:5120
  ds_read_b64_tr_b16 a[148:149], v7 offset:6144
  ds_read_b64_tr_b16 a[150:151], v7 offset:7168
  ds_read_b64_tr_b16 a[152:153], v7 offset:4128
  ds_read_b64_tr_b16 a[154:155], v7 offset:5152
  ds_read_b64_tr_b16 a[156:157], v7 offset:6176
  ds_read_b64_tr_b16 a[158:159], v7 offset:7200
  s_waitcnt lgkmcnt(0)
  s_waitcnt vmcnt(20)
  ds_read_b64_tr_b16 a[160:161], v7 offset:8192
  ds_read_b64_tr_b16 a[162:163], v7 offset:9216
  ds_read_b64_tr_b16 a[164:165], v7 offset:10240
  ds_read_b64_tr_b16 a[166:167], v7 offset:11264
  ds_read_b64_tr_b16 a[168:169], v7 offset:8224
  ds_read_b64_tr_b16 a[170:171], v7 offset:9248
  ds_read_b64_tr_b16 a[172:173], v7 offset:10272
  ds_read_b64_tr_b16 a[174:175], v7 offset:11296
  s_waitcnt lgkmcnt(0)
  s_waitcnt vmcnt(16)
  ds_read_b64_tr_b16 a[176:177], v7 offset:12288
  ds_read_b64_tr_b16 a[178:179], v7 offset:13312
  ds_read_b64_tr_b16 a[180:181], v7 offset:14336
  ds_read_b64_tr_b16 a[182:183], v7 offset:15360
  ds_read_b64_tr_b16 a[184:185], v7 offset:12320
  ds_read_b64_tr_b16 a[186:187], v7 offset:13344
  ds_read_b64_tr_b16 a[188:189], v7 offset:14368
  ds_read_b64_tr_b16 a[190:191], v7 offset:15392
  s_waitcnt lgkmcnt(0)
  s_waitcnt vmcnt(12)
  ds_read_b64_tr_b16 a[192:193], v7 offset:16384
  ds_read_b64_tr_b16 a[194:195], v7 offset:17408
  ds_read_b64_tr_b16 a[196:197], v7 offset:18432
  ds_read_b64_tr_b16 a[198:199], v7 offset:19456
  ds_read_b64_tr_b16 a[200:201], v7 offset:16416
  ds_read_b64_tr_b16 a[202:203], v7 offset:17440
  ds_read_b64_tr_b16 a[204:205], v7 offset:18464
  ds_read_b64_tr_b16 a[206:207], v7 offset:19488
  s_waitcnt lgkmcnt(0)
  s_waitcnt vmcnt(8)
  ds_read_b64_tr_b16 a[208:209], v7 offset:20480
  ds_read_b64_tr_b16 a[210:211], v7 offset:21504
  ds_read_b64_tr_b16 a[212:213], v7 offset:22528
  ds_read_b64_tr_b16 a[214:215], v7 offset:23552
  ds_read_b64_tr_b16 a[216:217], v7 offset:20512
  ds_read_b64_tr_b16 a[218:219], v7 offset:21536
  ds_read_b64_tr_b16 a[220:221], v7 offset:22560
  ds_read_b64_tr_b16 a[222:223], v7 offset:23584
  s_waitcnt lgkmcnt(0)
  s_waitcnt vmcnt(4)
  ds_read_b64_tr_b16 a[224:225], v7 offset:24576
  ds_read_b64_tr_b16 a[226:227], v7 offset:25600
  ds_read_b64_tr_b16 a[228:229], v7 offset:26624
  ds_read_b64_tr_b16 a[230:231], v7 offset:27648
  ds_read_b64_tr_b16 a[232:233], v7 offset:24608
  ds_read_b64_tr_b16 a[234:235], v7 offset:25632
  ds_read_b64_tr_b16 a[236:237], v7 offset:26656
  ds_read_b64_tr_b16 a[238:239], v7 offset:27680
  s_waitcnt lgkmcnt(0)
  s_waitcnt vmcnt(0)
  ds_read_b64_tr_b16 a[240:241], v7 offset:28672
  ds_read_b64_tr_b16 a[242:243], v7 offset:29696
  ds_read_b64_tr_b16 a[244:245], v7 offset:30720
  ds_read_b64_tr_b16 a[246:247], v7 offset:31744
  ds_read_b64_tr_b16 a[248:249], v7 offset:28704
  ds_read_b64_tr_b16 a[250:251], v7 offset:29728
  ds_read_b64_tr_b16 a[252:253], v7 offset:30752
  ds_read_b64_tr_b16 a[254:255], v7 offset:31776
  s_waitcnt lgkmcnt(0)
  s_barrier
  s_load_dwordx2 s[16:17], s[0:1], 104
  s_mov_b32 s18, 2097152
  s_mov_b32 s19, 0x20000
  s_waitcnt lgkmcnt(0)
  v_min_u32 v5, 55, v0
  v_lshlrev_b32 v5, 4, v5
  v_add_u32 v5, 598016, v5
  v_cmp_le_u32 vcc, 32, v0
  s_nop 1
  v_cndmask_b32 v12, 3, 3, vcc
  v_cmp_le_u32 vcc, 48, v0
  s_nop 1
  v_cndmask_b32 v12, v12, 0, vcc
W_spin_33:
  buffer_load_dwordx4 v[8:11], v5, s[8:11], 0 offen sc1
W_spin_33h:
  s_add_u32 s44, s44, 1
  s_cmp_gt_u32 s44, 400000
  s_cbranch_scc1 W_spin_33x
  s_waitcnt vmcnt(0)
  v_min3_u32 v8, v8, v9, v10
  v_min_u32 v8, v8, v11
  v_cmp_gt_u32 vcc, v12, v8
  s_cbranch_vccz W_spin_33x
  s_sleep 8
  s_branch W_spin_33
W_spin_33x:
  s_waitcnt vmcnt(0)
  v_and_b32 v4, 31, v0
  v_lshlrev_b32 v4, 2, v4
  s_lshl_b32 s3, s28, 7
  s_add_u32 s3, s3, 602112
  buffer_load_dword v5, v4, s[8:11], s3 offen sc1
  s_getreg_b32 s3, hwreg(HW_REG_XCC_ID, 0, 4)
  s_waitcnt vmcnt(0)
  v_cmp_ne_u32 vcc, s3, v5
  s_nop 3
  s_cmp_eq_u32 vcc_lo, 0
  s_cselect_b32 s45, 1, 0
  v_lshrrev_b32 v4, 4, v0
  v_bfe_u32 v5, v0, 2, 2
  v_xor_b32 v5, v4, v5
  v_lshlrev_b32 v5, 3, v5
  v_and_b32 v15, 15, v0
  v_lshl_add_u32 v6, v15, 5, v5
  s_lshl_b32 s3, s29, 10
  v_add_u32 v6, s3, v6
  v_and_b32 v5, 3, v0
  v_xor_b32 v5, v4, v5
  v_lshlrev_b32 v5, 3, v5
  v_lshrrev_b32 v7, 2, v0
  v_lshl_add_u32 v7, v7, 5, v5
  s_lshl_b32 s3, s29, 9
  s_add_u32 s3, s3, 4096
  v_lshl_add_u32 v8, v0, 3, s3
  s_lshr_b32 s6, s29, 1
  s_lshl_b32 s3, s6, 10
  s_add_u32 s3, s3, 4096
  v_lshl_add_u32 v9, v0, 3, s3
  s_and_b32 s7, s29, 1
  s_lshl_b32 s3, s7, 4
  v_lshlrev_b32 v5, 2, v4
  v_sub_u32 v10, v15, v5
  v_add_u32 v10, s3, v10
  v_lshlrev_b32 v11, 10, v15
  v_lshl_add_u32 v11, v4, 3, v11
  s_lshl_b32 s3, s7, 5
  s_and_b32 s6, s30, 15
  s_lshl_b32 s6, s6, 6
  s_add_u32 s3, s3, s6
  s_lshr_b32 s6, s30, 4
  s_lshl_b32 s6, s6, 14
  s_add_u32 s3, s3, s6
  v_add_u32 v11, s3, v11
  v_add_u32 v12, 8192, v3
  s_lshl_b32 s3, s7, 10
  s_add_u32 s3, s3, 8192
  v_add_u32 v13, s3, v1
  s_lshr_b32 s6, s30, 4
  s_lshl_b32 s6, s6, 6
  v_lshl_add_u32 v15, v15, 2, s6
  s_cmp_lt_u32 s28, 4
  s_cselect_b32 s3, 0, 12
  s_add_u32 s34, s28, s3
  s_mul_i32 s32, s28, 1536
  s_add_u32 s32, s32, 606208
  s_lshl_b32 s35, s28, 19
  s_mov_b32 s43, 0x3e0293ee
  v_mov_b32 v124, 0x3f803f80
  v_mov_b32 v125, 0x3f803f80
  v_mov_b32 v126, 0x3f803f80
  v_mov_b32 v127, 0x3f803f80
  v_mov_b32 v121, 0
  v_mov_b32 v122, 0
  v_add_u32 v196, 32768, v1
  s_lshl_b32 s3, s7, 12
  s_add_u32 s3, s3, 49152
  v_add_u32 v197, s3, v1
  s_lshr_b32 s3, s29, 1
  s_lshl_b32 s3, s3, 12
  s_add_u32 s3, s3, 40960
  v_add_u32 v198, s3, v1
  v_add_u32 v199, 57344, v2
  s_mov_b32 s37, 32768
  s_lshl_b32 s7, s30, 6
  s_add_u32 s7, s7, s34
  s_lshl_b32 s6, s29, 12
  s_add_u32 m0, s37, s6
  s_lshl_b32 s3, s7, 14
  s_add_u32 s3, s3, s6
  s_add_u32 s3, s3, 8388608
  buffer_load_dwordx4 v1, s[8:11], s3 offen offset:0 sc1 lds
  buffer_load_dwordx4 v1, s[8:11], s3 offen offset:1024 sc1 lds
  buffer_load_dwordx4 v1, s[8:11], s3 offen offset:2048 sc1 lds
  buffer_load_dwordx4 v1, s[8:11], s3 offen offset:3072 sc1 lds
  s_lshl_b32 s6, s29, 11
  s_add_u32 s6, s6, 16384
  s_add_u32 m0, s37, s6
  s_lshl_b32 s3, s7, 13
  s_add_u32 s3, s3, 42991616
  buffer_load_dwordx4 v3, s[8:11], s3 offen offset:0 sc1 lds
  buffer_load_dwordx4 v3, s[8:11], s3 offen offset:1024 sc1 lds
  s_lshl_b32 s6, s29, 10
  s_add_u32 s6, s6, 24576
  s_add_u32 m0, s37, s6
  s_add_u32 s3, s7, s30
  s_lshl_b32 s3, s3, 12
  s_add_u32 s3, s3, 59772928
  buffer_load_dwordx4 v2, s[8:11], s3 offen sc1 lds
  s_xor_b32 s37, s37, 98304
  s_cmp_lt_u32 s34, 12
  s_cselect_b32 s3, 4, 6
  s_add_u32 s39, s34, s3
  s_lshl_b32 s7, s30, 6
  s_add_u32 s7, s7, s39
  s_lshl_b32 s6, s29, 12
  s_add_u32 m0, s37, s6
  s_lshl_b32 s3, s7, 14
  s_add_u32 s3, s3, s6
  s_add_u32 s3, s3, 8388608
  buffer_load_dwordx4 v1, s[8:11], s3 offen offset:0 sc1 lds
  buffer_load_dwordx4 v1, s[8:11], s3 offen offset:1024 sc1 lds
  buffer_load_dwordx4 v1, s[8:11], s3 offen offset:2048 sc1 lds
  buffer_load_dwordx4 v1, s[8:11], s3 offen offset:3072 sc1 lds
  s_lshl_b32 s6, s29, 11
  s_add_u32 s6, s6, 16384
  s_add_u32 m0, s37, s6
  s_lshl_b32 s3, s7, 13
  s_add_u32 s3, s3, 42991616
  buffer_load_dwordx4 v3, s[8:11], s3 offen offset:0 sc1 lds
  buffer_load_dwordx4 v3, s[8:11], s3 offen offset:1024 sc1 lds
  s_lshl_b32 s6, s29, 10
  s_add_u32 s6, s6, 24576
  s_add_u32 m0, s37, s6
  s_add_u32 s3, s7, s30
  s_lshl_b32 s3, s3, 12
  s_add_u32 s3, s3, 59772928
  buffer_load_dwordx4 v2, s[8:11], s3 offen sc1 lds
  s_xor_b32 s37, s37, 98304
  s_waitcnt vmcnt(7)
  s_barrier
D_top_34:
  s_cmp_lt_u32 s34, 48
  s_cbranch_scc1 D_chk_35
  v_mov_b32 v128, v8
  v_mov_b32 v129, v9
  v_mov_b32 v130, v10
  v_mov_b32 v131, v11
  v_mov_b32 v132, v12
  v_min_u32 v5, 55, v0
  v_lshlrev_b32 v5, 4, v5
  v_add_u32 v5, 598016, v5
  v_cmp_le_u32 vcc, 32, v0
  s_nop 1
  v_cndmask_b32 v12, 3, 4, vcc
  v_cmp_le_u32 vcc, 48, v0
  s_nop 1
  v_cndmask_b32 v12, v12, 0, vcc
W_spin_36:
  buffer_load_dwordx4 v[8:11], v5, s[8:11], 0 offen sc1
W_spin_36h:
  s_add_u32 s44, s44, 1
  s_cmp_gt_u32 s44, 400000
  s_cbranch_scc1 W_spin_36x
  s_waitcnt vmcnt(0)
  v_min3_u32 v8, v8, v9, v10
  v_min_u32 v8, v8, v11
  v_cmp_gt_u32 vcc, v12, v8
  s_cbranch_vccz W_spin_36x
  s_sleep 8
  s_branch W_spin_36
W_spin_36x:
  s_waitcnt vmcnt(0)
  v_mov_b32 v8, v128
  v_mov_b32 v9, v129
  v_mov_b32 v10, v130
  v_mov_b32 v11, v131
  v_mov_b32 v12, v132
D_chk_35:
  s_lshl_b32 s39, s34, 7
  s_add_u32 s39, s39, 622592
  s_lshl_b32 s40, s34, 15
  s_add_u32 s3, s40, 5242880
  buffer_load_dwordx2 v[192:193], v11, s[8:11], s3 offen sc1
  buffer_load_dword v194, v15, s[8:11], s39 offen sc1
  s_mul_i32 s3, s30, 65
  s_add_u32 s3, s3, s34
  s_lshl_b32 s42, s3, 12
  s_add_u32 s42, s42, 59772928
  ds_read_b128 v[16:19], v197 offset:0
  ds_read_b128 v[20:23], v197 offset:1024
  ds_read_b128 v[24:27], v197 offset:2048
  ds_read_b128 v[28:31], v197 offset:3072
  ds_read_b128 v[32:35], v196 offset:0
  ds_read_b128 v[36:39], v196 offset:1024
  ds_read_b128 v[40:43], v196 offset:2048
  ds_read_b128 v[44:47], v196 offset:3072
  ds_read_b128 v[48:51], v196 offset:4096
  ds_read_b128 v[52:55], v196 offset:5120
  ds_read_b128 v[56:59], v196 offset:6144
  ds_read_b128 v[60:63], v196 offset:7168
  s_waitcnt lgkmcnt(4)
  ds_read_b128 v[64:67], v198 offset:0
  ds_read_b128 v[68:71], v198 offset:1024
  ds_read_b128 v[72:75], v198 offset:2048
  ds_read_b128 v[76:79], v198 offset:3072
  ds_read_b128 v[92:95], v199
  v_xor_b32 v196, 98304, v196
  v_xor_b32 v197, 98304, v197
  v_xor_b32 v198, 98304, v198
  v_xor_b32 v199, 98304, v199
  v_mfma_f32_16x16x32_bf16 v[80:83], v[32:35], v[16:19], 0
  v_mfma_f32_16x16x32_bf16 v[80:83], v[36:39], v[20:23], v[80:83]
  v_mfma_f32_16x16x32_bf16 v[80:83], v[40:43], v[24:27], v[80:83]
  v_mfma_f32_16x16x32_bf16 v[80:83], v[44:47], v[28:31], v[80:83]
  s_waitcnt lgkmcnt(5)
  v_mfma_f32_16x16x32_bf16 v[84:87], v[48:51], v[16:19], 0
  v_mfma_f32_16x16x32_bf16 v[84:87], v[52:55], v[20:23], v[84:87]
  v_mfma_f32_16x16x32_bf16 v[84:87], v[56:59], v[24:27], v[84:87]
  v_mfma_f32_16x16x32_bf16 v[84:87], v[60:63], v[28:31], v[84:87]
  v_mov_b32 v4, 0xd028965f
  v_cmp_le_i32 vcc, 0, v10
  s_nop 1
  v_cndmask_b32 v80, v4, v80, vcc
  v_cmp_le_i32 vcc, 1, v10
  s_nop 1
  v_cndmask_b32 v81, v4, v81, vcc
  v_cmp_le_i32 vcc, 2, v10
  s_nop 1
  v_cndmask_b32 v82, v4, v82, vcc
  v_cmp_le_i32 vcc, 3, v10
  s_nop 1
  v_cndmask_b32 v83, v4, v83, vcc
  v_cmp_le_i32 vcc, 16, v10
  s_nop 1
  v_cndmask_b32 v84, v4, v84, vcc
  v_cmp_le_i32 vcc, 17, v10
  s_nop 1
  v_cndmask_b32 v85, v4, v85, vcc
  v_cmp_le_i32 vcc, 18, v10
  s_nop 1
  v_cndmask_b32 v86, v4, v86, vcc
  v_cmp_le_i32 vcc, 19, v10
  s_nop 1
  v_cndmask_b32 v87, v4, v87, vcc
  v_max3_f32 v14, v80, v81, v82
  v_max3_f32 v14, v14, v83, v84
  v_max3_f32 v14, v14, v85, v86
  v_max_f32 v14, v14, v87
  s_waitcnt lgkmcnt(0)
  v_max3_u32 v4, v92, v93, v94
  v_max_u32 v4, v4, v95
  v_cmp_eq_u32 vcc, -1, v4
  s_cbranch_vccz D_got_37
W_spin_38:
  buffer_load_dwordx4 v[92:95], v2, s[8:11], s42 offen sc1
W_spin_38h:
  s_add_u32 s44, s44, 1
  s_cmp_gt_u32 s44, 400000
  s_cbranch_scc1 W_spin_38x
  s_waitcnt vmcnt(0)
  v_max3_u32 v4, v92, v93, v94
  v_max_u32 v4, v4, v95
  v_cmp_eq_u32 vcc, -1, v4
  s_cbranch_vccz W_spin_38x
  s_sleep 1
  s_branch W_spin_38
W_spin_38x:
  s_waitcnt vmcnt(0)
D_got_37:
  ds_write2_b32 v6, v92, v93 offset0:0 offset1:128
  ds_write_b64 v8, v[94:95]
  s_waitcnt lgkmcnt(0)
  s_barrier
  ds_read_b64_tr_b16 v[96:97], v7 offset:0
  ds_read_b64_tr_b16 v[98:99], v7 offset:512
  ds_read_b64_tr_b16 v[100:101], v7 offset:1024
  ds_read_b64_tr_b16 v[102:103], v7 offset:1536
  ds_read_b64_tr_b16 v[104:105], v7 offset:2048
  ds_read_b64_tr_b16 v[106:107], v7 offset:2560
  ds_read_b64_tr_b16 v[108:109], v7 offset:3072
  ds_read_b64_tr_b16 v[110:111], v7 offset:3584
  ds_read_b64 v[112:113], v9 offset:0
  ds_read_b64 v[114:115], v9 offset:512
  s_waitcnt lgkmcnt(8)
  v_mfma_f32_16x16x32_bf16 v[88:91], v[96:99], v[16:19], 0
  s_waitcnt lgkmcnt(6)
  v_mfma_f32_16x16x32_bf16 v[88:91], v[100:103], v[20:23], v[88:91]
  s_waitcnt lgkmcnt(4)
  v_mfma_f32_16x16x32_bf16 v[88:91], v[104:107], v[24:27], v[88:91]
  s_waitcnt lgkmcnt(2)
  v_mfma_f32_16x16x32_bf16 v[88:91], v[108:111], v[28:31], v[88:91]
  s_nop 7
  v_max3_f32 v4, v14, v88, v89
  v_max3_f32 v14, v14, v88, v89
  s_nop 1
  v_permlane16_swap_b32 v14, v4
  v_max_f32 v5, v14, v4
  v_max_f32 v14, v14, v4
  s_nop 1
  v_permlane32_swap_b32 v14, v5
  v_max_f32 v14, v14, v5
  v_mul_f32 v14, s43, v14
  v_fma_f32 v88, v88, s43, -v14
  v_fma_f32 v89, v89, s43, -v14
  v_fma_f32 v80, v80, s43, -v14
  v_fma_f32 v81, v81, s43, -v14
  v_fma_f32 v82, v82, s43, -v14
  v_fma_f32 v83, v83, s43, -v14
  v_fma_f32 v84, v84, s43, -v14
  v_fma_f32 v85, v85, s43, -v14
  v_fma_f32 v86, v86, s43, -v14
  v_fma_f32 v87, v87, s43, -v14
  v_exp_f32 v88, v88
  v_exp_f32 v89, v89
  v_exp_f32 v80, v80
  v_exp_f32 v81, v81
  v_exp_f32 v82, v82
  v_exp_f32 v83, v83
  v_exp_f32 v84, v84
  v_exp_f32 v85, v85
  v_exp_f32 v86, v86
  v_exp_f32 v87, v87
  v_cvt_pk_bf16_f32 v120, v88, v89
  v_cvt_pk_bf16_f32 v123, v88, v89
  v_cvt_pk_bf16_f32 v116, v80, v81
  v_cvt_pk_bf16_f32 v117, v82, v83
  v_cvt_pk_bf16_f32 v118, v84, v85
  v_cvt_pk_bf16_f32 v119, v86, v87
  s_waitcnt lgkmcnt(0)
  v_mfma_f32_16x16x16_bf16 v[16:19], v[124:125], v[120:121], 0
  v_mfma_f32_16x16x16_bf16 v[20:23], v[112:113], v[120:121], 0
  v_mfma_f32_16x16x16_bf16 v[24:27], v[112:113], v[122:123], 0
  v_mfma_f32_16x16x16_bf16 v[28:31], v[114:115], v[120:121], 0
  v_mfma_f32_16x16x16_bf16 v[32:35], v[114:115], v[122:123], 0
  v_mfma_f32_16x16x32_bf16 v[16:19], v[124:127], v[116:119], v[16:19]
  v_mfma_f32_16x16x32_bf16 v[20:23], v[64:67], v[116:119], v[20:23]
  v_mfma_f32_16x16x32_bf16 v[24:27], v[68:71], v[116:119], v[24:27]
  v_mfma_f32_16x16x32_bf16 v[28:31], v[72:75], v[116:119], v[28:31]
  v_mfma_f32_16x16x32_bf16 v[32:35], v[76:79], v[116:119], v[32:35]
  v_rcp_f32 v14, v16
  s_xor_b32 s35, s35, 0x40000
  s_add_u32 s38, s35, 69206016
  s_and_b32 s3, s29, 1
  s_lshl_b32 s3, s3, 17
  s_lshr_b32 s6, s29, 1
  s_lshl_b32 s6, s6, 11
  s_add_u32 s3, s3, s6
  s_lshl_b32 s6, s30, 12
  s_add_u32 s3, s3, s6
  s_add_u32 s3, s3, s38
  v_mul_f32 v20, v20, v14
  v_mul_f32 v21, v21, v14
  v_mul_f32 v22, v22, v14
  v_mul_f32 v23, v23, v14
  v_mul_f32 v24, v24, v14
  v_mul_f32 v25, v25, v14
  v_mul_f32 v26, v26, v14
  v_mul_f32 v27, v27, v14
  v_mul_f32 v28, v28, v14
  v_mul_f32 v29, v29, v14
  v_mul_f32 v30, v30, v14
  v_mul_f32 v31, v31, v14
  v_mul_f32 v32, v32, v14
  v_mul_f32 v33, v33, v14
  v_mul_f32 v34, v34, v14
  v_mul_f32 v35, v35, v14
  v_cvt_pk_bf16_f32 v36, v20, v21
  v_cvt_pk_bf16_f32 v37, v22, v23
  v_cvt_pk_bf16_f32 v38, v24, v25
  v_cvt_pk_bf16_f32 v39, v26, v27
  v_cvt_pk_bf16_f32 v40, v28, v29
  v_cvt_pk_bf16_f32 v41, v30, v31
  v_cvt_pk_bf16_f32 v42, v32, v33
  v_cvt_pk_bf16_f32 v43, v34, v35
  s_lshl_b32 s39, s34, 7
  s_mov_b32 s41, s32
  s_lshl_b32 s6, s30, 2
  s_add_u32 s7, s6, s41
  s_cmp_eq_u32 s45, 0
  s_cbranch_scc1 D_far_39
  buffer_store_dwordx4 v[36:39], v1, s[8:11], s3 offen offset:0
  buffer_store_dwordx4 v[40:43], v1, s[8:11], s3 offen offset:1024
  s_waitcnt vmcnt(0)
  s_barrier
  s_cmp_lg_u32 s29, 0
  s_cbranch_scc1 W_pub_41
  v_mov_b32 v4, 1
  s_mov_b64 exec, 1
  buffer_store_dword v4, off, s[8:11], s7
  s_mov_b64 exec, -1
W_pub_41:
  s_branch D_sent_40
D_far_39:
  buffer_store_dwordx4 v[36:39], v1, s[8:11], s3 offen offset:0 sc1
  buffer_store_dwordx4 v[40:43], v1, s[8:11], s3 offen offset:1024 sc1
  s_waitcnt vmcnt(0)
  s_barrier
  s_cmp_lg_u32 s29, 0
  s_cbranch_scc1 W_pub_42
  v_mov_b32 v4, 1
  s_mov_b64 exec, 1
  buffer_store_dword v4, off, s[8:11], s7 sc1
  s_mov_b64 exec, -1
W_pub_42:
D_sent_40:
  s_lshl_b32 s3, s29, 5
  s_add_u32 s41, s41, s3
  v_and_b32 v5, 7, v0
  v_lshlrev_b32 v5, 2, v5
  s_lshr_b32 s3, s30, 4
  s_lshl_b32 s3, s3, 17
  s_add_u32 s38, s38, s3
  s_lshl_b32 s3, s29, 15
  s_add_u32 s38, s38, s3
W_spin_45:
  buffer_load_dword v4, v5, s[8:11], s41 offen sc1
W_spin_45h:
  s_add_u32 s44, s44, 1
  s_cmp_gt_u32 s44, 400000
  s_cbranch_scc1 W_spin_45x
  s_waitcnt vmcnt(0)
  v_cmp_ne_u32 vcc, 1, v4
  s_cbranch_vccnz W_spin_45
W_spin_45x:
  s_waitcnt vmcnt(0)
  s_xor_b32 s3, s33, 0
  s_add_u32 s3, s3, s38
  buffer_load_dwordx4 v[128:131], v1, s[8:11], s3 offen offset:0 sc1
  buffer_load_dwordx4 v[132:135], v1, s[8:11], s3 offen offset:1024 sc1
  buffer_load_dwordx4 v[136:139], v1, s[8:11], s3 offen offset:2048 sc1
  buffer_load_dwordx4 v[140:143], v1, s[8:11], s3 offen offset:3072 sc1
  s_xor_b32 s3, s33, 4096
  s_add_u32 s3, s3, s38
  buffer_load_dwordx4 v[144:147], v1, s[8:11], s3 offen offset:0 sc1
  buffer_load_dwordx4 v[148:151], v1, s[8:11], s3 offen offset:1024 sc1
  buffer_load_dwordx4 v[152:155], v1, s[8:11], s3 offen offset:2048 sc1
  buffer_load_dwordx4 v[156:159], v1, s[8:11], s3 offen offset:3072 sc1
  s_xor_b32 s3, s33, 8192
  s_add_u32 s3, s3, s38
  buffer_load_dwordx4 v[160:163], v1, s[8:11], s3 offen offset:0 sc1
  buffer_load_dwordx4 v[164:167], v1, s[8:11], s3 offen offset:1024 sc1
  s_waitcnt vmcnt(9)
  v_mfma_f32_16x16x32_bf16 v[96:99], a[0:3], v[128:131], 0
  v_mfma_f32_16x16x32_bf16 v[100:103], a[8:11], v[128:131], 0
  buffer_load_dwordx4 v[168:171], v1, s[8:11], s3 offen offset:2048 sc1
  s_waitcnt vmcnt(9)
  v_mfma_f32_16x16x32_bf16 v[96:99], a[4:7], v[132:135], v[96:99]
  v_mfma_f32_16x16x32_bf16 v[100:103], a[12:15], v[132:135], v[100:103]
  buffer_load_dwordx4 v[172:175], v1, s[8:11], s3 offen offset:3072 sc1
  s_waitcnt vmcnt(9)
  v_mfma_f32_16x16x32_bf16 v[96:99], a[16:19], v[136:139], v[96:99]
  v_mfma_f32_16x16x32_bf16 v[100:103], a[24:27], v[136:139], v[100:103]
  s_xor_b32 s3, s33, 12288
  s_add_u32 s3, s3, s38
  buffer_load_dwordx4 v[176:179], v1, s[8:11], s3 offen offset:0 sc1
  s_waitcnt vmcnt(9)
  v_mfma_f32_16x16x32_bf16 v[96:99], a[20:23], v[140:143], v[96:99]
  v_mfma_f32_16x16x32_bf16 v[100:103], a[28:31], v[140:143], v[100:103]
  buffer_load_dwordx4 v[180:183], v1, s[8:11], s3 offen offset:1024 sc1
  s_waitcnt vmcnt(9)
  v_mfma_f32_16x16x32_bf16 v[96:99], a[32:35], v[144:147], v[96:99]
  v_mfma_f32_16x16x32_bf16 v[100:103], a[40:43], v[144:147], v[100:103]
  buffer_load_dwordx4 v[184:187], v1, s[8:11], s3 offen offset:2048 sc1
  s_waitcnt vmcnt(9)
  v_mfma_f32_16x16x32_bf16 v[96:99], a[36:39], v[148:151], v[96:99]
  v_mfma_f32_16x16x32_bf16 v[100:103], a[44:47], v[148:151], v[100:103]
  buffer_load_dwordx4 v[188:191], v1, s[8:11], s3 offen offset:3072 sc1
  s_waitcnt vmcnt(9)
  v_mfma_f32_16x16x32_bf16 v[96:99], a[48:51], v[152:155], v[96:99]
  v_mfma_f32_16x16x32_bf16 v[100:103], a[56:59], v[152:155], v[100:103]
  s_xor_b32 s3, s33, 16384
  s_add_u32 s3, s3, s38
  buffer_load_dwordx4 v[128:131], v1, s[8:11], s3 offen offset:0 sc1
  s_waitcnt vmcnt(9)
  v_mfma_f32_16x16x32_bf16 v[96:99], a[52:55], v[156:159], v[96:99]
  v_mfma_f32_16x16x32_bf16 v[100:103], a[60:63], v[156:159], v[100:103]
  buffer_load_dwordx4 v[132:135], v1, s[8:11], s3 offen offset:1024 sc1
  s_waitcnt vmcnt(9)
  v_mfma_f32_16x16x32_bf16 v[96:99], a[64:67], v[160:163], v[96:99]
  v_mfma_f32_16x16x32_bf16 v[100:103], a[72:75], v[160:163], v[100:103]
  buffer_load_dwordx4 v[136:139], v1, s[8:11], s3 offen offset:2048 sc1
  s_waitcnt vmcnt(9)
  v_mfma_f32_16x16x32_bf16 v[96:99], a[68:71], v[164:167], v[96:99]
  v_mfma_f32_16x16x32_bf16 v[100:103], a[76:79], v[164:167], v[100:103]
  buffer_load_dwordx4 v[140:143], v1, s[8:11], s3 offen offset:3072 sc1
  s_waitcnt vmcnt(9)
  v_mfma_f32_16x16x32_bf16 v[96:99], a[80:83], v[168:171], v[96:99]
  v_mfma_f32_16x16x32_bf16 v[100:103], a[88:91], v[168:171], v[100:103]
  s_xor_b32 s3, s33, 20480
  s_add_u32 s3, s3, s38
  buffer_load_dwordx4 v[144:147], v1, s[8:11], s3 offen offset:0 sc1
  s_waitcnt vmcnt(9)
  v_mfma_f32_16x16x32_bf16 v[96:99], a[84:87], v[172:175], v[96:99]
  v_mfma_f32_16x16x32_bf16 v[100:103], a[92:95], v[172:175], v[100:103]
  buffer_load_dwordx4 v[148:151], v1, s[8:11], s3 offen offset:1024 sc1
  s_waitcnt vmcnt(9)
  v_mfma_f32_16x16x32_bf16 v[96:99], a[96:99], v[176:179], v[96:99]
  v_mfma_f32_16x16x32_bf16 v[100:103], a[104:107], v[176:179], v[100:103]
  buffer_load_dwordx4 v[152:155], v1, s[8:11], s3 offen offset:2048 sc1
  s_waitcnt vmcnt(9)
  v_mfma_f32_16x16x32_bf16 v[96:99], a[100:103], v[180:183], v[96:99]
  v_mfma_f32_16x16x32_bf16 v[100:103], a[108:111], v[180:183], v[100:103]
  buffer_load_dwordx4 v[156:159], v1, s[8:11], s3 offen offset:3072 sc1
  s_waitcnt vmcnt(9)
  v_mfma_f32_16x16x32_bf16 v[96:99], a[112:115], v[184:187], v[96:99]
  v_mfma_f32_16x16x32_bf16 v[100:103], a[120:123], v[184:187], v[100:103]
  s_xor_b32 s3, s33, 24576
  s_add_u32 s3, s3, s38
  buffer_load_dwordx4 v[160:163], v1, s[8:11], s3 offen offset:0 sc1
  s_waitcnt vmcnt(9)
  v_mfma_f32_16x16x32_bf16 v[96:99], a[116:119], v[188:191], v[96:99]
  v_mfma_f32_16x16x32_bf16 v[100:103], a[124:127], v[188:191], v[100:103]
  buffer_load_dwordx4 v[164:167], v1, s[8:11], s3 offen offset:1024 sc1
  s_waitcnt vmcnt(9)
  v_mfma_f32_16x16x32_bf16 v[96:99], a[128:131], v[128:131], v[96:99]
  v_mfma_f32_16x16x32_bf16 v[100:103], a[136:139], v[128:131], v[100:103]
  buffer_load_dwordx4 v[168:171], v1, s[8:11], s3 offen offset:2048 sc1
  s_waitcnt vmcnt(9)
  v_mfma_f32_16x16x32_bf16 v[96:99], a[132:135], v[132:135], v[96:99]
  v_mfma_f32_16x16x32_bf16 v[100:103], a[140:143], v[132:135], v[100:103]
  buffer_load_dwordx4 v[172:175], v1, s[8:11], s3 offen offset:3072 sc1
  s_waitcnt vmcnt(9)
  v_mfma_f32_16x16x32_bf16 v[96:99], a[144:147], v[136:139], v[96:99]
  v_mfma_f32_16x16x32_bf16 v[100:103], a[152:155], v[136:139], v[100:103]
  s_xor_b32 s3, s33, 28672
  s_add_u32 s3, s3, s38
  buffer_load_dwordx4 v[176:179], v1, s[8:11], s3 offen offset:0 sc1
  s_waitcnt vmcnt(9)
  v_mfma_f32_16x16x32_bf16 v[96:99], a[148:151], v[140:143], v[96:99]
  v_mfma_f32_16x16x32_bf16 v[100:103], a[156:159], v[140:143], v[100:103]
  buffer_load_dwordx4 v[180:183], v1, s[8:11], s3 offen offset:1024 sc1
  s_waitcnt vmcnt(9)
  v_mfma_f32_16x16x32_bf16 v[96:99], a[160:163], v[144:147], v[96:99]
  v_mfma_f32_16x16x32_bf16 v[100:103], a[168:171], v[144:147], v[100:103]
  buffer_load_dwordx4 v[184:187], v1, s[8:11], s3 offen offset:2048 sc1
  s_waitcnt vmcnt(9)
  v_mfma_f32_16x16x32_bf16 v[96:99], a[164:167], v[148:151], v[96:99]
  v_mfma_f32_16x16x32_bf16 v[100:103], a[172:175], v[148:151], v[100:103]
  buffer_load_dwordx4 v[188:191], v1, s[8:11], s3 offen offset:3072 sc1
  s_waitcnt vmcnt(9)
  v_mfma_f32_16x16x32_bf16 v[96:99], a[176:179], v[152:155], v[96:99]
  v_mfma_f32_16x16x32_bf16 v[100:103], a[184:187], v[152:155], v[100:103]
  s_waitcnt vmcnt(8)
  v_mfma_f32_16x16x32_bf16 v[96:99], a[180:183], v[156:159], v[96:99]
  v_mfma_f32_16x16x32_bf16 v[100:103], a[188:191], v[156:159], v[100:103]
  s_waitcnt vmcnt(7)
  v_mfma_f32_16x16x32_bf16 v[96:99], a[192:195], v[160:163], v[96:99]
  v_mfma_f32_16x16x32_bf16 v[100:103], a[200:203], v[160:163], v[100:103]
  s_waitcnt vmcnt(6)
  v_mfma_f32_16x16x32_bf16 v[96:99], a[196:199], v[164:167], v[96:99]
  v_mfma_f32_16x16x32_bf16 v[100:103], a[204:207], v[164:167], v[100:103]
  s_waitcnt vmcnt(5)
  v_mfma_f32_16x16x32_bf16 v[96:99], a[208:211], v[168:171], v[96:99]
  v_mfma_f32_16x16x32_bf16 v[100:103], a[216:219], v[168:171], v[100:103]
  s_waitcnt vmcnt(4)
  v_mfma_f32_16x16x32_bf16 v[96:99], a[212:215], v[172:175], v[96:99]
  v_mfma_f32_16x16x32_bf16 v[100:103], a[220:223], v[172:175], v[100:103]
  s_waitcnt vmcnt(3)
  v_mfma_f32_16x16x32_bf16 v[96:99], a[224:227], v[176:179], v[96:99]
  v_mfma_f32_16x16x32_bf16 v[100:103], a[232:235], v[176:179], v[100:103]
  s_waitcnt vmcnt(2)
  v_mfma_f32_16x16x32_bf16 v[96:99], a[228:231], v[180:183], v[96:99]
  v_mfma_f32_16x16x32_bf16 v[100:103], a[236:239], v[180:183], v[100:103]
  s_waitcnt vmcnt(1)
  v_mfma_f32_16x16x32_bf16 v[96:99], a[240:243], v[184:187], v[96:99]
  v_mfma_f32_16x16x32_bf16 v[100:103], a[248:251], v[184:187], v[100:103]
  s_waitcnt vmcnt(0)
  v_mfma_f32_16x16x32_bf16 v[96:99], a[244:247], v[188:191], v[96:99]
  v_mfma_f32_16x16x32_bf16 v[100:103], a[252:255], v[188:191], v[100:103]
  s_nop 3
  ds_write_b128 v12, v[96:99] offset:0
  s_nop 2
  ds_write_b128 v12, v[100:103] offset:1024
  s_waitcnt lgkmcnt(0)
  s_barrier
  s_cmp_lt_u32 s34, 12
  s_cselect_b32 s3, 4, 6
  s_add_u32 s34, s34, s3
  s_add_u32 s32, s32, 128
  s_cmp_lt_u32 s34, 12
  s_cselect_b32 s3, 4, 6
  s_add_u32 s39, s34, s3
  s_cmp_ge_u32 s39, 64
  s_cbranch_scc1 E_nof_44
  s_lshl_b32 s7, s30, 6
  s_add_u32 s7, s7, s39
  s_lshl_b32 s6, s29, 12
  s_add_u32 m0, s37, s6
  s_lshl_b32 s3, s7, 14
  s_add_u32 s3, s3, s6
  s_add_u32 s3, s3, 8388608
  buffer_load_dwordx4 v1, s[8:11], s3 offen offset:0 sc1 lds
  buffer_load_dwordx4 v1, s[8:11], s3 offen offset:1024 sc1 lds
  buffer_load_dwordx4 v1, s[8:11], s3 offen offset:2048 sc1 lds
  buffer_load_dwordx4 v1, s[8:11], s3 offen offset:3072 sc1 lds
  s_lshl_b32 s6, s29, 11
  s_add_u32 s6, s6, 16384
  s_add_u32 m0, s37, s6
  s_lshl_b32 s3, s7, 13
  s_add_u32 s3, s3, 42991616
  buffer_load_dwordx4 v3, s[8:11], s3 offen offset:0 sc1 lds
  buffer_load_dwordx4 v3, s[8:11], s3 offen offset:1024 sc1 lds
  s_lshl_b32 s6, s29, 10
  s_add_u32 s6, s6, 24576
  s_add_u32 m0, s37, s6
  s_add_u32 s3, s7, s30
  s_lshl_b32 s3, s3, 12
  s_add_u32 s3, s3, 59772928
  buffer_load_dwordx4 v2, s[8:11], s3 offen sc1 lds
  s_xor_b32 s37, s37, 98304
E_nof_44:
  s_cmp_ge_u32 s29, 2
  s_cbranch_scc1 E_nxt_43
  ds_read_b128 v[96:99], v13 offset:0
  ds_read_b128 v[100:103], v13 offset:2048
  ds_read_b128 v[104:107], v13 offset:4096
  ds_read_b128 v[108:111], v13 offset:6144
  v_and_b32 v81, 0xffff0000, v192
  v_lshlrev_b32 v80, 16, v192
  v_and_b32 v83, 0xffff0000, v193
  v_lshlrev_b32 v82, 16, v193
  v_sub_f32 v195, 1.0, v194
  v_cvt_pk_bf16_f32 v195, v195, v195
  v_lshlrev_b32 v195, 16, v195
  v_mul_f32 v80, v80, v195
  v_mul_f32 v81, v81, v195
  v_mul_f32 v82, v82, v195
  v_mul_f32 v83, v83, v195
  v_cvt_pk_bf16_f32 v84, v80, v81
  v_and_b32 v81, 0xffff0000, v84
  v_lshlrev_b32 v80, 16, v84
  v_cvt_pk_bf16_f32 v84, v82, v83
  v_and_b32 v83, 0xffff0000, v84
  v_lshlrev_b32 v82, 16, v84
  s_waitcnt lgkmcnt(0)
  v_add_f32 v96, v96, v100
  v_add_f32 v104, v104, v108
  v_add_f32 v96, v96, v104
  v_add_f32 v97, v97, v101
  v_add_f32 v105, v105, v109
  v_add_f32 v97, v97, v105
  v_add_f32 v98, v98, v102
  v_add_f32 v106, v106, v110
  v_add_f32 v98, v98, v106
  v_add_f32 v99, v99, v103
  v_add_f32 v107, v107, v111
  v_add_f32 v99, v99, v107
  v_cvt_pk_bf16_f32 v84, v96, v97
  v_and_b32 v97, 0xffff0000, v84
  v_lshlrev_b32 v96, 16, v84
  v_cvt_pk_bf16_f32 v84, v98, v99
  v_and_b32 v99, 0xffff0000, v84
  v_lshlrev_b32 v98, 16, v84
  v_mul_f32 v96, v96, v194
  v_mul_f32 v97, v97, v194
  v_mul_f32 v98, v98, v194
  v_mul_f32 v99, v99, v194
  v_cvt_pk_bf16_f32 v84, v96, v97
  v_and_b32 v97, 0xffff0000, v84
  v_lshlrev_b32 v96, 16, v84
  v_cvt_pk_bf16_f32 v84, v98, v99
  v_and_b32 v99, 0xffff0000, v84
  v_lshlrev_b32 v98, 16, v84
  v_add_f32 v96, v96, v80
  v_add_f32 v97, v97, v81
  v_add_f32 v98, v98, v82
  v_add_f32 v99, v99, v83
  v_cvt_pk_bf16_f32 v84, v96, v97
  v_cvt_pk_bf16_f32 v85, v98, v99
  buffer_store_dwordx2 v[84:85], v11, s[16:19], s40 offen
E_nxt_43:
  s_cmp_lt_u32 s34, 64
  s_cbranch_scc1 D_top_34
L_done:
L_end:
s_endpgm
.section .rodata,"a"
.p2align 6
.amdhsa_kernel gated_mix__memory_aug_recurrent_mem_tr__mixer_token_mlp__prompt_kernel
  .amdhsa_next_free_vgpr 512
  .amdhsa_next_free_sgpr 102
  .amdhsa_accum_offset 256
  .amdhsa_group_segment_fixed_size 0
  .amdhsa_kernarg_size 128
  .amdhsa_user_sgpr_count 2
  .amdhsa_user_sgpr_kernarg_segment_ptr 1
  .amdhsa_system_sgpr_workgroup_id_x 1
  .amdhsa_float_denorm_mode_32 3
.end_amdhsa_kernel
```
